```python
import torch

def _softmax(x, axis=-1):
    return torch.softmax(x, dim=axis)
def _gelu(x):
    return torch.nn.functional.gelu(x, approximate="tanh")
def _silu(x):
    return torch.nn.functional.silu(x)
def _sigmoid(x):
    return torch.sigmoid(x)
def _layernorm(x, axis=-1, eps=1e-5):
    m = x.mean(dim=axis, keepdim=True)
    v = x.var(dim=axis, keepdim=True, unbiased=False)
    return (x - m) / torch.sqrt(v + eps)
def _scatter_add(tgt, idx, src, axis=0):
    return tgt.clone().index_add_(axis, idx, src)
def _segment_sum(src, seg, n):
    out = torch.zeros((n,) + src.shape[1:], dtype=src.dtype)
    return out.index_add_(0, seg, src)
def _pad(x, pw):
    flat = tuple(v for pair in reversed(pw) for v in pair)
    return torch.nn.functional.pad(x, flat)

kernel_name = 'gated_mix__mha_block_cached__dense_activation_squared_relu__decode'

def setup_inputs():

    _w = (lambda a: (lambda t: t.to(torch.bfloat16) if t.is_floating_point() else t)(torch.as_tensor(a)))
    def _A_setup():
        B, Sq, D = 4, 1, 512
        H, Sk, Dh = 32, 8192, 128
        return {
            "x": _w((lambda *s: torch.randn(*s, dtype=torch.bfloat16) * 0.05)(B, Sq, D)),
            "k_cache": _w((lambda *s: torch.randn(*s, dtype=torch.bfloat16) * 6.4)(B, H, Sk, Dh)),
            "v_cache": _w((lambda *s: torch.randn(*s, dtype=torch.bfloat16) * 0.4)(B, H, Sk, Dh)),
            "wq": _w((lambda *s: torch.randn(*s, dtype=torch.bfloat16) * 6.4)(D, H * Dh) * (D ** -0.5)),
            "wo": _w((lambda *s: torch.randn(*s, dtype=torch.bfloat16) * 0.4)(H * Dh, D) * ((H * Dh) ** -0.5)),
        }
    _A_in = _A_setup()

    def _B_setup():
        B, S, D, F = 4, 1, 512, 1792
        return {
            "x": _w((lambda *s: torch.randn(*s, dtype=torch.bfloat16) * 0.05)(B, S, D)),
            "w1": _w((lambda *s: torch.randn(*s, dtype=torch.bfloat16) * 0.05)(D, F)),
            "b1": _w((lambda *s: torch.randn(*s, dtype=torch.bfloat16) * 0.05)(F)),
            "w2": _w((lambda *s: torch.randn(*s, dtype=torch.bfloat16) * 0.05)(F, D)),
            "b2": _w((lambda *s: torch.randn(*s, dtype=torch.bfloat16) * 0.05)(D)),
        }
    _B_in = _B_setup()

    return {
        "A_x": _A_in["x"],
        "A_k_cache": _A_in["k_cache"],
        "A_v_cache": _A_in["v_cache"],
        "A_wq": _A_in["wq"],
        "A_wo": _A_in["wo"],
        "B_x": _B_in["x"],
        "B_w1": _B_in["w1"],
        "B_b1": _B_in["b1"],
        "B_w2": _B_in["w2"],
        "B_b2": _B_in["b2"],
        "gate_w": _w((lambda *s: torch.randn(*s, dtype=torch.bfloat16) * 0.05)(512) * 16.0),
    }

def reference(A_x, A_k_cache, A_v_cache, A_wq, A_wo, B_x, B_w1, B_b1, B_w2, B_b2, gate_w):
    def _A_ref(x, k_cache, v_cache, wq, wo):
        B, Sq, D = x.shape
        H, Dh = 32, 128
        q = (lambda x, *d: x.permute(*d))((x @ wq).reshape(B, Sq, H, Dh), 0, 2, 1, 3)
        scores = torch.einsum("bhqd,bhkd->bhqk", q, k_cache) * (Dh ** -0.5)
        p = _softmax(scores, axis=-1)
        o = torch.einsum("bhqk,bhkd->bhqd", p, v_cache)
        return (lambda x, *d: x.permute(*d))(o, 0, 2, 1, 3).reshape(B, Sq, H * Dh) @ wo

    def _B_ref(x, w1, b1, w2, b2):
        h = torch.einsum("bsd,df->bsf", x, w1) + b1
        zero = torch.zeros_like(h)
        r = torch.where(h > zero, h, zero)
        h = r * r
        out = torch.einsum("bsf,fd->bsd", h, w2) + b2
        return out

    x = A_x
    g = _sigmoid((x * gate_w).sum(-1, keepdims=True))
    a = _A_ref(x, A_k_cache, A_v_cache, A_wq, A_wo)
    b = _B_ref(x, B_w1, B_b1, B_w2, B_b2)
    return g * a + (1 - g) * b
```

```asm
; @launch grid=(256,1,1) block=(320,1,1) lds=4224
.amdgcn_target "amdgcn-amd-amdhsa--gfx950"
.text
.globl gated_mix__mha_block_cached__dense_activation_squared_relu__decode_kernel
.p2align 8
.type gated_mix__mha_block_cached__dense_activation_squared_relu__decode_kernel,@function
gated_mix__mha_block_cached__dense_activation_squared_relu__decode_kernel:
    s_cmp_ge_u32 s2, 256
    s_cbranch_scc1 L_end
    s_load_dwordx16 s[4:19], s[0:1], 0
    s_load_dwordx2 s[20:21], s[0:1], 64
    s_load_dwordx2 s[22:23], s[0:1], 104
    v_lshrrev_b32 v29, 6, v0
    s_and_b32 s62, s2, 7
    s_lshr_b32 s63, s2, 3
    v_readfirstlane_b32 s59, v29
    s_lshr_b32 s64, s63, 3
    s_lshl_b32 s56, s64, 3
    s_add_u32 s56, s56, s62
    s_and_b32 s63, s63, 7
    s_lshr_b32 s57, s63, 1
    s_and_b32 s58, s63, 1
    s_lshl_b32 s60, s56, 1
    s_add_u32 s60, s60, s58
    s_lshl_b32 s61, s57, 6
    s_add_u32 s61, s61, s60
    v_and_b32 v1, 63, v0
    s_mov_b32 s72, 0x05040100
    s_mov_b32 s73, 0x07060302
    s_cmp_eq_u32 s59, 4
    s_cbranch_scc1 L_aux
    s_add_u32 s65, s59, s63
    s_and_b32 s65, s65, 3
    v_lshrrev_b32 v29, 4, v1
    v_and_b32 v30, 15, v1
    v_lshlrev_b32 v31, 6, v29
    v_lshlrev_b32 v32, 18, v29
    v_lshl_add_u32 v32, v30, 4, v32
    v_lshlrev_b32 v35, 3, v29
    v_lshl_add_u32 v35, v30, 5, v35
    v_lshlrev_b32 v34, 4, v1
    s_lshl_b32 s62, s59, 13
    v_add_u32 v2, s62, v34
    v_add_u32 v3, 0x1000, v2
    s_lshl_b32 s63, s57, 10
    s_lshl_b32 s64, s65, 8
    s_add_u32 s63, s63, s64
    s_lshl_b32 s64, s65, 20
    s_lshl_b32 s62, s56, 8
    s_waitcnt lgkmcnt(0)
    s_mov_b32 s40, s4
    s_and_b32 s41, s5, 0xffff
    s_mov_b32 s42, 0x1000
    s_mov_b32 s43, 0x00020000
    s_add_u32 s32, s10, s62
    s_addc_u32 s33, s11, 0
    s_and_b32 s33, s33, 0xffff
    s_mov_b32 s34, 0x400000
    s_mov_b32 s35, 0x00020000
    s_sub_u32 s34, s34, s62
    buffer_load_dwordx4 v[232:235], v31, s[40:43], s63 offen offset:0
    buffer_load_dwordx4 v[236:239], v31, s[40:43], s63 offen offset:16
    buffer_load_dwordx4 v[240:243], v31, s[40:43], s63 offen offset:32
    buffer_load_dwordx4 v[244:247], v31, s[40:43], s63 offen offset:48
    s_lshl_b32 s62, s57, 5
    s_add_u32 s62, s62, s56
    s_lshl_b32 s62, s62, 1
    s_add_u32 s62, s62, s58
    s_lshl_b32 s62, s62, 20
    s_add_u32 s24, s6, s62
    s_addc_u32 s25, s7, 0
    s_and_b32 s25, s25, 0xffff
    s_mov_b32 s26, 0x100000
    s_mov_b32 s27, 0x00020000
    s_add_u32 s28, s8, s62
    s_addc_u32 s29, s9, 0
    s_and_b32 s29, s29, 0xffff
    s_mov_b32 s30, 0x100000
    s_mov_b32 s31, 0x00020000
    buffer_load_dwordx4 v[104:107], v32, s[32:35], s64 offen
    s_add_u32 s64, s64, 0x2000
    buffer_load_dwordx4 v[108:111], v32, s[32:35], s64 offen
    s_add_u32 s64, s64, 0x2000
    buffer_load_dwordx4 v[112:115], v32, s[32:35], s64 offen
    s_add_u32 s64, s64, 0x2000
    buffer_load_dwordx4 v[116:119], v32, s[32:35], s64 offen
    s_add_u32 s64, s64, 0x2000
    buffer_load_dwordx4 v[40:43], v2, s[24:27], 0 offen offset:0 nt
    buffer_load_dwordx4 v[120:123], v32, s[32:35], s64 offen
    s_add_u32 s64, s64, 0x2000
    buffer_load_dwordx4 v[124:127], v32, s[32:35], s64 offen
    s_add_u32 s64, s64, 0x2000
    buffer_load_dwordx4 v[128:131], v32, s[32:35], s64 offen
    s_add_u32 s64, s64, 0x2000
    buffer_load_dwordx4 v[132:135], v32, s[32:35], s64 offen
    s_add_u32 s64, s64, 0x2000
    buffer_load_dwordx4 v[44:47], v2, s[24:27], 0 offen offset:1024 nt
    buffer_load_dwordx4 v[136:139], v32, s[32:35], s64 offen
    s_add_u32 s64, s64, 0x2000
    buffer_load_dwordx4 v[140:143], v32, s[32:35], s64 offen
    s_add_u32 s64, s64, 0x2000
    buffer_load_dwordx4 v[144:147], v32, s[32:35], s64 offen
    s_add_u32 s64, s64, 0x2000
    buffer_load_dwordx4 v[148:151], v32, s[32:35], s64 offen
    s_add_u32 s64, s64, 0x2000
    buffer_load_dwordx4 v[48:51], v2, s[24:27], 0 offen offset:2048 nt
    buffer_load_dwordx4 v[152:155], v32, s[32:35], s64 offen
    s_add_u32 s64, s64, 0x2000
    buffer_load_dwordx4 v[156:159], v32, s[32:35], s64 offen
    s_add_u32 s64, s64, 0x2000
    buffer_load_dwordx4 v[160:163], v32, s[32:35], s64 offen
    s_add_u32 s64, s64, 0x2000
    buffer_load_dwordx4 v[164:167], v32, s[32:35], s64 offen
    s_add_u32 s64, s64, 0x2000
    buffer_load_dwordx4 v[52:55], v2, s[24:27], 0 offen offset:3072 nt
    buffer_load_dwordx4 v[168:171], v32, s[32:35], s64 offen
    s_add_u32 s64, s64, 0x2000
    buffer_load_dwordx4 v[172:175], v32, s[32:35], s64 offen
    s_add_u32 s64, s64, 0x2000
    buffer_load_dwordx4 v[176:179], v32, s[32:35], s64 offen
    s_add_u32 s64, s64, 0x2000
    buffer_load_dwordx4 v[180:183], v32, s[32:35], s64 offen
    s_add_u32 s64, s64, 0x2000
    buffer_load_dwordx4 v[56:59], v3, s[24:27], 0 offen offset:0 nt
    buffer_load_dwordx4 v[184:187], v32, s[32:35], s64 offen
    s_add_u32 s64, s64, 0x2000
    buffer_load_dwordx4 v[188:191], v32, s[32:35], s64 offen
    s_add_u32 s64, s64, 0x2000
    buffer_load_dwordx4 v[192:195], v32, s[32:35], s64 offen
    s_add_u32 s64, s64, 0x2000
    buffer_load_dwordx4 v[196:199], v32, s[32:35], s64 offen
    s_add_u32 s64, s64, 0x2000
    buffer_load_dwordx4 v[60:63], v3, s[24:27], 0 offen offset:1024 nt
    buffer_load_dwordx4 v[200:203], v32, s[32:35], s64 offen
    s_add_u32 s64, s64, 0x2000
    buffer_load_dwordx4 v[204:207], v32, s[32:35], s64 offen
    s_add_u32 s64, s64, 0x2000
    buffer_load_dwordx4 v[208:211], v32, s[32:35], s64 offen
    s_add_u32 s64, s64, 0x2000
    buffer_load_dwordx4 v[212:215], v32, s[32:35], s64 offen
    s_add_u32 s64, s64, 0x2000
    buffer_load_dwordx4 v[64:67], v3, s[24:27], 0 offen offset:2048 nt
    buffer_load_dwordx4 v[216:219], v32, s[32:35], s64 offen
    s_add_u32 s64, s64, 0x2000
    buffer_load_dwordx4 v[220:223], v32, s[32:35], s64 offen
    s_add_u32 s64, s64, 0x2000
    buffer_load_dwordx4 v[224:227], v32, s[32:35], s64 offen
    s_add_u32 s64, s64, 0x2000
    buffer_load_dwordx4 v[228:231], v32, s[32:35], s64 offen
    buffer_load_dwordx4 v[68:71], v3, s[24:27], 0 offen offset:3072 nt
    s_lshl_b32 s62, s56, 17
    s_lshl_b32 s64, s59, 8
    s_add_u32 s62, s62, s64
    s_add_u32 s36, s12, s62
    s_addc_u32 s37, s13, 0
    s_and_b32 s37, s37, 0xffff
    s_mov_b32 s38, 0x20000
    s_mov_b32 s39, 0x00020000
    s_sub_u32 s38, s38, s64
    v_lshrrev_b32 v36, 4, v1
    v_lshlrev_b32 v36, 11, v36
    v_and_b32 v29, 15, v1
    v_lshl_add_u32 v36, v29, 4, v36
    s_mov_b32 s52, s22
    s_and_b32 s53, s23, 0xffff
    s_mov_b32 s54, 0x138200
    s_mov_b32 s55, 0x00020000
    s_mov_b32 s74, 0x3e0293ee
    s_mov_b32 s76, 0xaaaaaaaa
    s_mov_b32 s77, 0xaaaaaaaa
    v_mov_b32 v8, 0
    v_mov_b32 v9, 0
    v_mov_b32 v10, 0
    v_mov_b32 v11, 0
    v_mov_b32 v12, 0
    v_mov_b32 v13, 0
    v_mov_b32 v14, 0
    v_mov_b32 v15, 0
    s_waitcnt vmcnt(38)
    v_perm_b32 v29, v108, v104, s72
    v_perm_b32 v30, v108, v104, s73
    v_dot2c_f32_bf16 v8, v29, v232
    v_dot2c_f32_bf16 v9, v30, v232
    v_perm_b32 v29, v109, v105, s72
    v_perm_b32 v30, v109, v105, s73
    v_dot2c_f32_bf16 v10, v29, v232
    v_dot2c_f32_bf16 v11, v30, v232
    v_perm_b32 v29, v110, v106, s72
    v_perm_b32 v30, v110, v106, s73
    v_dot2c_f32_bf16 v12, v29, v232
    v_dot2c_f32_bf16 v13, v30, v232
    v_perm_b32 v29, v111, v107, s72
    v_perm_b32 v30, v111, v107, s73
    v_dot2c_f32_bf16 v14, v29, v232
    v_dot2c_f32_bf16 v15, v30, v232
    s_waitcnt vmcnt(36)
    v_perm_b32 v29, v116, v112, s72
    v_perm_b32 v30, v116, v112, s73
    v_dot2c_f32_bf16 v8, v29, v233
    v_dot2c_f32_bf16 v9, v30, v233
    v_perm_b32 v29, v117, v113, s72
    v_perm_b32 v30, v117, v113, s73
    v_dot2c_f32_bf16 v10, v29, v233
    v_dot2c_f32_bf16 v11, v30, v233
    v_perm_b32 v29, v118, v114, s72
    v_perm_b32 v30, v118, v114, s73
    v_dot2c_f32_bf16 v12, v29, v233
    v_dot2c_f32_bf16 v13, v30, v233
    v_perm_b32 v29, v119, v115, s72
    v_perm_b32 v30, v119, v115, s73
    v_dot2c_f32_bf16 v14, v29, v233
    v_dot2c_f32_bf16 v15, v30, v233
    buffer_load_dwordx4 v[72:75], v2, s[28:31], 0 offen offset:0 nt
    s_waitcnt vmcnt(34)
    v_perm_b32 v29, v124, v120, s72
    v_perm_b32 v30, v124, v120, s73
    v_dot2c_f32_bf16 v8, v29, v234
    v_dot2c_f32_bf16 v9, v30, v234
    v_perm_b32 v29, v125, v121, s72
    v_perm_b32 v30, v125, v121, s73
    v_dot2c_f32_bf16 v10, v29, v234
    v_dot2c_f32_bf16 v11, v30, v234
    v_perm_b32 v29, v126, v122, s72
    v_perm_b32 v30, v126, v122, s73
    v_dot2c_f32_bf16 v12, v29, v234
    v_dot2c_f32_bf16 v13, v30, v234
    v_perm_b32 v29, v127, v123, s72
    v_perm_b32 v30, v127, v123, s73
    v_dot2c_f32_bf16 v14, v29, v234
    v_dot2c_f32_bf16 v15, v30, v234
    s_waitcnt vmcnt(32)
    v_perm_b32 v29, v132, v128, s72
    v_perm_b32 v30, v132, v128, s73
    v_dot2c_f32_bf16 v8, v29, v235
    v_dot2c_f32_bf16 v9, v30, v235
    v_perm_b32 v29, v133, v129, s72
    v_perm_b32 v30, v133, v129, s73
    v_dot2c_f32_bf16 v10, v29, v235
    v_dot2c_f32_bf16 v11, v30, v235
    v_perm_b32 v29, v134, v130, s72
    v_perm_b32 v30, v134, v130, s73
    v_dot2c_f32_bf16 v12, v29, v235
    v_dot2c_f32_bf16 v13, v30, v235
    v_perm_b32 v29, v135, v131, s72
    v_perm_b32 v30, v135, v131, s73
    v_dot2c_f32_bf16 v14, v29, v235
    v_dot2c_f32_bf16 v15, v30, v235
    buffer_load_dwordx4 v[76:79], v2, s[28:31], 0 offen offset:1024 nt
    s_waitcnt vmcnt(30)
    v_perm_b32 v29, v140, v136, s72
    v_perm_b32 v30, v140, v136, s73
    v_dot2c_f32_bf16 v8, v29, v236
    v_dot2c_f32_bf16 v9, v30, v236
    v_perm_b32 v29, v141, v137, s72
    v_perm_b32 v30, v141, v137, s73
    v_dot2c_f32_bf16 v10, v29, v236
    v_dot2c_f32_bf16 v11, v30, v236
    v_perm_b32 v29, v142, v138, s72
    v_perm_b32 v30, v142, v138, s73
    v_dot2c_f32_bf16 v12, v29, v236
    v_dot2c_f32_bf16 v13, v30, v236
    v_perm_b32 v29, v143, v139, s72
    v_perm_b32 v30, v143, v139, s73
    v_dot2c_f32_bf16 v14, v29, v236
    v_dot2c_f32_bf16 v15, v30, v236
    s_waitcnt vmcnt(28)
    v_perm_b32 v29, v148, v144, s72
    v_perm_b32 v30, v148, v144, s73
    v_dot2c_f32_bf16 v8, v29, v237
    v_dot2c_f32_bf16 v9, v30, v237
    v_perm_b32 v29, v149, v145, s72
    v_perm_b32 v30, v149, v145, s73
    v_dot2c_f32_bf16 v10, v29, v237
    v_dot2c_f32_bf16 v11, v30, v237
    v_perm_b32 v29, v150, v146, s72
    v_perm_b32 v30, v150, v146, s73
    v_dot2c_f32_bf16 v12, v29, v237
    v_dot2c_f32_bf16 v13, v30, v237
    v_perm_b32 v29, v151, v147, s72
    v_perm_b32 v30, v151, v147, s73
    v_dot2c_f32_bf16 v14, v29, v237
    v_dot2c_f32_bf16 v15, v30, v237
    buffer_load_dwordx4 v[80:83], v2, s[28:31], 0 offen offset:2048 nt
    s_waitcnt vmcnt(26)
    v_perm_b32 v29, v156, v152, s72
    v_perm_b32 v30, v156, v152, s73
    v_dot2c_f32_bf16 v8, v29, v238
    v_dot2c_f32_bf16 v9, v30, v238
    v_perm_b32 v29, v157, v153, s72
    v_perm_b32 v30, v157, v153, s73
    v_dot2c_f32_bf16 v10, v29, v238
    v_dot2c_f32_bf16 v11, v30, v238
    v_perm_b32 v29, v158, v154, s72
    v_perm_b32 v30, v158, v154, s73
    v_dot2c_f32_bf16 v12, v29, v238
    v_dot2c_f32_bf16 v13, v30, v238
    v_perm_b32 v29, v159, v155, s72
    v_perm_b32 v30, v159, v155, s73
    v_dot2c_f32_bf16 v14, v29, v238
    v_dot2c_f32_bf16 v15, v30, v238
    s_waitcnt vmcnt(24)
    v_perm_b32 v29, v164, v160, s72
    v_perm_b32 v30, v164, v160, s73
    v_dot2c_f32_bf16 v8, v29, v239
    v_dot2c_f32_bf16 v9, v30, v239
    v_perm_b32 v29, v165, v161, s72
    v_perm_b32 v30, v165, v161, s73
    v_dot2c_f32_bf16 v10, v29, v239
    v_dot2c_f32_bf16 v11, v30, v239
    v_perm_b32 v29, v166, v162, s72
    v_perm_b32 v30, v166, v162, s73
    v_dot2c_f32_bf16 v12, v29, v239
    v_dot2c_f32_bf16 v13, v30, v239
    v_perm_b32 v29, v167, v163, s72
    v_perm_b32 v30, v167, v163, s73
    v_dot2c_f32_bf16 v14, v29, v239
    v_dot2c_f32_bf16 v15, v30, v239
    buffer_load_dwordx4 v[84:87], v2, s[28:31], 0 offen offset:3072 nt
    s_waitcnt vmcnt(22)
    v_perm_b32 v29, v172, v168, s72
    v_perm_b32 v30, v172, v168, s73
    v_dot2c_f32_bf16 v8, v29, v240
    v_dot2c_f32_bf16 v9, v30, v240
    v_perm_b32 v29, v173, v169, s72
    v_perm_b32 v30, v173, v169, s73
    v_dot2c_f32_bf16 v10, v29, v240
    v_dot2c_f32_bf16 v11, v30, v240
    v_perm_b32 v29, v174, v170, s72
    v_perm_b32 v30, v174, v170, s73
    v_dot2c_f32_bf16 v12, v29, v240
    v_dot2c_f32_bf16 v13, v30, v240
    v_perm_b32 v29, v175, v171, s72
    v_perm_b32 v30, v175, v171, s73
    v_dot2c_f32_bf16 v14, v29, v240
    v_dot2c_f32_bf16 v15, v30, v240
    s_waitcnt vmcnt(20)
    v_perm_b32 v29, v180, v176, s72
    v_perm_b32 v30, v180, v176, s73
    v_dot2c_f32_bf16 v8, v29, v241
    v_dot2c_f32_bf16 v9, v30, v241
    v_perm_b32 v29, v181, v177, s72
    v_perm_b32 v30, v181, v177, s73
    v_dot2c_f32_bf16 v10, v29, v241
    v_dot2c_f32_bf16 v11, v30, v241
    v_perm_b32 v29, v182, v178, s72
    v_perm_b32 v30, v182, v178, s73
    v_dot2c_f32_bf16 v12, v29, v241
    v_dot2c_f32_bf16 v13, v30, v241
    v_perm_b32 v29, v183, v179, s72
    v_perm_b32 v30, v183, v179, s73
    v_dot2c_f32_bf16 v14, v29, v241
    v_dot2c_f32_bf16 v15, v30, v241
    buffer_load_dwordx4 v[88:91], v3, s[28:31], 0 offen offset:0 nt
    s_waitcnt vmcnt(18)
    v_perm_b32 v29, v188, v184, s72
    v_perm_b32 v30, v188, v184, s73
    v_dot2c_f32_bf16 v8, v29, v242
    v_dot2c_f32_bf16 v9, v30, v242
    v_perm_b32 v29, v189, v185, s72
    v_perm_b32 v30, v189, v185, s73
    v_dot2c_f32_bf16 v10, v29, v242
    v_dot2c_f32_bf16 v11, v30, v242
    v_perm_b32 v29, v190, v186, s72
    v_perm_b32 v30, v190, v186, s73
    v_dot2c_f32_bf16 v12, v29, v242
    v_dot2c_f32_bf16 v13, v30, v242
    v_perm_b32 v29, v191, v187, s72
    v_perm_b32 v30, v191, v187, s73
    v_dot2c_f32_bf16 v14, v29, v242
    v_dot2c_f32_bf16 v15, v30, v242
    s_waitcnt vmcnt(16)
    v_perm_b32 v29, v196, v192, s72
    v_perm_b32 v30, v196, v192, s73
    v_dot2c_f32_bf16 v8, v29, v243
    v_dot2c_f32_bf16 v9, v30, v243
    v_perm_b32 v29, v197, v193, s72
    v_perm_b32 v30, v197, v193, s73
    v_dot2c_f32_bf16 v10, v29, v243
    v_dot2c_f32_bf16 v11, v30, v243
    v_perm_b32 v29, v198, v194, s72
    v_perm_b32 v30, v198, v194, s73
    v_dot2c_f32_bf16 v12, v29, v243
    v_dot2c_f32_bf16 v13, v30, v243
    v_perm_b32 v29, v199, v195, s72
    v_perm_b32 v30, v199, v195, s73
    v_dot2c_f32_bf16 v14, v29, v243
    v_dot2c_f32_bf16 v15, v30, v243
    buffer_load_dwordx4 v[92:95], v3, s[28:31], 0 offen offset:1024 nt
    s_waitcnt vmcnt(14)
    v_perm_b32 v29, v204, v200, s72
    v_perm_b32 v30, v204, v200, s73
    v_dot2c_f32_bf16 v8, v29, v244
    v_dot2c_f32_bf16 v9, v30, v244
    v_perm_b32 v29, v205, v201, s72
    v_perm_b32 v30, v205, v201, s73
    v_dot2c_f32_bf16 v10, v29, v244
    v_dot2c_f32_bf16 v11, v30, v244
    v_perm_b32 v29, v206, v202, s72
    v_perm_b32 v30, v206, v202, s73
    v_dot2c_f32_bf16 v12, v29, v244
    v_dot2c_f32_bf16 v13, v30, v244
    v_perm_b32 v29, v207, v203, s72
    v_perm_b32 v30, v207, v203, s73
    v_dot2c_f32_bf16 v14, v29, v244
    v_dot2c_f32_bf16 v15, v30, v244
    s_waitcnt vmcnt(12)
    v_perm_b32 v29, v212, v208, s72
    v_perm_b32 v30, v212, v208, s73
    v_dot2c_f32_bf16 v8, v29, v245
    v_dot2c_f32_bf16 v9, v30, v245
    v_perm_b32 v29, v213, v209, s72
    v_perm_b32 v30, v213, v209, s73
    v_dot2c_f32_bf16 v10, v29, v245
    v_dot2c_f32_bf16 v11, v30, v245
    v_perm_b32 v29, v214, v210, s72
    v_perm_b32 v30, v214, v210, s73
    v_dot2c_f32_bf16 v12, v29, v245
    v_dot2c_f32_bf16 v13, v30, v245
    v_perm_b32 v29, v215, v211, s72
    v_perm_b32 v30, v215, v211, s73
    v_dot2c_f32_bf16 v14, v29, v245
    v_dot2c_f32_bf16 v15, v30, v245
    buffer_load_dwordx4 v[96:99], v3, s[28:31], 0 offen offset:2048 nt
    s_waitcnt vmcnt(10)
    v_perm_b32 v29, v220, v216, s72
    v_perm_b32 v30, v220, v216, s73
    v_dot2c_f32_bf16 v8, v29, v246
    v_dot2c_f32_bf16 v9, v30, v246
    v_perm_b32 v29, v221, v217, s72
    v_perm_b32 v30, v221, v217, s73
    v_dot2c_f32_bf16 v10, v29, v246
    v_dot2c_f32_bf16 v11, v30, v246
    v_perm_b32 v29, v222, v218, s72
    v_perm_b32 v30, v222, v218, s73
    v_dot2c_f32_bf16 v12, v29, v246
    v_dot2c_f32_bf16 v13, v30, v246
    v_perm_b32 v29, v223, v219, s72
    v_perm_b32 v30, v223, v219, s73
    v_dot2c_f32_bf16 v14, v29, v246
    v_dot2c_f32_bf16 v15, v30, v246
    s_waitcnt vmcnt(8)
    v_perm_b32 v29, v228, v224, s72
    v_perm_b32 v30, v228, v224, s73
    v_dot2c_f32_bf16 v8, v29, v247
    v_dot2c_f32_bf16 v9, v30, v247
    v_perm_b32 v29, v229, v225, s72
    v_perm_b32 v30, v229, v225, s73
    v_dot2c_f32_bf16 v10, v29, v247
    v_dot2c_f32_bf16 v11, v30, v247
    v_perm_b32 v29, v230, v226, s72
    v_perm_b32 v30, v230, v226, s73
    v_dot2c_f32_bf16 v12, v29, v247
    v_dot2c_f32_bf16 v13, v30, v247
    v_perm_b32 v29, v231, v227, s72
    v_perm_b32 v30, v231, v227, s73
    v_dot2c_f32_bf16 v14, v29, v247
    v_dot2c_f32_bf16 v15, v30, v247
    buffer_load_dwordx4 v[100:103], v3, s[28:31], 0 offen offset:3072 nt
    s_lshl_b32 s62, s59, 9
    v_add_u32 v31, s62, v35
    s_nop 0
    v_permlane32_swap_b32 v8, v12
    v_permlane32_swap_b32 v9, v13
    v_permlane32_swap_b32 v10, v14
    v_permlane32_swap_b32 v11, v15
    s_nop 1
    v_add_f32 v8, v8, v12
    v_add_f32 v9, v9, v13
    v_add_f32 v10, v10, v14
    v_add_f32 v11, v11, v15
    s_nop 1
    v_permlane16_swap_b32 v8, v10
    v_permlane16_swap_b32 v9, v11
    s_nop 1
    v_add_f32 v8, v8, v10
    v_add_f32 v9, v9, v11
    ds_write_b64 v31, v[8:9] offset:0
    s_waitcnt lgkmcnt(0)
    s_barrier
    v_add_u32 v2, 0x8000, v2
    v_add_u32 v3, 0x8000, v3
    buffer_load_dwordx4 v[104:107], v2, s[24:27], 0 offen offset:0 nt
    buffer_load_dwordx4 v[108:111], v2, s[24:27], 0 offen offset:1024 nt
    buffer_load_dwordx4 v[112:115], v2, s[24:27], 0 offen offset:2048 nt
    buffer_load_dwordx4 v[116:119], v2, s[24:27], 0 offen offset:3072 nt
    buffer_load_dwordx4 v[120:123], v3, s[24:27], 0 offen offset:0 nt
    buffer_load_dwordx4 v[124:127], v3, s[24:27], 0 offen offset:1024 nt
    buffer_load_dwordx4 v[128:131], v3, s[24:27], 0 offen offset:2048 nt
    buffer_load_dwordx4 v[132:135], v3, s[24:27], 0 offen offset:3072 nt
    buffer_load_dwordx4 v[136:139], v2, s[28:31], 0 offen offset:0 nt
    buffer_load_dwordx4 v[140:143], v2, s[28:31], 0 offen offset:1024 nt
    buffer_load_dwordx4 v[144:147], v2, s[28:31], 0 offen offset:2048 nt
    buffer_load_dwordx4 v[148:151], v2, s[28:31], 0 offen offset:3072 nt
    buffer_load_dwordx4 v[152:155], v3, s[28:31], 0 offen offset:0 nt
    buffer_load_dwordx4 v[156:159], v3, s[28:31], 0 offen offset:1024 nt
    buffer_load_dwordx4 v[160:163], v3, s[28:31], 0 offen offset:2048 nt
    buffer_load_dwordx4 v[164:167], v3, s[28:31], 0 offen offset:3072 nt
    ds_read_b64 v[16:17], v35 offset:0
    ds_read_b64 v[18:19], v35 offset:512
    ds_read_b64 v[20:21], v35 offset:1024
    ds_read_b64 v[22:23], v35 offset:1536
    s_waitcnt lgkmcnt(0)
    v_add_f32 v16, v16, v18
    v_add_f32 v20, v20, v22
    v_add_f32 v17, v17, v19
    v_add_f32 v21, v21, v23
    v_add_f32 v16, v16, v20
    v_add_f32 v17, v17, v21
    v_cvt_pk_bf16_f32 v4, v16, v17
    v_mov_b32 v5, v4
    s_nop 1
    v_permlane16_swap_b32 v4, v5
    s_nop 1
    v_mov_b32 v6, v4
    v_mov_b32 v7, v5
    s_nop 1
    v_permlane32_swap_b32 v4, v6
    v_permlane32_swap_b32 v5, v7
    v_mov_b32 v8, 0
    v_mov_b32 v9, 0
    v_mov_b32 v10, 0
    v_mov_b32 v11, 0
    v_mov_b32 v12, 0
    v_mov_b32 v13, 0
    v_mov_b32 v14, 0
    v_mov_b32 v15, 0
    v_mov_b32 v24, 0xff7fffff
    v_mov_b32 v25, 0
    v_dot2_f32_bf16 v16, v40, v4, 0
    v_dot2_f32_bf16 v16, v41, v5, v16
    v_dot2_f32_bf16 v16, v42, v6, v16
    v_dot2_f32_bf16 v16, v43, v7, v16
    v_dot2_f32_bf16 v17, v44, v4, 0
    v_dot2_f32_bf16 v17, v45, v5, v17
    v_dot2_f32_bf16 v17, v46, v6, v17
    v_dot2_f32_bf16 v17, v47, v7, v17
    v_dot2_f32_bf16 v18, v48, v4, 0
    v_dot2_f32_bf16 v18, v49, v5, v18
    v_dot2_f32_bf16 v18, v50, v6, v18
    v_dot2_f32_bf16 v18, v51, v7, v18
    v_dot2_f32_bf16 v19, v52, v4, 0
    v_dot2_f32_bf16 v19, v53, v5, v19
    v_dot2_f32_bf16 v19, v54, v6, v19
    v_dot2_f32_bf16 v19, v55, v7, v19
    v_dot2_f32_bf16 v20, v56, v4, 0
    v_dot2_f32_bf16 v20, v57, v5, v20
    v_dot2_f32_bf16 v20, v58, v6, v20
    v_dot2_f32_bf16 v20, v59, v7, v20
    v_dot2_f32_bf16 v21, v60, v4, 0
    v_dot2_f32_bf16 v21, v61, v5, v21
    v_dot2_f32_bf16 v21, v62, v6, v21
    v_dot2_f32_bf16 v21, v63, v7, v21
    v_dot2_f32_bf16 v22, v64, v4, 0
    v_dot2_f32_bf16 v22, v65, v5, v22
    v_dot2_f32_bf16 v22, v66, v6, v22
    v_dot2_f32_bf16 v22, v67, v7, v22
    s_waitcnt vmcnt(24)
    v_dot2_f32_bf16 v23, v68, v4, 0
    v_dot2_f32_bf16 v23, v69, v5, v23
    v_dot2_f32_bf16 v23, v70, v6, v23
    v_dot2_f32_bf16 v23, v71, v7, v23
    s_nop 2
    v_add_f32_dpp v16, v16, v16 row_ror:8 row_mask:0xf bank_mask:0x3
    v_add_f32_dpp v17, v17, v17 row_ror:8 row_mask:0xf bank_mask:0x3
    v_add_f32_dpp v18, v18, v18 row_ror:8 row_mask:0xf bank_mask:0x3
    v_add_f32_dpp v19, v19, v19 row_ror:8 row_mask:0xf bank_mask:0x3
    v_add_f32_dpp v16, v20, v20 row_ror:8 row_mask:0xf bank_mask:0xc
    v_add_f32_dpp v17, v21, v21 row_ror:8 row_mask:0xf bank_mask:0xc
    v_add_f32_dpp v18, v22, v22 row_ror:8 row_mask:0xf bank_mask:0xc
    v_add_f32_dpp v19, v23, v23 row_ror:8 row_mask:0xf bank_mask:0xc
    v_add_f32_dpp v16, v16, v16 row_half_mirror row_mask:0xf bank_mask:0x5
    v_add_f32_dpp v17, v17, v17 row_half_mirror row_mask:0xf bank_mask:0x5
    v_add_f32_dpp v16, v18, v18 row_half_mirror row_mask:0xf bank_mask:0xa
    v_add_f32_dpp v17, v19, v19 row_half_mirror row_mask:0xf bank_mask:0xa
    s_nop 0
    v_add_f32_dpp v16, v16, v16 quad_perm:[1,0,3,2] row_mask:0xf bank_mask:0xf
    v_add_f32_dpp v17, v17, v17 quad_perm:[1,0,3,2] row_mask:0xf bank_mask:0xf
    s_nop 0
    v_cndmask_b32 v29, v16, v17, s[76:77]
    s_nop 1
    v_add_f32_dpp v29, v29, v29 quad_perm:[2,3,0,1] row_mask:0xf bank_mask:0xf
    v_mul_f32 v29, s74, v29
    s_nop 1
    v_max_f32_dpp v30, v29, v29 quad_perm:[1,0,3,2] row_mask:0xf bank_mask:0xf
    s_nop 1
    v_max_f32_dpp v30, v30, v30 row_ror:4 row_mask:0xf bank_mask:0xf
    s_nop 1
    v_max_f32_dpp v30, v30, v30 row_ror:8 row_mask:0xf bank_mask:0xf
    v_max_f32 v30, v30, v24
    v_sub_f32 v28, v24, v30
    v_sub_f32 v29, v29, v30
    v_exp_f32 v28, v28
    v_exp_f32 v29, v29
    v_mov_b32 v24, v30
    v_cvt_pk_bf16_f32 v26, v29, 0
    v_cvt_pk_bf16_f32 v27, 0, v29
    v_fma_f32 v25, v25, v28, v29
    v_mul_f32 v8, v28, v8
    v_mul_f32 v9, v28, v9
    v_mul_f32 v10, v28, v10
    v_mul_f32 v11, v28, v11
    v_mul_f32 v12, v28, v12
    v_mul_f32 v13, v28, v13
    v_mul_f32 v14, v28, v14
    v_mul_f32 v15, v28, v15
    s_waitcnt vmcnt(23)
    v_dot2c_f32_bf16_dpp v8, v26, v72 row_newbcast:0 row_mask:0xf bank_mask:0xf
    v_dot2c_f32_bf16_dpp v9, v27, v72 row_newbcast:0 row_mask:0xf bank_mask:0xf
    v_dot2c_f32_bf16_dpp v10, v26, v73 row_newbcast:0 row_mask:0xf bank_mask:0xf
    v_dot2c_f32_bf16_dpp v11, v27, v73 row_newbcast:0 row_mask:0xf bank_mask:0xf
    v_dot2c_f32_bf16_dpp v12, v26, v74 row_newbcast:0 row_mask:0xf bank_mask:0xf
    v_dot2c_f32_bf16_dpp v13, v27, v74 row_newbcast:0 row_mask:0xf bank_mask:0xf
    v_dot2c_f32_bf16_dpp v14, v26, v75 row_newbcast:0 row_mask:0xf bank_mask:0xf
    v_dot2c_f32_bf16_dpp v15, v27, v75 row_newbcast:0 row_mask:0xf bank_mask:0xf
    s_waitcnt vmcnt(22)
    v_dot2c_f32_bf16_dpp v8, v26, v76 row_newbcast:1 row_mask:0xf bank_mask:0xf
    v_dot2c_f32_bf16_dpp v9, v27, v76 row_newbcast:1 row_mask:0xf bank_mask:0xf
    v_dot2c_f32_bf16_dpp v10, v26, v77 row_newbcast:1 row_mask:0xf bank_mask:0xf
    v_dot2c_f32_bf16_dpp v11, v27, v77 row_newbcast:1 row_mask:0xf bank_mask:0xf
    v_dot2c_f32_bf16_dpp v12, v26, v78 row_newbcast:1 row_mask:0xf bank_mask:0xf
    v_dot2c_f32_bf16_dpp v13, v27, v78 row_newbcast:1 row_mask:0xf bank_mask:0xf
    v_dot2c_f32_bf16_dpp v14, v26, v79 row_newbcast:1 row_mask:0xf bank_mask:0xf
    v_dot2c_f32_bf16_dpp v15, v27, v79 row_newbcast:1 row_mask:0xf bank_mask:0xf
    s_waitcnt vmcnt(21)
    v_dot2c_f32_bf16_dpp v8, v26, v80 row_newbcast:4 row_mask:0xf bank_mask:0xf
    v_dot2c_f32_bf16_dpp v9, v27, v80 row_newbcast:4 row_mask:0xf bank_mask:0xf
    v_dot2c_f32_bf16_dpp v10, v26, v81 row_newbcast:4 row_mask:0xf bank_mask:0xf
    v_dot2c_f32_bf16_dpp v11, v27, v81 row_newbcast:4 row_mask:0xf bank_mask:0xf
    v_dot2c_f32_bf16_dpp v12, v26, v82 row_newbcast:4 row_mask:0xf bank_mask:0xf
    v_dot2c_f32_bf16_dpp v13, v27, v82 row_newbcast:4 row_mask:0xf bank_mask:0xf
    v_dot2c_f32_bf16_dpp v14, v26, v83 row_newbcast:4 row_mask:0xf bank_mask:0xf
    v_dot2c_f32_bf16_dpp v15, v27, v83 row_newbcast:4 row_mask:0xf bank_mask:0xf
    s_waitcnt vmcnt(20)
    v_dot2c_f32_bf16_dpp v8, v26, v84 row_newbcast:5 row_mask:0xf bank_mask:0xf
    v_dot2c_f32_bf16_dpp v9, v27, v84 row_newbcast:5 row_mask:0xf bank_mask:0xf
    v_dot2c_f32_bf16_dpp v10, v26, v85 row_newbcast:5 row_mask:0xf bank_mask:0xf
    v_dot2c_f32_bf16_dpp v11, v27, v85 row_newbcast:5 row_mask:0xf bank_mask:0xf
    v_dot2c_f32_bf16_dpp v12, v26, v86 row_newbcast:5 row_mask:0xf bank_mask:0xf
    v_dot2c_f32_bf16_dpp v13, v27, v86 row_newbcast:5 row_mask:0xf bank_mask:0xf
    v_dot2c_f32_bf16_dpp v14, v26, v87 row_newbcast:5 row_mask:0xf bank_mask:0xf
    v_dot2c_f32_bf16_dpp v15, v27, v87 row_newbcast:5 row_mask:0xf bank_mask:0xf
    s_waitcnt vmcnt(19)
    v_dot2c_f32_bf16_dpp v8, v26, v88 row_newbcast:8 row_mask:0xf bank_mask:0xf
    v_dot2c_f32_bf16_dpp v9, v27, v88 row_newbcast:8 row_mask:0xf bank_mask:0xf
    v_dot2c_f32_bf16_dpp v10, v26, v89 row_newbcast:8 row_mask:0xf bank_mask:0xf
    v_dot2c_f32_bf16_dpp v11, v27, v89 row_newbcast:8 row_mask:0xf bank_mask:0xf
    v_dot2c_f32_bf16_dpp v12, v26, v90 row_newbcast:8 row_mask:0xf bank_mask:0xf
    v_dot2c_f32_bf16_dpp v13, v27, v90 row_newbcast:8 row_mask:0xf bank_mask:0xf
    v_dot2c_f32_bf16_dpp v14, v26, v91 row_newbcast:8 row_mask:0xf bank_mask:0xf
    v_dot2c_f32_bf16_dpp v15, v27, v91 row_newbcast:8 row_mask:0xf bank_mask:0xf
    s_waitcnt vmcnt(18)
    v_dot2c_f32_bf16_dpp v8, v26, v92 row_newbcast:9 row_mask:0xf bank_mask:0xf
    v_dot2c_f32_bf16_dpp v9, v27, v92 row_newbcast:9 row_mask:0xf bank_mask:0xf
    v_dot2c_f32_bf16_dpp v10, v26, v93 row_newbcast:9 row_mask:0xf bank_mask:0xf
    v_dot2c_f32_bf16_dpp v11, v27, v93 row_newbcast:9 row_mask:0xf bank_mask:0xf
    v_dot2c_f32_bf16_dpp v12, v26, v94 row_newbcast:9 row_mask:0xf bank_mask:0xf
    v_dot2c_f32_bf16_dpp v13, v27, v94 row_newbcast:9 row_mask:0xf bank_mask:0xf
    v_dot2c_f32_bf16_dpp v14, v26, v95 row_newbcast:9 row_mask:0xf bank_mask:0xf
    v_dot2c_f32_bf16_dpp v15, v27, v95 row_newbcast:9 row_mask:0xf bank_mask:0xf
    s_waitcnt vmcnt(17)
    v_dot2c_f32_bf16_dpp v8, v26, v96 row_newbcast:12 row_mask:0xf bank_mask:0xf
    v_dot2c_f32_bf16_dpp v9, v27, v96 row_newbcast:12 row_mask:0xf bank_mask:0xf
    v_dot2c_f32_bf16_dpp v10, v26, v97 row_newbcast:12 row_mask:0xf bank_mask:0xf
    v_dot2c_f32_bf16_dpp v11, v27, v97 row_newbcast:12 row_mask:0xf bank_mask:0xf
    v_dot2c_f32_bf16_dpp v12, v26, v98 row_newbcast:12 row_mask:0xf bank_mask:0xf
    v_dot2c_f32_bf16_dpp v13, v27, v98 row_newbcast:12 row_mask:0xf bank_mask:0xf
    v_dot2c_f32_bf16_dpp v14, v26, v99 row_newbcast:12 row_mask:0xf bank_mask:0xf
    v_dot2c_f32_bf16_dpp v15, v27, v99 row_newbcast:12 row_mask:0xf bank_mask:0xf
    s_waitcnt vmcnt(16)
    v_dot2c_f32_bf16_dpp v8, v26, v100 row_newbcast:13 row_mask:0xf bank_mask:0xf
    v_dot2c_f32_bf16_dpp v9, v27, v100 row_newbcast:13 row_mask:0xf bank_mask:0xf
    v_dot2c_f32_bf16_dpp v10, v26, v101 row_newbcast:13 row_mask:0xf bank_mask:0xf
    v_dot2c_f32_bf16_dpp v11, v27, v101 row_newbcast:13 row_mask:0xf bank_mask:0xf
    v_dot2c_f32_bf16_dpp v12, v26, v102 row_newbcast:13 row_mask:0xf bank_mask:0xf
    v_dot2c_f32_bf16_dpp v13, v27, v102 row_newbcast:13 row_mask:0xf bank_mask:0xf
    v_dot2c_f32_bf16_dpp v14, v26, v103 row_newbcast:13 row_mask:0xf bank_mask:0xf
    v_dot2c_f32_bf16_dpp v15, v27, v103 row_newbcast:13 row_mask:0xf bank_mask:0xf
    s_waitcnt vmcnt(15)
    v_dot2_f32_bf16 v16, v104, v4, 0
    v_dot2_f32_bf16 v16, v105, v5, v16
    v_dot2_f32_bf16 v16, v106, v6, v16
    v_dot2_f32_bf16 v16, v107, v7, v16
    s_waitcnt vmcnt(14)
    v_dot2_f32_bf16 v17, v108, v4, 0
    v_dot2_f32_bf16 v17, v109, v5, v17
    v_dot2_f32_bf16 v17, v110, v6, v17
    v_dot2_f32_bf16 v17, v111, v7, v17
    s_waitcnt vmcnt(13)
    v_dot2_f32_bf16 v18, v112, v4, 0
    v_dot2_f32_bf16 v18, v113, v5, v18
    v_dot2_f32_bf16 v18, v114, v6, v18
    v_dot2_f32_bf16 v18, v115, v7, v18
    s_waitcnt vmcnt(12)
    v_dot2_f32_bf16 v19, v116, v4, 0
    v_dot2_f32_bf16 v19, v117, v5, v19
    v_dot2_f32_bf16 v19, v118, v6, v19
    v_dot2_f32_bf16 v19, v119, v7, v19
    s_waitcnt vmcnt(11)
    v_dot2_f32_bf16 v20, v120, v4, 0
    v_dot2_f32_bf16 v20, v121, v5, v20
    v_dot2_f32_bf16 v20, v122, v6, v20
    v_dot2_f32_bf16 v20, v123, v7, v20
    s_waitcnt vmcnt(10)
    v_dot2_f32_bf16 v21, v124, v4, 0
    v_dot2_f32_bf16 v21, v125, v5, v21
    v_dot2_f32_bf16 v21, v126, v6, v21
    v_dot2_f32_bf16 v21, v127, v7, v21
    s_waitcnt vmcnt(9)
    v_dot2_f32_bf16 v22, v128, v4, 0
    v_dot2_f32_bf16 v22, v129, v5, v22
    v_dot2_f32_bf16 v22, v130, v6, v22
    v_dot2_f32_bf16 v22, v131, v7, v22
    s_waitcnt vmcnt(8)
    v_dot2_f32_bf16 v23, v132, v4, 0
    v_dot2_f32_bf16 v23, v133, v5, v23
    v_dot2_f32_bf16 v23, v134, v6, v23
    v_dot2_f32_bf16 v23, v135, v7, v23
    s_nop 2
    v_add_f32_dpp v16, v16, v16 row_ror:8 row_mask:0xf bank_mask:0x3
    v_add_f32_dpp v17, v17, v17 row_ror:8 row_mask:0xf bank_mask:0x3
    v_add_f32_dpp v18, v18, v18 row_ror:8 row_mask:0xf bank_mask:0x3
    v_add_f32_dpp v19, v19, v19 row_ror:8 row_mask:0xf bank_mask:0x3
    v_add_f32_dpp v16, v20, v20 row_ror:8 row_mask:0xf bank_mask:0xc
    v_add_f32_dpp v17, v21, v21 row_ror:8 row_mask:0xf bank_mask:0xc
    v_add_f32_dpp v18, v22, v22 row_ror:8 row_mask:0xf bank_mask:0xc
    v_add_f32_dpp v19, v23, v23 row_ror:8 row_mask:0xf bank_mask:0xc
    v_add_f32_dpp v16, v16, v16 row_half_mirror row_mask:0xf bank_mask:0x5
    v_add_f32_dpp v17, v17, v17 row_half_mirror row_mask:0xf bank_mask:0x5
    v_add_f32_dpp v16, v18, v18 row_half_mirror row_mask:0xf bank_mask:0xa
    v_add_f32_dpp v17, v19, v19 row_half_mirror row_mask:0xf bank_mask:0xa
    s_nop 0
    v_add_f32_dpp v16, v16, v16 quad_perm:[1,0,3,2] row_mask:0xf bank_mask:0xf
    v_add_f32_dpp v17, v17, v17 quad_perm:[1,0,3,2] row_mask:0xf bank_mask:0xf
    s_nop 0
    v_cndmask_b32 v29, v16, v17, s[76:77]
    s_nop 1
    v_add_f32_dpp v29, v29, v29 quad_perm:[2,3,0,1] row_mask:0xf bank_mask:0xf
    v_mul_f32 v29, s74, v29
    s_nop 1
    v_max_f32_dpp v30, v29, v29 quad_perm:[1,0,3,2] row_mask:0xf bank_mask:0xf
    s_nop 1
    v_max_f32_dpp v30, v30, v30 row_ror:4 row_mask:0xf bank_mask:0xf
    s_nop 1
    v_max_f32_dpp v30, v30, v30 row_ror:8 row_mask:0xf bank_mask:0xf
    v_max_f32 v30, v30, v24
    v_sub_f32 v28, v24, v30
    v_sub_f32 v29, v29, v30
    v_exp_f32 v28, v28
    v_exp_f32 v29, v29
    v_mov_b32 v24, v30
    v_cvt_pk_bf16_f32 v26, v29, 0
    v_cvt_pk_bf16_f32 v27, 0, v29
    v_fma_f32 v25, v25, v28, v29
    v_mul_f32 v8, v28, v8
    v_mul_f32 v9, v28, v9
    v_mul_f32 v10, v28, v10
    v_mul_f32 v11, v28, v11
    v_mul_f32 v12, v28, v12
    v_mul_f32 v13, v28, v13
    v_mul_f32 v14, v28, v14
    v_mul_f32 v15, v28, v15
    s_waitcnt vmcnt(7)
    v_dot2c_f32_bf16_dpp v8, v26, v136 row_newbcast:0 row_mask:0xf bank_mask:0xf
    v_dot2c_f32_bf16_dpp v9, v27, v136 row_newbcast:0 row_mask:0xf bank_mask:0xf
    v_dot2c_f32_bf16_dpp v10, v26, v137 row_newbcast:0 row_mask:0xf bank_mask:0xf
    v_dot2c_f32_bf16_dpp v11, v27, v137 row_newbcast:0 row_mask:0xf bank_mask:0xf
    v_dot2c_f32_bf16_dpp v12, v26, v138 row_newbcast:0 row_mask:0xf bank_mask:0xf
    v_dot2c_f32_bf16_dpp v13, v27, v138 row_newbcast:0 row_mask:0xf bank_mask:0xf
    v_dot2c_f32_bf16_dpp v14, v26, v139 row_newbcast:0 row_mask:0xf bank_mask:0xf
    v_dot2c_f32_bf16_dpp v15, v27, v139 row_newbcast:0 row_mask:0xf bank_mask:0xf
    s_waitcnt vmcnt(6)
    v_dot2c_f32_bf16_dpp v8, v26, v140 row_newbcast:1 row_mask:0xf bank_mask:0xf
    v_dot2c_f32_bf16_dpp v9, v27, v140 row_newbcast:1 row_mask:0xf bank_mask:0xf
    v_dot2c_f32_bf16_dpp v10, v26, v141 row_newbcast:1 row_mask:0xf bank_mask:0xf
    v_dot2c_f32_bf16_dpp v11, v27, v141 row_newbcast:1 row_mask:0xf bank_mask:0xf
    v_dot2c_f32_bf16_dpp v12, v26, v142 row_newbcast:1 row_mask:0xf bank_mask:0xf
    v_dot2c_f32_bf16_dpp v13, v27, v142 row_newbcast:1 row_mask:0xf bank_mask:0xf
    v_dot2c_f32_bf16_dpp v14, v26, v143 row_newbcast:1 row_mask:0xf bank_mask:0xf
    v_dot2c_f32_bf16_dpp v15, v27, v143 row_newbcast:1 row_mask:0xf bank_mask:0xf
    s_waitcnt vmcnt(5)
    v_dot2c_f32_bf16_dpp v8, v26, v144 row_newbcast:4 row_mask:0xf bank_mask:0xf
    v_dot2c_f32_bf16_dpp v9, v27, v144 row_newbcast:4 row_mask:0xf bank_mask:0xf
    v_dot2c_f32_bf16_dpp v10, v26, v145 row_newbcast:4 row_mask:0xf bank_mask:0xf
    v_dot2c_f32_bf16_dpp v11, v27, v145 row_newbcast:4 row_mask:0xf bank_mask:0xf
    v_dot2c_f32_bf16_dpp v12, v26, v146 row_newbcast:4 row_mask:0xf bank_mask:0xf
    v_dot2c_f32_bf16_dpp v13, v27, v146 row_newbcast:4 row_mask:0xf bank_mask:0xf
    v_dot2c_f32_bf16_dpp v14, v26, v147 row_newbcast:4 row_mask:0xf bank_mask:0xf
    v_dot2c_f32_bf16_dpp v15, v27, v147 row_newbcast:4 row_mask:0xf bank_mask:0xf
    s_waitcnt vmcnt(4)
    v_add_u32 v2, 0x8000, v2
    v_add_u32 v3, 0x8000, v3
    buffer_load_dwordx4 v[40:43], v2, s[24:27], 0 offen offset:0 nt
    v_dot2c_f32_bf16_dpp v8, v26, v148 row_newbcast:5 row_mask:0xf bank_mask:0xf
    v_dot2c_f32_bf16_dpp v9, v27, v148 row_newbcast:5 row_mask:0xf bank_mask:0xf
    v_dot2c_f32_bf16_dpp v10, v26, v149 row_newbcast:5 row_mask:0xf bank_mask:0xf
    v_dot2c_f32_bf16_dpp v11, v27, v149 row_newbcast:5 row_mask:0xf bank_mask:0xf
    v_dot2c_f32_bf16_dpp v12, v26, v150 row_newbcast:5 row_mask:0xf bank_mask:0xf
    v_dot2c_f32_bf16_dpp v13, v27, v150 row_newbcast:5 row_mask:0xf bank_mask:0xf
    v_dot2c_f32_bf16_dpp v14, v26, v151 row_newbcast:5 row_mask:0xf bank_mask:0xf
    v_dot2c_f32_bf16_dpp v15, v27, v151 row_newbcast:5 row_mask:0xf bank_mask:0xf
    s_waitcnt vmcnt(4)
    buffer_load_dwordx4 v[44:47], v2, s[24:27], 0 offen offset:1024 nt
    v_dot2c_f32_bf16_dpp v8, v26, v152 row_newbcast:8 row_mask:0xf bank_mask:0xf
    v_dot2c_f32_bf16_dpp v9, v27, v152 row_newbcast:8 row_mask:0xf bank_mask:0xf
    v_dot2c_f32_bf16_dpp v10, v26, v153 row_newbcast:8 row_mask:0xf bank_mask:0xf
    v_dot2c_f32_bf16_dpp v11, v27, v153 row_newbcast:8 row_mask:0xf bank_mask:0xf
    v_dot2c_f32_bf16_dpp v12, v26, v154 row_newbcast:8 row_mask:0xf bank_mask:0xf
    v_dot2c_f32_bf16_dpp v13, v27, v154 row_newbcast:8 row_mask:0xf bank_mask:0xf
    v_dot2c_f32_bf16_dpp v14, v26, v155 row_newbcast:8 row_mask:0xf bank_mask:0xf
    v_dot2c_f32_bf16_dpp v15, v27, v155 row_newbcast:8 row_mask:0xf bank_mask:0xf
    s_waitcnt vmcnt(4)
    buffer_load_dwordx4 v[48:51], v2, s[24:27], 0 offen offset:2048 nt
    v_dot2c_f32_bf16_dpp v8, v26, v156 row_newbcast:9 row_mask:0xf bank_mask:0xf
    v_dot2c_f32_bf16_dpp v9, v27, v156 row_newbcast:9 row_mask:0xf bank_mask:0xf
    v_dot2c_f32_bf16_dpp v10, v26, v157 row_newbcast:9 row_mask:0xf bank_mask:0xf
    v_dot2c_f32_bf16_dpp v11, v27, v157 row_newbcast:9 row_mask:0xf bank_mask:0xf
    v_dot2c_f32_bf16_dpp v12, v26, v158 row_newbcast:9 row_mask:0xf bank_mask:0xf
    v_dot2c_f32_bf16_dpp v13, v27, v158 row_newbcast:9 row_mask:0xf bank_mask:0xf
    v_dot2c_f32_bf16_dpp v14, v26, v159 row_newbcast:9 row_mask:0xf bank_mask:0xf
    v_dot2c_f32_bf16_dpp v15, v27, v159 row_newbcast:9 row_mask:0xf bank_mask:0xf
    s_waitcnt vmcnt(4)
    buffer_load_dwordx4 v[52:55], v2, s[24:27], 0 offen offset:3072 nt
    v_dot2c_f32_bf16_dpp v8, v26, v160 row_newbcast:12 row_mask:0xf bank_mask:0xf
    v_dot2c_f32_bf16_dpp v9, v27, v160 row_newbcast:12 row_mask:0xf bank_mask:0xf
    v_dot2c_f32_bf16_dpp v10, v26, v161 row_newbcast:12 row_mask:0xf bank_mask:0xf
    v_dot2c_f32_bf16_dpp v11, v27, v161 row_newbcast:12 row_mask:0xf bank_mask:0xf
    v_dot2c_f32_bf16_dpp v12, v26, v162 row_newbcast:12 row_mask:0xf bank_mask:0xf
    v_dot2c_f32_bf16_dpp v13, v27, v162 row_newbcast:12 row_mask:0xf bank_mask:0xf
    v_dot2c_f32_bf16_dpp v14, v26, v163 row_newbcast:12 row_mask:0xf bank_mask:0xf
    v_dot2c_f32_bf16_dpp v15, v27, v163 row_newbcast:12 row_mask:0xf bank_mask:0xf
    s_waitcnt vmcnt(4)
    buffer_load_dwordx4 v[56:59], v3, s[24:27], 0 offen offset:0 nt
    buffer_load_dwordx4 v[60:63], v3, s[24:27], 0 offen offset:1024 nt
    v_dot2c_f32_bf16_dpp v8, v26, v164 row_newbcast:13 row_mask:0xf bank_mask:0xf
    v_dot2c_f32_bf16_dpp v9, v27, v164 row_newbcast:13 row_mask:0xf bank_mask:0xf
    v_dot2c_f32_bf16_dpp v10, v26, v165 row_newbcast:13 row_mask:0xf bank_mask:0xf
    v_dot2c_f32_bf16_dpp v11, v27, v165 row_newbcast:13 row_mask:0xf bank_mask:0xf
    v_dot2c_f32_bf16_dpp v12, v26, v166 row_newbcast:13 row_mask:0xf bank_mask:0xf
    v_dot2c_f32_bf16_dpp v13, v27, v166 row_newbcast:13 row_mask:0xf bank_mask:0xf
    v_dot2c_f32_bf16_dpp v14, v26, v167 row_newbcast:13 row_mask:0xf bank_mask:0xf
    v_dot2c_f32_bf16_dpp v15, v27, v167 row_newbcast:13 row_mask:0xf bank_mask:0xf
    s_waitcnt vmcnt(5)
    s_mov_b32 s64, 0
    buffer_load_dwordx4 v[104:107], v36, s[36:39], s64 offen
    s_mov_b32 s64, 1024
    buffer_load_dwordx4 v[108:111], v36, s[36:39], s64 offen
    v_dot2_f32_bf16 v16, v40, v4, 0
    v_dot2_f32_bf16 v16, v41, v5, v16
    v_dot2_f32_bf16 v16, v42, v6, v16
    v_dot2_f32_bf16 v16, v43, v7, v16
    s_waitcnt vmcnt(6)
    buffer_load_dwordx4 v[64:67], v3, s[24:27], 0 offen offset:2048 nt
    v_dot2_f32_bf16 v17, v44, v4, 0
    v_dot2_f32_bf16 v17, v45, v5, v17
    v_dot2_f32_bf16 v17, v46, v6, v17
    v_dot2_f32_bf16 v17, v47, v7, v17
    s_waitcnt vmcnt(6)
    buffer_load_dwordx4 v[68:71], v3, s[24:27], 0 offen offset:3072 nt
    v_dot2_f32_bf16 v18, v48, v4, 0
    v_dot2_f32_bf16 v18, v49, v5, v18
    v_dot2_f32_bf16 v18, v50, v6, v18
    v_dot2_f32_bf16 v18, v51, v7, v18
    s_waitcnt vmcnt(6)
    buffer_load_dwordx4 v[72:75], v2, s[28:31], 0 offen offset:0 nt
    v_dot2_f32_bf16 v19, v52, v4, 0
    v_dot2_f32_bf16 v19, v53, v5, v19
    v_dot2_f32_bf16 v19, v54, v6, v19
    v_dot2_f32_bf16 v19, v55, v7, v19
    s_waitcnt vmcnt(6)
    buffer_load_dwordx4 v[76:79], v2, s[28:31], 0 offen offset:1024 nt
    v_dot2_f32_bf16 v20, v56, v4, 0
    v_dot2_f32_bf16 v20, v57, v5, v20
    v_dot2_f32_bf16 v20, v58, v6, v20
    v_dot2_f32_bf16 v20, v59, v7, v20
    s_waitcnt vmcnt(6)
    buffer_load_dwordx4 v[80:83], v2, s[28:31], 0 offen offset:2048 nt
    v_dot2_f32_bf16 v21, v60, v4, 0
    v_dot2_f32_bf16 v21, v61, v5, v21
    v_dot2_f32_bf16 v21, v62, v6, v21
    v_dot2_f32_bf16 v21, v63, v7, v21
    s_waitcnt vmcnt(4)
    buffer_load_dwordx4 v[84:87], v2, s[28:31], 0 offen offset:3072 nt
    v_dot2_f32_bf16 v22, v64, v4, 0
    v_dot2_f32_bf16 v22, v65, v5, v22
    v_dot2_f32_bf16 v22, v66, v6, v22
    v_dot2_f32_bf16 v22, v67, v7, v22
    s_waitcnt vmcnt(4)
    buffer_load_dwordx4 v[88:91], v3, s[28:31], 0 offen offset:0 nt
    buffer_load_dwordx4 v[92:95], v3, s[28:31], 0 offen offset:1024 nt
    v_dot2_f32_bf16 v23, v68, v4, 0
    v_dot2_f32_bf16 v23, v69, v5, v23
    v_dot2_f32_bf16 v23, v70, v6, v23
    v_dot2_f32_bf16 v23, v71, v7, v23
    s_nop 2
    v_add_f32_dpp v16, v16, v16 row_ror:8 row_mask:0xf bank_mask:0x3
    v_add_f32_dpp v17, v17, v17 row_ror:8 row_mask:0xf bank_mask:0x3
    v_add_f32_dpp v18, v18, v18 row_ror:8 row_mask:0xf bank_mask:0x3
    v_add_f32_dpp v19, v19, v19 row_ror:8 row_mask:0xf bank_mask:0x3
    v_add_f32_dpp v16, v20, v20 row_ror:8 row_mask:0xf bank_mask:0xc
    v_add_f32_dpp v17, v21, v21 row_ror:8 row_mask:0xf bank_mask:0xc
    v_add_f32_dpp v18, v22, v22 row_ror:8 row_mask:0xf bank_mask:0xc
    v_add_f32_dpp v19, v23, v23 row_ror:8 row_mask:0xf bank_mask:0xc
    v_add_f32_dpp v16, v16, v16 row_half_mirror row_mask:0xf bank_mask:0x5
    v_add_f32_dpp v17, v17, v17 row_half_mirror row_mask:0xf bank_mask:0x5
    v_add_f32_dpp v16, v18, v18 row_half_mirror row_mask:0xf bank_mask:0xa
    v_add_f32_dpp v17, v19, v19 row_half_mirror row_mask:0xf bank_mask:0xa
    s_nop 0
    v_add_f32_dpp v16, v16, v16 quad_perm:[1,0,3,2] row_mask:0xf bank_mask:0xf
    v_add_f32_dpp v17, v17, v17 quad_perm:[1,0,3,2] row_mask:0xf bank_mask:0xf
    s_nop 0
    v_cndmask_b32 v29, v16, v17, s[76:77]
    s_nop 1
    v_add_f32_dpp v29, v29, v29 quad_perm:[2,3,0,1] row_mask:0xf bank_mask:0xf
    v_mul_f32 v29, s74, v29
    s_nop 1
    v_max_f32_dpp v30, v29, v29 quad_perm:[1,0,3,2] row_mask:0xf bank_mask:0xf
    s_nop 1
    v_max_f32_dpp v30, v30, v30 row_ror:4 row_mask:0xf bank_mask:0xf
    s_nop 1
    v_max_f32_dpp v30, v30, v30 row_ror:8 row_mask:0xf bank_mask:0xf
    v_max_f32 v30, v30, v24
    v_sub_f32 v28, v24, v30
    v_sub_f32 v29, v29, v30
    v_exp_f32 v28, v28
    v_exp_f32 v29, v29
    v_mov_b32 v24, v30
    v_cvt_pk_bf16_f32 v26, v29, 0
    v_cvt_pk_bf16_f32 v27, 0, v29
    v_fma_f32 v25, v25, v28, v29
    v_mul_f32 v8, v28, v8
    v_mul_f32 v9, v28, v9
    v_mul_f32 v10, v28, v10
    v_mul_f32 v11, v28, v11
    v_mul_f32 v12, v28, v12
    v_mul_f32 v13, v28, v13
    v_mul_f32 v14, v28, v14
    v_mul_f32 v15, v28, v15
    s_waitcnt vmcnt(5)
    v_dot2c_f32_bf16_dpp v8, v26, v72 row_newbcast:0 row_mask:0xf bank_mask:0xf
    v_dot2c_f32_bf16_dpp v9, v27, v72 row_newbcast:0 row_mask:0xf bank_mask:0xf
    v_dot2c_f32_bf16_dpp v10, v26, v73 row_newbcast:0 row_mask:0xf bank_mask:0xf
    v_dot2c_f32_bf16_dpp v11, v27, v73 row_newbcast:0 row_mask:0xf bank_mask:0xf
    v_dot2c_f32_bf16_dpp v12, v26, v74 row_newbcast:0 row_mask:0xf bank_mask:0xf
    v_dot2c_f32_bf16_dpp v13, v27, v74 row_newbcast:0 row_mask:0xf bank_mask:0xf
    v_dot2c_f32_bf16_dpp v14, v26, v75 row_newbcast:0 row_mask:0xf bank_mask:0xf
    v_dot2c_f32_bf16_dpp v15, v27, v75 row_newbcast:0 row_mask:0xf bank_mask:0xf
    s_waitcnt vmcnt(4)
    buffer_load_dwordx4 v[96:99], v3, s[28:31], 0 offen offset:2048 nt
    v_dot2c_f32_bf16_dpp v8, v26, v76 row_newbcast:1 row_mask:0xf bank_mask:0xf
    v_dot2c_f32_bf16_dpp v9, v27, v76 row_newbcast:1 row_mask:0xf bank_mask:0xf
    v_dot2c_f32_bf16_dpp v10, v26, v77 row_newbcast:1 row_mask:0xf bank_mask:0xf
    v_dot2c_f32_bf16_dpp v11, v27, v77 row_newbcast:1 row_mask:0xf bank_mask:0xf
    v_dot2c_f32_bf16_dpp v12, v26, v78 row_newbcast:1 row_mask:0xf bank_mask:0xf
    v_dot2c_f32_bf16_dpp v13, v27, v78 row_newbcast:1 row_mask:0xf bank_mask:0xf
    v_dot2c_f32_bf16_dpp v14, v26, v79 row_newbcast:1 row_mask:0xf bank_mask:0xf
    v_dot2c_f32_bf16_dpp v15, v27, v79 row_newbcast:1 row_mask:0xf bank_mask:0xf
    s_waitcnt vmcnt(4)
    buffer_load_dwordx4 v[100:103], v3, s[28:31], 0 offen offset:3072 nt
    v_dot2c_f32_bf16_dpp v8, v26, v80 row_newbcast:4 row_mask:0xf bank_mask:0xf
    v_dot2c_f32_bf16_dpp v9, v27, v80 row_newbcast:4 row_mask:0xf bank_mask:0xf
    v_dot2c_f32_bf16_dpp v10, v26, v81 row_newbcast:4 row_mask:0xf bank_mask:0xf
    v_dot2c_f32_bf16_dpp v11, v27, v81 row_newbcast:4 row_mask:0xf bank_mask:0xf
    v_dot2c_f32_bf16_dpp v12, v26, v82 row_newbcast:4 row_mask:0xf bank_mask:0xf
    v_dot2c_f32_bf16_dpp v13, v27, v82 row_newbcast:4 row_mask:0xf bank_mask:0xf
    v_dot2c_f32_bf16_dpp v14, v26, v83 row_newbcast:4 row_mask:0xf bank_mask:0xf
    v_dot2c_f32_bf16_dpp v15, v27, v83 row_newbcast:4 row_mask:0xf bank_mask:0xf
    s_waitcnt vmcnt(4)
    v_add_u32 v2, 0x8000, v2
    v_add_u32 v3, 0x8000, v3
    buffer_load_dwordx4 v[40:43], v2, s[24:27], 0 offen offset:0 nt
    v_dot2c_f32_bf16_dpp v8, v26, v84 row_newbcast:5 row_mask:0xf bank_mask:0xf
    v_dot2c_f32_bf16_dpp v9, v27, v84 row_newbcast:5 row_mask:0xf bank_mask:0xf
    v_dot2c_f32_bf16_dpp v10, v26, v85 row_newbcast:5 row_mask:0xf bank_mask:0xf
    v_dot2c_f32_bf16_dpp v11, v27, v85 row_newbcast:5 row_mask:0xf bank_mask:0xf
    v_dot2c_f32_bf16_dpp v12, v26, v86 row_newbcast:5 row_mask:0xf bank_mask:0xf
    v_dot2c_f32_bf16_dpp v13, v27, v86 row_newbcast:5 row_mask:0xf bank_mask:0xf
    v_dot2c_f32_bf16_dpp v14, v26, v87 row_newbcast:5 row_mask:0xf bank_mask:0xf
    v_dot2c_f32_bf16_dpp v15, v27, v87 row_newbcast:5 row_mask:0xf bank_mask:0xf
    s_waitcnt vmcnt(4)
    buffer_load_dwordx4 v[44:47], v2, s[24:27], 0 offen offset:1024 nt
    v_dot2c_f32_bf16_dpp v8, v26, v88 row_newbcast:8 row_mask:0xf bank_mask:0xf
    v_dot2c_f32_bf16_dpp v9, v27, v88 row_newbcast:8 row_mask:0xf bank_mask:0xf
    v_dot2c_f32_bf16_dpp v10, v26, v89 row_newbcast:8 row_mask:0xf bank_mask:0xf
    v_dot2c_f32_bf16_dpp v11, v27, v89 row_newbcast:8 row_mask:0xf bank_mask:0xf
    v_dot2c_f32_bf16_dpp v12, v26, v90 row_newbcast:8 row_mask:0xf bank_mask:0xf
    v_dot2c_f32_bf16_dpp v13, v27, v90 row_newbcast:8 row_mask:0xf bank_mask:0xf
    v_dot2c_f32_bf16_dpp v14, v26, v91 row_newbcast:8 row_mask:0xf bank_mask:0xf
    v_dot2c_f32_bf16_dpp v15, v27, v91 row_newbcast:8 row_mask:0xf bank_mask:0xf
    s_waitcnt vmcnt(4)
    buffer_load_dwordx4 v[48:51], v2, s[24:27], 0 offen offset:2048 nt
    v_dot2c_f32_bf16_dpp v8, v26, v92 row_newbcast:9 row_mask:0xf bank_mask:0xf
    v_dot2c_f32_bf16_dpp v9, v27, v92 row_newbcast:9 row_mask:0xf bank_mask:0xf
    v_dot2c_f32_bf16_dpp v10, v26, v93 row_newbcast:9 row_mask:0xf bank_mask:0xf
    v_dot2c_f32_bf16_dpp v11, v27, v93 row_newbcast:9 row_mask:0xf bank_mask:0xf
    v_dot2c_f32_bf16_dpp v12, v26, v94 row_newbcast:9 row_mask:0xf bank_mask:0xf
    v_dot2c_f32_bf16_dpp v13, v27, v94 row_newbcast:9 row_mask:0xf bank_mask:0xf
    v_dot2c_f32_bf16_dpp v14, v26, v95 row_newbcast:9 row_mask:0xf bank_mask:0xf
    v_dot2c_f32_bf16_dpp v15, v27, v95 row_newbcast:9 row_mask:0xf bank_mask:0xf
    s_waitcnt vmcnt(4)
    buffer_load_dwordx4 v[52:55], v2, s[24:27], 0 offen offset:3072 nt
    v_dot2c_f32_bf16_dpp v8, v26, v96 row_newbcast:12 row_mask:0xf bank_mask:0xf
    v_dot2c_f32_bf16_dpp v9, v27, v96 row_newbcast:12 row_mask:0xf bank_mask:0xf
    v_dot2c_f32_bf16_dpp v10, v26, v97 row_newbcast:12 row_mask:0xf bank_mask:0xf
    v_dot2c_f32_bf16_dpp v11, v27, v97 row_newbcast:12 row_mask:0xf bank_mask:0xf
    v_dot2c_f32_bf16_dpp v12, v26, v98 row_newbcast:12 row_mask:0xf bank_mask:0xf
    v_dot2c_f32_bf16_dpp v13, v27, v98 row_newbcast:12 row_mask:0xf bank_mask:0xf
    v_dot2c_f32_bf16_dpp v14, v26, v99 row_newbcast:12 row_mask:0xf bank_mask:0xf
    v_dot2c_f32_bf16_dpp v15, v27, v99 row_newbcast:12 row_mask:0xf bank_mask:0xf
    s_waitcnt vmcnt(4)
    buffer_load_dwordx4 v[56:59], v3, s[24:27], 0 offen offset:0 nt
    buffer_load_dwordx4 v[60:63], v3, s[24:27], 0 offen offset:1024 nt
    v_dot2c_f32_bf16_dpp v8, v26, v100 row_newbcast:13 row_mask:0xf bank_mask:0xf
    v_dot2c_f32_bf16_dpp v9, v27, v100 row_newbcast:13 row_mask:0xf bank_mask:0xf
    v_dot2c_f32_bf16_dpp v10, v26, v101 row_newbcast:13 row_mask:0xf bank_mask:0xf
    v_dot2c_f32_bf16_dpp v11, v27, v101 row_newbcast:13 row_mask:0xf bank_mask:0xf
    v_dot2c_f32_bf16_dpp v12, v26, v102 row_newbcast:13 row_mask:0xf bank_mask:0xf
    v_dot2c_f32_bf16_dpp v13, v27, v102 row_newbcast:13 row_mask:0xf bank_mask:0xf
    v_dot2c_f32_bf16_dpp v14, v26, v103 row_newbcast:13 row_mask:0xf bank_mask:0xf
    v_dot2c_f32_bf16_dpp v15, v27, v103 row_newbcast:13 row_mask:0xf bank_mask:0xf
    s_waitcnt vmcnt(5)
    s_mov_b32 s64, 8192
    buffer_load_dwordx4 v[112:115], v36, s[36:39], s64 offen
    s_mov_b32 s64, 9216
    buffer_load_dwordx4 v[116:119], v36, s[36:39], s64 offen
    v_dot2_f32_bf16 v16, v40, v4, 0
    v_dot2_f32_bf16 v16, v41, v5, v16
    v_dot2_f32_bf16 v16, v42, v6, v16
    v_dot2_f32_bf16 v16, v43, v7, v16
    s_waitcnt vmcnt(6)
    buffer_load_dwordx4 v[64:67], v3, s[24:27], 0 offen offset:2048 nt
    v_dot2_f32_bf16 v17, v44, v4, 0
    v_dot2_f32_bf16 v17, v45, v5, v17
    v_dot2_f32_bf16 v17, v46, v6, v17
    v_dot2_f32_bf16 v17, v47, v7, v17
    s_waitcnt vmcnt(6)
    buffer_load_dwordx4 v[68:71], v3, s[24:27], 0 offen offset:3072 nt
    v_dot2_f32_bf16 v18, v48, v4, 0
    v_dot2_f32_bf16 v18, v49, v5, v18
    v_dot2_f32_bf16 v18, v50, v6, v18
    v_dot2_f32_bf16 v18, v51, v7, v18
    s_waitcnt vmcnt(6)
    buffer_load_dwordx4 v[72:75], v2, s[28:31], 0 offen offset:0 nt
    v_dot2_f32_bf16 v19, v52, v4, 0
    v_dot2_f32_bf16 v19, v53, v5, v19
    v_dot2_f32_bf16 v19, v54, v6, v19
    v_dot2_f32_bf16 v19, v55, v7, v19
    s_waitcnt vmcnt(6)
    buffer_load_dwordx4 v[76:79], v2, s[28:31], 0 offen offset:1024 nt
    v_dot2_f32_bf16 v20, v56, v4, 0
    v_dot2_f32_bf16 v20, v57, v5, v20
    v_dot2_f32_bf16 v20, v58, v6, v20
    v_dot2_f32_bf16 v20, v59, v7, v20
    s_waitcnt vmcnt(6)
    buffer_load_dwordx4 v[80:83], v2, s[28:31], 0 offen offset:2048 nt
    v_dot2_f32_bf16 v21, v60, v4, 0
    v_dot2_f32_bf16 v21, v61, v5, v21
    v_dot2_f32_bf16 v21, v62, v6, v21
    v_dot2_f32_bf16 v21, v63, v7, v21
    s_waitcnt vmcnt(4)
    buffer_load_dwordx4 v[84:87], v2, s[28:31], 0 offen offset:3072 nt
    v_dot2_f32_bf16 v22, v64, v4, 0
    v_dot2_f32_bf16 v22, v65, v5, v22
    v_dot2_f32_bf16 v22, v66, v6, v22
    v_dot2_f32_bf16 v22, v67, v7, v22
    s_waitcnt vmcnt(4)
    buffer_load_dwordx4 v[88:91], v3, s[28:31], 0 offen offset:0 nt
    buffer_load_dwordx4 v[92:95], v3, s[28:31], 0 offen offset:1024 nt
    v_dot2_f32_bf16 v23, v68, v4, 0
    v_dot2_f32_bf16 v23, v69, v5, v23
    v_dot2_f32_bf16 v23, v70, v6, v23
    v_dot2_f32_bf16 v23, v71, v7, v23
    s_nop 2
    v_add_f32_dpp v16, v16, v16 row_ror:8 row_mask:0xf bank_mask:0x3
    v_add_f32_dpp v17, v17, v17 row_ror:8 row_mask:0xf bank_mask:0x3
    v_add_f32_dpp v18, v18, v18 row_ror:8 row_mask:0xf bank_mask:0x3
    v_add_f32_dpp v19, v19, v19 row_ror:8 row_mask:0xf bank_mask:0x3
    v_add_f32_dpp v16, v20, v20 row_ror:8 row_mask:0xf bank_mask:0xc
    v_add_f32_dpp v17, v21, v21 row_ror:8 row_mask:0xf bank_mask:0xc
    v_add_f32_dpp v18, v22, v22 row_ror:8 row_mask:0xf bank_mask:0xc
    v_add_f32_dpp v19, v23, v23 row_ror:8 row_mask:0xf bank_mask:0xc
    v_add_f32_dpp v16, v16, v16 row_half_mirror row_mask:0xf bank_mask:0x5
    v_add_f32_dpp v17, v17, v17 row_half_mirror row_mask:0xf bank_mask:0x5
    v_add_f32_dpp v16, v18, v18 row_half_mirror row_mask:0xf bank_mask:0xa
    v_add_f32_dpp v17, v19, v19 row_half_mirror row_mask:0xf bank_mask:0xa
    s_nop 0
    v_add_f32_dpp v16, v16, v16 quad_perm:[1,0,3,2] row_mask:0xf bank_mask:0xf
    v_add_f32_dpp v17, v17, v17 quad_perm:[1,0,3,2] row_mask:0xf bank_mask:0xf
    s_nop 0
    v_cndmask_b32 v29, v16, v17, s[76:77]
    s_nop 1
    v_add_f32_dpp v29, v29, v29 quad_perm:[2,3,0,1] row_mask:0xf bank_mask:0xf
    v_mul_f32 v29, s74, v29
    s_nop 1
    v_max_f32_dpp v30, v29, v29 quad_perm:[1,0,3,2] row_mask:0xf bank_mask:0xf
    s_nop 1
    v_max_f32_dpp v30, v30, v30 row_ror:4 row_mask:0xf bank_mask:0xf
    s_nop 1
    v_max_f32_dpp v30, v30, v30 row_ror:8 row_mask:0xf bank_mask:0xf
    v_max_f32 v30, v30, v24
    v_sub_f32 v28, v24, v30
    v_sub_f32 v29, v29, v30
    v_exp_f32 v28, v28
    v_exp_f32 v29, v29
    v_mov_b32 v24, v30
    v_cvt_pk_bf16_f32 v26, v29, 0
    v_cvt_pk_bf16_f32 v27, 0, v29
    v_fma_f32 v25, v25, v28, v29
    v_mul_f32 v8, v28, v8
    v_mul_f32 v9, v28, v9
    v_mul_f32 v10, v28, v10
    v_mul_f32 v11, v28, v11
    v_mul_f32 v12, v28, v12
    v_mul_f32 v13, v28, v13
    v_mul_f32 v14, v28, v14
    v_mul_f32 v15, v28, v15
    s_waitcnt vmcnt(5)
    v_dot2c_f32_bf16_dpp v8, v26, v72 row_newbcast:0 row_mask:0xf bank_mask:0xf
    v_dot2c_f32_bf16_dpp v9, v27, v72 row_newbcast:0 row_mask:0xf bank_mask:0xf
    v_dot2c_f32_bf16_dpp v10, v26, v73 row_newbcast:0 row_mask:0xf bank_mask:0xf
    v_dot2c_f32_bf16_dpp v11, v27, v73 row_newbcast:0 row_mask:0xf bank_mask:0xf
    v_dot2c_f32_bf16_dpp v12, v26, v74 row_newbcast:0 row_mask:0xf bank_mask:0xf
    v_dot2c_f32_bf16_dpp v13, v27, v74 row_newbcast:0 row_mask:0xf bank_mask:0xf
    v_dot2c_f32_bf16_dpp v14, v26, v75 row_newbcast:0 row_mask:0xf bank_mask:0xf
    v_dot2c_f32_bf16_dpp v15, v27, v75 row_newbcast:0 row_mask:0xf bank_mask:0xf
    s_waitcnt vmcnt(4)
    buffer_load_dwordx4 v[96:99], v3, s[28:31], 0 offen offset:2048 nt
    v_dot2c_f32_bf16_dpp v8, v26, v76 row_newbcast:1 row_mask:0xf bank_mask:0xf
    v_dot2c_f32_bf16_dpp v9, v27, v76 row_newbcast:1 row_mask:0xf bank_mask:0xf
    v_dot2c_f32_bf16_dpp v10, v26, v77 row_newbcast:1 row_mask:0xf bank_mask:0xf
    v_dot2c_f32_bf16_dpp v11, v27, v77 row_newbcast:1 row_mask:0xf bank_mask:0xf
    v_dot2c_f32_bf16_dpp v12, v26, v78 row_newbcast:1 row_mask:0xf bank_mask:0xf
    v_dot2c_f32_bf16_dpp v13, v27, v78 row_newbcast:1 row_mask:0xf bank_mask:0xf
    v_dot2c_f32_bf16_dpp v14, v26, v79 row_newbcast:1 row_mask:0xf bank_mask:0xf
    v_dot2c_f32_bf16_dpp v15, v27, v79 row_newbcast:1 row_mask:0xf bank_mask:0xf
    s_waitcnt vmcnt(4)
    buffer_load_dwordx4 v[100:103], v3, s[28:31], 0 offen offset:3072 nt
    v_dot2c_f32_bf16_dpp v8, v26, v80 row_newbcast:4 row_mask:0xf bank_mask:0xf
    v_dot2c_f32_bf16_dpp v9, v27, v80 row_newbcast:4 row_mask:0xf bank_mask:0xf
    v_dot2c_f32_bf16_dpp v10, v26, v81 row_newbcast:4 row_mask:0xf bank_mask:0xf
    v_dot2c_f32_bf16_dpp v11, v27, v81 row_newbcast:4 row_mask:0xf bank_mask:0xf
    v_dot2c_f32_bf16_dpp v12, v26, v82 row_newbcast:4 row_mask:0xf bank_mask:0xf
    v_dot2c_f32_bf16_dpp v13, v27, v82 row_newbcast:4 row_mask:0xf bank_mask:0xf
    v_dot2c_f32_bf16_dpp v14, v26, v83 row_newbcast:4 row_mask:0xf bank_mask:0xf
    v_dot2c_f32_bf16_dpp v15, v27, v83 row_newbcast:4 row_mask:0xf bank_mask:0xf
    s_waitcnt vmcnt(4)
    v_add_u32 v2, 0x8000, v2
    v_add_u32 v3, 0x8000, v3
    buffer_load_dwordx4 v[40:43], v2, s[24:27], 0 offen offset:0 nt
    v_dot2c_f32_bf16_dpp v8, v26, v84 row_newbcast:5 row_mask:0xf bank_mask:0xf
    v_dot2c_f32_bf16_dpp v9, v27, v84 row_newbcast:5 row_mask:0xf bank_mask:0xf
    v_dot2c_f32_bf16_dpp v10, v26, v85 row_newbcast:5 row_mask:0xf bank_mask:0xf
    v_dot2c_f32_bf16_dpp v11, v27, v85 row_newbcast:5 row_mask:0xf bank_mask:0xf
    v_dot2c_f32_bf16_dpp v12, v26, v86 row_newbcast:5 row_mask:0xf bank_mask:0xf
    v_dot2c_f32_bf16_dpp v13, v27, v86 row_newbcast:5 row_mask:0xf bank_mask:0xf
    v_dot2c_f32_bf16_dpp v14, v26, v87 row_newbcast:5 row_mask:0xf bank_mask:0xf
    v_dot2c_f32_bf16_dpp v15, v27, v87 row_newbcast:5 row_mask:0xf bank_mask:0xf
    s_waitcnt vmcnt(4)
    buffer_load_dwordx4 v[44:47], v2, s[24:27], 0 offen offset:1024 nt
    v_dot2c_f32_bf16_dpp v8, v26, v88 row_newbcast:8 row_mask:0xf bank_mask:0xf
    v_dot2c_f32_bf16_dpp v9, v27, v88 row_newbcast:8 row_mask:0xf bank_mask:0xf
    v_dot2c_f32_bf16_dpp v10, v26, v89 row_newbcast:8 row_mask:0xf bank_mask:0xf
    v_dot2c_f32_bf16_dpp v11, v27, v89 row_newbcast:8 row_mask:0xf bank_mask:0xf
    v_dot2c_f32_bf16_dpp v12, v26, v90 row_newbcast:8 row_mask:0xf bank_mask:0xf
    v_dot2c_f32_bf16_dpp v13, v27, v90 row_newbcast:8 row_mask:0xf bank_mask:0xf
    v_dot2c_f32_bf16_dpp v14, v26, v91 row_newbcast:8 row_mask:0xf bank_mask:0xf
    v_dot2c_f32_bf16_dpp v15, v27, v91 row_newbcast:8 row_mask:0xf bank_mask:0xf
    s_waitcnt vmcnt(4)
    buffer_load_dwordx4 v[48:51], v2, s[24:27], 0 offen offset:2048 nt
    v_dot2c_f32_bf16_dpp v8, v26, v92 row_newbcast:9 row_mask:0xf bank_mask:0xf
    v_dot2c_f32_bf16_dpp v9, v27, v92 row_newbcast:9 row_mask:0xf bank_mask:0xf
    v_dot2c_f32_bf16_dpp v10, v26, v93 row_newbcast:9 row_mask:0xf bank_mask:0xf
    v_dot2c_f32_bf16_dpp v11, v27, v93 row_newbcast:9 row_mask:0xf bank_mask:0xf
    v_dot2c_f32_bf16_dpp v12, v26, v94 row_newbcast:9 row_mask:0xf bank_mask:0xf
    v_dot2c_f32_bf16_dpp v13, v27, v94 row_newbcast:9 row_mask:0xf bank_mask:0xf
    v_dot2c_f32_bf16_dpp v14, v26, v95 row_newbcast:9 row_mask:0xf bank_mask:0xf
    v_dot2c_f32_bf16_dpp v15, v27, v95 row_newbcast:9 row_mask:0xf bank_mask:0xf
    s_waitcnt vmcnt(4)
    buffer_load_dwordx4 v[52:55], v2, s[24:27], 0 offen offset:3072 nt
    v_dot2c_f32_bf16_dpp v8, v26, v96 row_newbcast:12 row_mask:0xf bank_mask:0xf
    v_dot2c_f32_bf16_dpp v9, v27, v96 row_newbcast:12 row_mask:0xf bank_mask:0xf
    v_dot2c_f32_bf16_dpp v10, v26, v97 row_newbcast:12 row_mask:0xf bank_mask:0xf
    v_dot2c_f32_bf16_dpp v11, v27, v97 row_newbcast:12 row_mask:0xf bank_mask:0xf
    v_dot2c_f32_bf16_dpp v12, v26, v98 row_newbcast:12 row_mask:0xf bank_mask:0xf
    v_dot2c_f32_bf16_dpp v13, v27, v98 row_newbcast:12 row_mask:0xf bank_mask:0xf
    v_dot2c_f32_bf16_dpp v14, v26, v99 row_newbcast:12 row_mask:0xf bank_mask:0xf
    v_dot2c_f32_bf16_dpp v15, v27, v99 row_newbcast:12 row_mask:0xf bank_mask:0xf
    s_waitcnt vmcnt(4)
    buffer_load_dwordx4 v[56:59], v3, s[24:27], 0 offen offset:0 nt
    buffer_load_dwordx4 v[60:63], v3, s[24:27], 0 offen offset:1024 nt
    v_dot2c_f32_bf16_dpp v8, v26, v100 row_newbcast:13 row_mask:0xf bank_mask:0xf
    v_dot2c_f32_bf16_dpp v9, v27, v100 row_newbcast:13 row_mask:0xf bank_mask:0xf
    v_dot2c_f32_bf16_dpp v10, v26, v101 row_newbcast:13 row_mask:0xf bank_mask:0xf
    v_dot2c_f32_bf16_dpp v11, v27, v101 row_newbcast:13 row_mask:0xf bank_mask:0xf
    v_dot2c_f32_bf16_dpp v12, v26, v102 row_newbcast:13 row_mask:0xf bank_mask:0xf
    v_dot2c_f32_bf16_dpp v13, v27, v102 row_newbcast:13 row_mask:0xf bank_mask:0xf
    v_dot2c_f32_bf16_dpp v14, v26, v103 row_newbcast:13 row_mask:0xf bank_mask:0xf
    v_dot2c_f32_bf16_dpp v15, v27, v103 row_newbcast:13 row_mask:0xf bank_mask:0xf
    v_perm_b32 v29, v108, v104, s72
    v_perm_b32 v108, v108, v104, s73
    v_mov_b32 v104, v29
    v_perm_b32 v29, v109, v105, s72
    v_perm_b32 v109, v109, v105, s73
    v_mov_b32 v105, v29
    v_perm_b32 v29, v110, v106, s72
    v_perm_b32 v110, v110, v106, s73
    v_mov_b32 v106, v29
    v_perm_b32 v29, v111, v107, s72
    v_perm_b32 v111, v111, v107, s73
    v_mov_b32 v107, v29
    s_waitcnt vmcnt(5)
    s_mov_b32 s64, 16384
    buffer_load_dwordx4 v[120:123], v36, s[36:39], s64 offen
    s_mov_b32 s64, 17408
    buffer_load_dwordx4 v[124:127], v36, s[36:39], s64 offen
    v_dot2_f32_bf16 v16, v40, v4, 0
    v_dot2_f32_bf16 v16, v41, v5, v16
    v_dot2_f32_bf16 v16, v42, v6, v16
    v_dot2_f32_bf16 v16, v43, v7, v16
    s_waitcnt vmcnt(6)
    buffer_load_dwordx4 v[64:67], v3, s[24:27], 0 offen offset:2048 nt
    v_dot2_f32_bf16 v17, v44, v4, 0
    v_dot2_f32_bf16 v17, v45, v5, v17
    v_dot2_f32_bf16 v17, v46, v6, v17
    v_dot2_f32_bf16 v17, v47, v7, v17
    s_waitcnt vmcnt(6)
    buffer_load_dwordx4 v[68:71], v3, s[24:27], 0 offen offset:3072 nt
    v_dot2_f32_bf16 v18, v48, v4, 0
    v_dot2_f32_bf16 v18, v49, v5, v18
    v_dot2_f32_bf16 v18, v50, v6, v18
    v_dot2_f32_bf16 v18, v51, v7, v18
    s_waitcnt vmcnt(6)
    buffer_load_dwordx4 v[72:75], v2, s[28:31], 0 offen offset:0 nt
    v_dot2_f32_bf16 v19, v52, v4, 0
    v_dot2_f32_bf16 v19, v53, v5, v19
    v_dot2_f32_bf16 v19, v54, v6, v19
    v_dot2_f32_bf16 v19, v55, v7, v19
    s_waitcnt vmcnt(6)
    buffer_load_dwordx4 v[76:79], v2, s[28:31], 0 offen offset:1024 nt
    v_dot2_f32_bf16 v20, v56, v4, 0
    v_dot2_f32_bf16 v20, v57, v5, v20
    v_dot2_f32_bf16 v20, v58, v6, v20
    v_dot2_f32_bf16 v20, v59, v7, v20
    s_waitcnt vmcnt(6)
    buffer_load_dwordx4 v[80:83], v2, s[28:31], 0 offen offset:2048 nt
    v_dot2_f32_bf16 v21, v60, v4, 0
    v_dot2_f32_bf16 v21, v61, v5, v21
    v_dot2_f32_bf16 v21, v62, v6, v21
    v_dot2_f32_bf16 v21, v63, v7, v21
    s_waitcnt vmcnt(4)
    buffer_load_dwordx4 v[84:87], v2, s[28:31], 0 offen offset:3072 nt
    v_dot2_f32_bf16 v22, v64, v4, 0
    v_dot2_f32_bf16 v22, v65, v5, v22
    v_dot2_f32_bf16 v22, v66, v6, v22
    v_dot2_f32_bf16 v22, v67, v7, v22
    s_waitcnt vmcnt(4)
    buffer_load_dwordx4 v[88:91], v3, s[28:31], 0 offen offset:0 nt
    buffer_load_dwordx4 v[92:95], v3, s[28:31], 0 offen offset:1024 nt
    v_dot2_f32_bf16 v23, v68, v4, 0
    v_dot2_f32_bf16 v23, v69, v5, v23
    v_dot2_f32_bf16 v23, v70, v6, v23
    v_dot2_f32_bf16 v23, v71, v7, v23
    s_nop 2
    v_add_f32_dpp v16, v16, v16 row_ror:8 row_mask:0xf bank_mask:0x3
    v_add_f32_dpp v17, v17, v17 row_ror:8 row_mask:0xf bank_mask:0x3
    v_add_f32_dpp v18, v18, v18 row_ror:8 row_mask:0xf bank_mask:0x3
    v_add_f32_dpp v19, v19, v19 row_ror:8 row_mask:0xf bank_mask:0x3
    v_add_f32_dpp v16, v20, v20 row_ror:8 row_mask:0xf bank_mask:0xc
    v_add_f32_dpp v17, v21, v21 row_ror:8 row_mask:0xf bank_mask:0xc
    v_add_f32_dpp v18, v22, v22 row_ror:8 row_mask:0xf bank_mask:0xc
    v_add_f32_dpp v19, v23, v23 row_ror:8 row_mask:0xf bank_mask:0xc
    v_add_f32_dpp v16, v16, v16 row_half_mirror row_mask:0xf bank_mask:0x5
    v_add_f32_dpp v17, v17, v17 row_half_mirror row_mask:0xf bank_mask:0x5
    v_add_f32_dpp v16, v18, v18 row_half_mirror row_mask:0xf bank_mask:0xa
    v_add_f32_dpp v17, v19, v19 row_half_mirror row_mask:0xf bank_mask:0xa
    s_nop 0
    v_add_f32_dpp v16, v16, v16 quad_perm:[1,0,3,2] row_mask:0xf bank_mask:0xf
    v_add_f32_dpp v17, v17, v17 quad_perm:[1,0,3,2] row_mask:0xf bank_mask:0xf
    s_nop 0
    v_cndmask_b32 v29, v16, v17, s[76:77]
    s_nop 1
    v_add_f32_dpp v29, v29, v29 quad_perm:[2,3,0,1] row_mask:0xf bank_mask:0xf
    v_mul_f32 v29, s74, v29
    s_nop 1
    v_max_f32_dpp v30, v29, v29 quad_perm:[1,0,3,2] row_mask:0xf bank_mask:0xf
    s_nop 1
    v_max_f32_dpp v30, v30, v30 row_ror:4 row_mask:0xf bank_mask:0xf
    s_nop 1
    v_max_f32_dpp v30, v30, v30 row_ror:8 row_mask:0xf bank_mask:0xf
    v_max_f32 v30, v30, v24
    v_sub_f32 v28, v24, v30
    v_sub_f32 v29, v29, v30
    v_exp_f32 v28, v28
    v_exp_f32 v29, v29
    v_mov_b32 v24, v30
    v_cvt_pk_bf16_f32 v26, v29, 0
    v_cvt_pk_bf16_f32 v27, 0, v29
    v_fma_f32 v25, v25, v28, v29
    v_mul_f32 v8, v28, v8
    v_mul_f32 v9, v28, v9
    v_mul_f32 v10, v28, v10
    v_mul_f32 v11, v28, v11
    v_mul_f32 v12, v28, v12
    v_mul_f32 v13, v28, v13
    v_mul_f32 v14, v28, v14
    v_mul_f32 v15, v28, v15
    s_waitcnt vmcnt(5)
    v_dot2c_f32_bf16_dpp v8, v26, v72 row_newbcast:0 row_mask:0xf bank_mask:0xf
    v_dot2c_f32_bf16_dpp v9, v27, v72 row_newbcast:0 row_mask:0xf bank_mask:0xf
    v_dot2c_f32_bf16_dpp v10, v26, v73 row_newbcast:0 row_mask:0xf bank_mask:0xf
    v_dot2c_f32_bf16_dpp v11, v27, v73 row_newbcast:0 row_mask:0xf bank_mask:0xf
    v_dot2c_f32_bf16_dpp v12, v26, v74 row_newbcast:0 row_mask:0xf bank_mask:0xf
    v_dot2c_f32_bf16_dpp v13, v27, v74 row_newbcast:0 row_mask:0xf bank_mask:0xf
    v_dot2c_f32_bf16_dpp v14, v26, v75 row_newbcast:0 row_mask:0xf bank_mask:0xf
    v_dot2c_f32_bf16_dpp v15, v27, v75 row_newbcast:0 row_mask:0xf bank_mask:0xf
    s_waitcnt vmcnt(4)
    buffer_load_dwordx4 v[96:99], v3, s[28:31], 0 offen offset:2048 nt
    v_dot2c_f32_bf16_dpp v8, v26, v76 row_newbcast:1 row_mask:0xf bank_mask:0xf
    v_dot2c_f32_bf16_dpp v9, v27, v76 row_newbcast:1 row_mask:0xf bank_mask:0xf
    v_dot2c_f32_bf16_dpp v10, v26, v77 row_newbcast:1 row_mask:0xf bank_mask:0xf
    v_dot2c_f32_bf16_dpp v11, v27, v77 row_newbcast:1 row_mask:0xf bank_mask:0xf
    v_dot2c_f32_bf16_dpp v12, v26, v78 row_newbcast:1 row_mask:0xf bank_mask:0xf
    v_dot2c_f32_bf16_dpp v13, v27, v78 row_newbcast:1 row_mask:0xf bank_mask:0xf
    v_dot2c_f32_bf16_dpp v14, v26, v79 row_newbcast:1 row_mask:0xf bank_mask:0xf
    v_dot2c_f32_bf16_dpp v15, v27, v79 row_newbcast:1 row_mask:0xf bank_mask:0xf
    s_waitcnt vmcnt(4)
    buffer_load_dwordx4 v[100:103], v3, s[28:31], 0 offen offset:3072 nt
    v_dot2c_f32_bf16_dpp v8, v26, v80 row_newbcast:4 row_mask:0xf bank_mask:0xf
    v_dot2c_f32_bf16_dpp v9, v27, v80 row_newbcast:4 row_mask:0xf bank_mask:0xf
    v_dot2c_f32_bf16_dpp v10, v26, v81 row_newbcast:4 row_mask:0xf bank_mask:0xf
    v_dot2c_f32_bf16_dpp v11, v27, v81 row_newbcast:4 row_mask:0xf bank_mask:0xf
    v_dot2c_f32_bf16_dpp v12, v26, v82 row_newbcast:4 row_mask:0xf bank_mask:0xf
    v_dot2c_f32_bf16_dpp v13, v27, v82 row_newbcast:4 row_mask:0xf bank_mask:0xf
    v_dot2c_f32_bf16_dpp v14, v26, v83 row_newbcast:4 row_mask:0xf bank_mask:0xf
    v_dot2c_f32_bf16_dpp v15, v27, v83 row_newbcast:4 row_mask:0xf bank_mask:0xf
    s_waitcnt vmcnt(4)
    v_add_u32 v2, 0x8000, v2
    v_add_u32 v3, 0x8000, v3
    buffer_load_dwordx4 v[40:43], v2, s[24:27], 0 offen offset:0 nt
    v_dot2c_f32_bf16_dpp v8, v26, v84 row_newbcast:5 row_mask:0xf bank_mask:0xf
    v_dot2c_f32_bf16_dpp v9, v27, v84 row_newbcast:5 row_mask:0xf bank_mask:0xf
    v_dot2c_f32_bf16_dpp v10, v26, v85 row_newbcast:5 row_mask:0xf bank_mask:0xf
    v_dot2c_f32_bf16_dpp v11, v27, v85 row_newbcast:5 row_mask:0xf bank_mask:0xf
    v_dot2c_f32_bf16_dpp v12, v26, v86 row_newbcast:5 row_mask:0xf bank_mask:0xf
    v_dot2c_f32_bf16_dpp v13, v27, v86 row_newbcast:5 row_mask:0xf bank_mask:0xf
    v_dot2c_f32_bf16_dpp v14, v26, v87 row_newbcast:5 row_mask:0xf bank_mask:0xf
    v_dot2c_f32_bf16_dpp v15, v27, v87 row_newbcast:5 row_mask:0xf bank_mask:0xf
    s_waitcnt vmcnt(4)
    buffer_load_dwordx4 v[44:47], v2, s[24:27], 0 offen offset:1024 nt
    v_dot2c_f32_bf16_dpp v8, v26, v88 row_newbcast:8 row_mask:0xf bank_mask:0xf
    v_dot2c_f32_bf16_dpp v9, v27, v88 row_newbcast:8 row_mask:0xf bank_mask:0xf
    v_dot2c_f32_bf16_dpp v10, v26, v89 row_newbcast:8 row_mask:0xf bank_mask:0xf
    v_dot2c_f32_bf16_dpp v11, v27, v89 row_newbcast:8 row_mask:0xf bank_mask:0xf
    v_dot2c_f32_bf16_dpp v12, v26, v90 row_newbcast:8 row_mask:0xf bank_mask:0xf
    v_dot2c_f32_bf16_dpp v13, v27, v90 row_newbcast:8 row_mask:0xf bank_mask:0xf
    v_dot2c_f32_bf16_dpp v14, v26, v91 row_newbcast:8 row_mask:0xf bank_mask:0xf
    v_dot2c_f32_bf16_dpp v15, v27, v91 row_newbcast:8 row_mask:0xf bank_mask:0xf
    s_waitcnt vmcnt(4)
    buffer_load_dwordx4 v[48:51], v2, s[24:27], 0 offen offset:2048 nt
    v_dot2c_f32_bf16_dpp v8, v26, v92 row_newbcast:9 row_mask:0xf bank_mask:0xf
    v_dot2c_f32_bf16_dpp v9, v27, v92 row_newbcast:9 row_mask:0xf bank_mask:0xf
    v_dot2c_f32_bf16_dpp v10, v26, v93 row_newbcast:9 row_mask:0xf bank_mask:0xf
    v_dot2c_f32_bf16_dpp v11, v27, v93 row_newbcast:9 row_mask:0xf bank_mask:0xf
    v_dot2c_f32_bf16_dpp v12, v26, v94 row_newbcast:9 row_mask:0xf bank_mask:0xf
    v_dot2c_f32_bf16_dpp v13, v27, v94 row_newbcast:9 row_mask:0xf bank_mask:0xf
    v_dot2c_f32_bf16_dpp v14, v26, v95 row_newbcast:9 row_mask:0xf bank_mask:0xf
    v_dot2c_f32_bf16_dpp v15, v27, v95 row_newbcast:9 row_mask:0xf bank_mask:0xf
    s_waitcnt vmcnt(4)
    buffer_load_dwordx4 v[52:55], v2, s[24:27], 0 offen offset:3072 nt
    v_dot2c_f32_bf16_dpp v8, v26, v96 row_newbcast:12 row_mask:0xf bank_mask:0xf
    v_dot2c_f32_bf16_dpp v9, v27, v96 row_newbcast:12 row_mask:0xf bank_mask:0xf
    v_dot2c_f32_bf16_dpp v10, v26, v97 row_newbcast:12 row_mask:0xf bank_mask:0xf
    v_dot2c_f32_bf16_dpp v11, v27, v97 row_newbcast:12 row_mask:0xf bank_mask:0xf
    v_dot2c_f32_bf16_dpp v12, v26, v98 row_newbcast:12 row_mask:0xf bank_mask:0xf
    v_dot2c_f32_bf16_dpp v13, v27, v98 row_newbcast:12 row_mask:0xf bank_mask:0xf
    v_dot2c_f32_bf16_dpp v14, v26, v99 row_newbcast:12 row_mask:0xf bank_mask:0xf
    v_dot2c_f32_bf16_dpp v15, v27, v99 row_newbcast:12 row_mask:0xf bank_mask:0xf
    s_waitcnt vmcnt(4)
    buffer_load_dwordx4 v[56:59], v3, s[24:27], 0 offen offset:0 nt
    buffer_load_dwordx4 v[60:63], v3, s[24:27], 0 offen offset:1024 nt
    v_dot2c_f32_bf16_dpp v8, v26, v100 row_newbcast:13 row_mask:0xf bank_mask:0xf
    v_dot2c_f32_bf16_dpp v9, v27, v100 row_newbcast:13 row_mask:0xf bank_mask:0xf
    v_dot2c_f32_bf16_dpp v10, v26, v101 row_newbcast:13 row_mask:0xf bank_mask:0xf
    v_dot2c_f32_bf16_dpp v11, v27, v101 row_newbcast:13 row_mask:0xf bank_mask:0xf
    v_dot2c_f32_bf16_dpp v12, v26, v102 row_newbcast:13 row_mask:0xf bank_mask:0xf
    v_dot2c_f32_bf16_dpp v13, v27, v102 row_newbcast:13 row_mask:0xf bank_mask:0xf
    v_dot2c_f32_bf16_dpp v14, v26, v103 row_newbcast:13 row_mask:0xf bank_mask:0xf
    v_dot2c_f32_bf16_dpp v15, v27, v103 row_newbcast:13 row_mask:0xf bank_mask:0xf
    v_perm_b32 v29, v116, v112, s72
    v_perm_b32 v116, v116, v112, s73
    v_mov_b32 v112, v29
    v_perm_b32 v29, v117, v113, s72
    v_perm_b32 v117, v117, v113, s73
    v_mov_b32 v113, v29
    v_perm_b32 v29, v118, v114, s72
    v_perm_b32 v118, v118, v114, s73
    v_mov_b32 v114, v29
    v_perm_b32 v29, v119, v115, s72
    v_perm_b32 v119, v119, v115, s73
    v_mov_b32 v115, v29
    s_waitcnt vmcnt(5)
    s_mov_b32 s64, 24576
    buffer_load_dwordx4 v[128:131], v36, s[36:39], s64 offen
    s_mov_b32 s64, 25600
    buffer_load_dwordx4 v[132:135], v36, s[36:39], s64 offen
    v_dot2_f32_bf16 v16, v40, v4, 0
    v_dot2_f32_bf16 v16, v41, v5, v16
    v_dot2_f32_bf16 v16, v42, v6, v16
    v_dot2_f32_bf16 v16, v43, v7, v16
    s_waitcnt vmcnt(6)
    buffer_load_dwordx4 v[64:67], v3, s[24:27], 0 offen offset:2048 nt
    v_dot2_f32_bf16 v17, v44, v4, 0
    v_dot2_f32_bf16 v17, v45, v5, v17
    v_dot2_f32_bf16 v17, v46, v6, v17
    v_dot2_f32_bf16 v17, v47, v7, v17
    s_waitcnt vmcnt(6)
    buffer_load_dwordx4 v[68:71], v3, s[24:27], 0 offen offset:3072 nt
    v_dot2_f32_bf16 v18, v48, v4, 0
    v_dot2_f32_bf16 v18, v49, v5, v18
    v_dot2_f32_bf16 v18, v50, v6, v18
    v_dot2_f32_bf16 v18, v51, v7, v18
    s_waitcnt vmcnt(6)
    buffer_load_dwordx4 v[72:75], v2, s[28:31], 0 offen offset:0 nt
    v_dot2_f32_bf16 v19, v52, v4, 0
    v_dot2_f32_bf16 v19, v53, v5, v19
    v_dot2_f32_bf16 v19, v54, v6, v19
    v_dot2_f32_bf16 v19, v55, v7, v19
    s_waitcnt vmcnt(6)
    buffer_load_dwordx4 v[76:79], v2, s[28:31], 0 offen offset:1024 nt
    v_dot2_f32_bf16 v20, v56, v4, 0
    v_dot2_f32_bf16 v20, v57, v5, v20
    v_dot2_f32_bf16 v20, v58, v6, v20
    v_dot2_f32_bf16 v20, v59, v7, v20
    s_waitcnt vmcnt(6)
    buffer_load_dwordx4 v[80:83], v2, s[28:31], 0 offen offset:2048 nt
    v_dot2_f32_bf16 v21, v60, v4, 0
    v_dot2_f32_bf16 v21, v61, v5, v21
    v_dot2_f32_bf16 v21, v62, v6, v21
    v_dot2_f32_bf16 v21, v63, v7, v21
    s_waitcnt vmcnt(4)
    buffer_load_dwordx4 v[84:87], v2, s[28:31], 0 offen offset:3072 nt
    v_dot2_f32_bf16 v22, v64, v4, 0
    v_dot2_f32_bf16 v22, v65, v5, v22
    v_dot2_f32_bf16 v22, v66, v6, v22
    v_dot2_f32_bf16 v22, v67, v7, v22
    s_waitcnt vmcnt(4)
    buffer_load_dwordx4 v[88:91], v3, s[28:31], 0 offen offset:0 nt
    buffer_load_dwordx4 v[92:95], v3, s[28:31], 0 offen offset:1024 nt
    v_dot2_f32_bf16 v23, v68, v4, 0
    v_dot2_f32_bf16 v23, v69, v5, v23
    v_dot2_f32_bf16 v23, v70, v6, v23
    v_dot2_f32_bf16 v23, v71, v7, v23
    s_nop 2
    v_add_f32_dpp v16, v16, v16 row_ror:8 row_mask:0xf bank_mask:0x3
    v_add_f32_dpp v17, v17, v17 row_ror:8 row_mask:0xf bank_mask:0x3
    v_add_f32_dpp v18, v18, v18 row_ror:8 row_mask:0xf bank_mask:0x3
    v_add_f32_dpp v19, v19, v19 row_ror:8 row_mask:0xf bank_mask:0x3
    v_add_f32_dpp v16, v20, v20 row_ror:8 row_mask:0xf bank_mask:0xc
    v_add_f32_dpp v17, v21, v21 row_ror:8 row_mask:0xf bank_mask:0xc
    v_add_f32_dpp v18, v22, v22 row_ror:8 row_mask:0xf bank_mask:0xc
    v_add_f32_dpp v19, v23, v23 row_ror:8 row_mask:0xf bank_mask:0xc
    v_add_f32_dpp v16, v16, v16 row_half_mirror row_mask:0xf bank_mask:0x5
    v_add_f32_dpp v17, v17, v17 row_half_mirror row_mask:0xf bank_mask:0x5
    v_add_f32_dpp v16, v18, v18 row_half_mirror row_mask:0xf bank_mask:0xa
    v_add_f32_dpp v17, v19, v19 row_half_mirror row_mask:0xf bank_mask:0xa
    s_nop 0
    v_add_f32_dpp v16, v16, v16 quad_perm:[1,0,3,2] row_mask:0xf bank_mask:0xf
    v_add_f32_dpp v17, v17, v17 quad_perm:[1,0,3,2] row_mask:0xf bank_mask:0xf
    s_nop 0
    v_cndmask_b32 v29, v16, v17, s[76:77]
    s_nop 1
    v_add_f32_dpp v29, v29, v29 quad_perm:[2,3,0,1] row_mask:0xf bank_mask:0xf
    v_mul_f32 v29, s74, v29
    s_nop 1
    v_max_f32_dpp v30, v29, v29 quad_perm:[1,0,3,2] row_mask:0xf bank_mask:0xf
    s_nop 1
    v_max_f32_dpp v30, v30, v30 row_ror:4 row_mask:0xf bank_mask:0xf
    s_nop 1
    v_max_f32_dpp v30, v30, v30 row_ror:8 row_mask:0xf bank_mask:0xf
    v_max_f32 v30, v30, v24
    v_sub_f32 v28, v24, v30
    v_sub_f32 v29, v29, v30
    v_exp_f32 v28, v28
    v_exp_f32 v29, v29
    v_mov_b32 v24, v30
    v_cvt_pk_bf16_f32 v26, v29, 0
    v_cvt_pk_bf16_f32 v27, 0, v29
    v_fma_f32 v25, v25, v28, v29
    v_mul_f32 v8, v28, v8
    v_mul_f32 v9, v28, v9
    v_mul_f32 v10, v28, v10
    v_mul_f32 v11, v28, v11
    v_mul_f32 v12, v28, v12
    v_mul_f32 v13, v28, v13
    v_mul_f32 v14, v28, v14
    v_mul_f32 v15, v28, v15
    s_waitcnt vmcnt(5)
    v_dot2c_f32_bf16_dpp v8, v26, v72 row_newbcast:0 row_mask:0xf bank_mask:0xf
    v_dot2c_f32_bf16_dpp v9, v27, v72 row_newbcast:0 row_mask:0xf bank_mask:0xf
    v_dot2c_f32_bf16_dpp v10, v26, v73 row_newbcast:0 row_mask:0xf bank_mask:0xf
    v_dot2c_f32_bf16_dpp v11, v27, v73 row_newbcast:0 row_mask:0xf bank_mask:0xf
    v_dot2c_f32_bf16_dpp v12, v26, v74 row_newbcast:0 row_mask:0xf bank_mask:0xf
    v_dot2c_f32_bf16_dpp v13, v27, v74 row_newbcast:0 row_mask:0xf bank_mask:0xf
    v_dot2c_f32_bf16_dpp v14, v26, v75 row_newbcast:0 row_mask:0xf bank_mask:0xf
    v_dot2c_f32_bf16_dpp v15, v27, v75 row_newbcast:0 row_mask:0xf bank_mask:0xf
    s_waitcnt vmcnt(4)
    buffer_load_dwordx4 v[96:99], v3, s[28:31], 0 offen offset:2048 nt
    v_dot2c_f32_bf16_dpp v8, v26, v76 row_newbcast:1 row_mask:0xf bank_mask:0xf
    v_dot2c_f32_bf16_dpp v9, v27, v76 row_newbcast:1 row_mask:0xf bank_mask:0xf
    v_dot2c_f32_bf16_dpp v10, v26, v77 row_newbcast:1 row_mask:0xf bank_mask:0xf
    v_dot2c_f32_bf16_dpp v11, v27, v77 row_newbcast:1 row_mask:0xf bank_mask:0xf
    v_dot2c_f32_bf16_dpp v12, v26, v78 row_newbcast:1 row_mask:0xf bank_mask:0xf
    v_dot2c_f32_bf16_dpp v13, v27, v78 row_newbcast:1 row_mask:0xf bank_mask:0xf
    v_dot2c_f32_bf16_dpp v14, v26, v79 row_newbcast:1 row_mask:0xf bank_mask:0xf
    v_dot2c_f32_bf16_dpp v15, v27, v79 row_newbcast:1 row_mask:0xf bank_mask:0xf
    s_waitcnt vmcnt(4)
    buffer_load_dwordx4 v[100:103], v3, s[28:31], 0 offen offset:3072 nt
    v_dot2c_f32_bf16_dpp v8, v26, v80 row_newbcast:4 row_mask:0xf bank_mask:0xf
    v_dot2c_f32_bf16_dpp v9, v27, v80 row_newbcast:4 row_mask:0xf bank_mask:0xf
    v_dot2c_f32_bf16_dpp v10, v26, v81 row_newbcast:4 row_mask:0xf bank_mask:0xf
    v_dot2c_f32_bf16_dpp v11, v27, v81 row_newbcast:4 row_mask:0xf bank_mask:0xf
    v_dot2c_f32_bf16_dpp v12, v26, v82 row_newbcast:4 row_mask:0xf bank_mask:0xf
    v_dot2c_f32_bf16_dpp v13, v27, v82 row_newbcast:4 row_mask:0xf bank_mask:0xf
    v_dot2c_f32_bf16_dpp v14, v26, v83 row_newbcast:4 row_mask:0xf bank_mask:0xf
    v_dot2c_f32_bf16_dpp v15, v27, v83 row_newbcast:4 row_mask:0xf bank_mask:0xf
    s_waitcnt vmcnt(4)
    v_add_u32 v2, 0x8000, v2
    v_add_u32 v3, 0x8000, v3
    buffer_load_dwordx4 v[40:43], v2, s[24:27], 0 offen offset:0 nt
    v_dot2c_f32_bf16_dpp v8, v26, v84 row_newbcast:5 row_mask:0xf bank_mask:0xf
    v_dot2c_f32_bf16_dpp v9, v27, v84 row_newbcast:5 row_mask:0xf bank_mask:0xf
    v_dot2c_f32_bf16_dpp v10, v26, v85 row_newbcast:5 row_mask:0xf bank_mask:0xf
    v_dot2c_f32_bf16_dpp v11, v27, v85 row_newbcast:5 row_mask:0xf bank_mask:0xf
    v_dot2c_f32_bf16_dpp v12, v26, v86 row_newbcast:5 row_mask:0xf bank_mask:0xf
    v_dot2c_f32_bf16_dpp v13, v27, v86 row_newbcast:5 row_mask:0xf bank_mask:0xf
    v_dot2c_f32_bf16_dpp v14, v26, v87 row_newbcast:5 row_mask:0xf bank_mask:0xf
    v_dot2c_f32_bf16_dpp v15, v27, v87 row_newbcast:5 row_mask:0xf bank_mask:0xf
    s_waitcnt vmcnt(4)
    buffer_load_dwordx4 v[44:47], v2, s[24:27], 0 offen offset:1024 nt
    v_dot2c_f32_bf16_dpp v8, v26, v88 row_newbcast:8 row_mask:0xf bank_mask:0xf
    v_dot2c_f32_bf16_dpp v9, v27, v88 row_newbcast:8 row_mask:0xf bank_mask:0xf
    v_dot2c_f32_bf16_dpp v10, v26, v89 row_newbcast:8 row_mask:0xf bank_mask:0xf
    v_dot2c_f32_bf16_dpp v11, v27, v89 row_newbcast:8 row_mask:0xf bank_mask:0xf
    v_dot2c_f32_bf16_dpp v12, v26, v90 row_newbcast:8 row_mask:0xf bank_mask:0xf
    v_dot2c_f32_bf16_dpp v13, v27, v90 row_newbcast:8 row_mask:0xf bank_mask:0xf
    v_dot2c_f32_bf16_dpp v14, v26, v91 row_newbcast:8 row_mask:0xf bank_mask:0xf
    v_dot2c_f32_bf16_dpp v15, v27, v91 row_newbcast:8 row_mask:0xf bank_mask:0xf
    s_waitcnt vmcnt(4)
    buffer_load_dwordx4 v[48:51], v2, s[24:27], 0 offen offset:2048 nt
    v_dot2c_f32_bf16_dpp v8, v26, v92 row_newbcast:9 row_mask:0xf bank_mask:0xf
    v_dot2c_f32_bf16_dpp v9, v27, v92 row_newbcast:9 row_mask:0xf bank_mask:0xf
    v_dot2c_f32_bf16_dpp v10, v26, v93 row_newbcast:9 row_mask:0xf bank_mask:0xf
    v_dot2c_f32_bf16_dpp v11, v27, v93 row_newbcast:9 row_mask:0xf bank_mask:0xf
    v_dot2c_f32_bf16_dpp v12, v26, v94 row_newbcast:9 row_mask:0xf bank_mask:0xf
    v_dot2c_f32_bf16_dpp v13, v27, v94 row_newbcast:9 row_mask:0xf bank_mask:0xf
    v_dot2c_f32_bf16_dpp v14, v26, v95 row_newbcast:9 row_mask:0xf bank_mask:0xf
    v_dot2c_f32_bf16_dpp v15, v27, v95 row_newbcast:9 row_mask:0xf bank_mask:0xf
    s_waitcnt vmcnt(4)
    buffer_load_dwordx4 v[52:55], v2, s[24:27], 0 offen offset:3072 nt
    v_dot2c_f32_bf16_dpp v8, v26, v96 row_newbcast:12 row_mask:0xf bank_mask:0xf
    v_dot2c_f32_bf16_dpp v9, v27, v96 row_newbcast:12 row_mask:0xf bank_mask:0xf
    v_dot2c_f32_bf16_dpp v10, v26, v97 row_newbcast:12 row_mask:0xf bank_mask:0xf
    v_dot2c_f32_bf16_dpp v11, v27, v97 row_newbcast:12 row_mask:0xf bank_mask:0xf
    v_dot2c_f32_bf16_dpp v12, v26, v98 row_newbcast:12 row_mask:0xf bank_mask:0xf
    v_dot2c_f32_bf16_dpp v13, v27, v98 row_newbcast:12 row_mask:0xf bank_mask:0xf
    v_dot2c_f32_bf16_dpp v14, v26, v99 row_newbcast:12 row_mask:0xf bank_mask:0xf
    v_dot2c_f32_bf16_dpp v15, v27, v99 row_newbcast:12 row_mask:0xf bank_mask:0xf
    s_waitcnt vmcnt(4)
    buffer_load_dwordx4 v[56:59], v3, s[24:27], 0 offen offset:0 nt
    buffer_load_dwordx4 v[60:63], v3, s[24:27], 0 offen offset:1024 nt
    v_dot2c_f32_bf16_dpp v8, v26, v100 row_newbcast:13 row_mask:0xf bank_mask:0xf
    v_dot2c_f32_bf16_dpp v9, v27, v100 row_newbcast:13 row_mask:0xf bank_mask:0xf
    v_dot2c_f32_bf16_dpp v10, v26, v101 row_newbcast:13 row_mask:0xf bank_mask:0xf
    v_dot2c_f32_bf16_dpp v11, v27, v101 row_newbcast:13 row_mask:0xf bank_mask:0xf
    v_dot2c_f32_bf16_dpp v12, v26, v102 row_newbcast:13 row_mask:0xf bank_mask:0xf
    v_dot2c_f32_bf16_dpp v13, v27, v102 row_newbcast:13 row_mask:0xf bank_mask:0xf
    v_dot2c_f32_bf16_dpp v14, v26, v103 row_newbcast:13 row_mask:0xf bank_mask:0xf
    v_dot2c_f32_bf16_dpp v15, v27, v103 row_newbcast:13 row_mask:0xf bank_mask:0xf
    v_perm_b32 v29, v124, v120, s72
    v_perm_b32 v124, v124, v120, s73
    v_mov_b32 v120, v29
    v_perm_b32 v29, v125, v121, s72
    v_perm_b32 v125, v125, v121, s73
    v_mov_b32 v121, v29
    v_perm_b32 v29, v126, v122, s72
    v_perm_b32 v126, v126, v122, s73
    v_mov_b32 v122, v29
    v_perm_b32 v29, v127, v123, s72
    v_perm_b32 v127, v127, v123, s73
    v_mov_b32 v123, v29
    s_waitcnt vmcnt(5)
    s_mov_b32 s64, 32768
    buffer_load_dwordx4 v[136:139], v36, s[36:39], s64 offen
    s_mov_b32 s64, 33792
    buffer_load_dwordx4 v[140:143], v36, s[36:39], s64 offen
    v_dot2_f32_bf16 v16, v40, v4, 0
    v_dot2_f32_bf16 v16, v41, v5, v16
    v_dot2_f32_bf16 v16, v42, v6, v16
    v_dot2_f32_bf16 v16, v43, v7, v16
    s_waitcnt vmcnt(6)
    buffer_load_dwordx4 v[64:67], v3, s[24:27], 0 offen offset:2048 nt
    v_dot2_f32_bf16 v17, v44, v4, 0
    v_dot2_f32_bf16 v17, v45, v5, v17
    v_dot2_f32_bf16 v17, v46, v6, v17
    v_dot2_f32_bf16 v17, v47, v7, v17
    s_waitcnt vmcnt(6)
    buffer_load_dwordx4 v[68:71], v3, s[24:27], 0 offen offset:3072 nt
    v_dot2_f32_bf16 v18, v48, v4, 0
    v_dot2_f32_bf16 v18, v49, v5, v18
    v_dot2_f32_bf16 v18, v50, v6, v18
    v_dot2_f32_bf16 v18, v51, v7, v18
    s_waitcnt vmcnt(6)
    buffer_load_dwordx4 v[72:75], v2, s[28:31], 0 offen offset:0 nt
    v_dot2_f32_bf16 v19, v52, v4, 0
    v_dot2_f32_bf16 v19, v53, v5, v19
    v_dot2_f32_bf16 v19, v54, v6, v19
    v_dot2_f32_bf16 v19, v55, v7, v19
    s_waitcnt vmcnt(6)
    buffer_load_dwordx4 v[76:79], v2, s[28:31], 0 offen offset:1024 nt
    v_dot2_f32_bf16 v20, v56, v4, 0
    v_dot2_f32_bf16 v20, v57, v5, v20
    v_dot2_f32_bf16 v20, v58, v6, v20
    v_dot2_f32_bf16 v20, v59, v7, v20
    s_waitcnt vmcnt(6)
    buffer_load_dwordx4 v[80:83], v2, s[28:31], 0 offen offset:2048 nt
    v_dot2_f32_bf16 v21, v60, v4, 0
    v_dot2_f32_bf16 v21, v61, v5, v21
    v_dot2_f32_bf16 v21, v62, v6, v21
    v_dot2_f32_bf16 v21, v63, v7, v21
    s_waitcnt vmcnt(4)
    buffer_load_dwordx4 v[84:87], v2, s[28:31], 0 offen offset:3072 nt
    v_dot2_f32_bf16 v22, v64, v4, 0
    v_dot2_f32_bf16 v22, v65, v5, v22
    v_dot2_f32_bf16 v22, v66, v6, v22
    v_dot2_f32_bf16 v22, v67, v7, v22
    s_waitcnt vmcnt(4)
    buffer_load_dwordx4 v[88:91], v3, s[28:31], 0 offen offset:0 nt
    buffer_load_dwordx4 v[92:95], v3, s[28:31], 0 offen offset:1024 nt
    v_dot2_f32_bf16 v23, v68, v4, 0
    v_dot2_f32_bf16 v23, v69, v5, v23
    v_dot2_f32_bf16 v23, v70, v6, v23
    v_dot2_f32_bf16 v23, v71, v7, v23
    s_nop 2
    v_add_f32_dpp v16, v16, v16 row_ror:8 row_mask:0xf bank_mask:0x3
    v_add_f32_dpp v17, v17, v17 row_ror:8 row_mask:0xf bank_mask:0x3
    v_add_f32_dpp v18, v18, v18 row_ror:8 row_mask:0xf bank_mask:0x3
    v_add_f32_dpp v19, v19, v19 row_ror:8 row_mask:0xf bank_mask:0x3
    v_add_f32_dpp v16, v20, v20 row_ror:8 row_mask:0xf bank_mask:0xc
    v_add_f32_dpp v17, v21, v21 row_ror:8 row_mask:0xf bank_mask:0xc
    v_add_f32_dpp v18, v22, v22 row_ror:8 row_mask:0xf bank_mask:0xc
    v_add_f32_dpp v19, v23, v23 row_ror:8 row_mask:0xf bank_mask:0xc
    v_add_f32_dpp v16, v16, v16 row_half_mirror row_mask:0xf bank_mask:0x5
    v_add_f32_dpp v17, v17, v17 row_half_mirror row_mask:0xf bank_mask:0x5
    v_add_f32_dpp v16, v18, v18 row_half_mirror row_mask:0xf bank_mask:0xa
    v_add_f32_dpp v17, v19, v19 row_half_mirror row_mask:0xf bank_mask:0xa
    s_nop 0
    v_add_f32_dpp v16, v16, v16 quad_perm:[1,0,3,2] row_mask:0xf bank_mask:0xf
    v_add_f32_dpp v17, v17, v17 quad_perm:[1,0,3,2] row_mask:0xf bank_mask:0xf
    s_nop 0
    v_cndmask_b32 v29, v16, v17, s[76:77]
    s_nop 1
    v_add_f32_dpp v29, v29, v29 quad_perm:[2,3,0,1] row_mask:0xf bank_mask:0xf
    v_mul_f32 v29, s74, v29
    s_nop 1
    v_max_f32_dpp v30, v29, v29 quad_perm:[1,0,3,2] row_mask:0xf bank_mask:0xf
    s_nop 1
    v_max_f32_dpp v30, v30, v30 row_ror:4 row_mask:0xf bank_mask:0xf
    s_nop 1
    v_max_f32_dpp v30, v30, v30 row_ror:8 row_mask:0xf bank_mask:0xf
    v_max_f32 v30, v30, v24
    v_sub_f32 v28, v24, v30
    v_sub_f32 v29, v29, v30
    v_exp_f32 v28, v28
    v_exp_f32 v29, v29
    v_mov_b32 v24, v30
    v_cvt_pk_bf16_f32 v26, v29, 0
    v_cvt_pk_bf16_f32 v27, 0, v29
    v_fma_f32 v25, v25, v28, v29
    v_mul_f32 v8, v28, v8
    v_mul_f32 v9, v28, v9
    v_mul_f32 v10, v28, v10
    v_mul_f32 v11, v28, v11
    v_mul_f32 v12, v28, v12
    v_mul_f32 v13, v28, v13
    v_mul_f32 v14, v28, v14
    v_mul_f32 v15, v28, v15
    s_waitcnt vmcnt(5)
    v_dot2c_f32_bf16_dpp v8, v26, v72 row_newbcast:0 row_mask:0xf bank_mask:0xf
    v_dot2c_f32_bf16_dpp v9, v27, v72 row_newbcast:0 row_mask:0xf bank_mask:0xf
    v_dot2c_f32_bf16_dpp v10, v26, v73 row_newbcast:0 row_mask:0xf bank_mask:0xf
    v_dot2c_f32_bf16_dpp v11, v27, v73 row_newbcast:0 row_mask:0xf bank_mask:0xf
    v_dot2c_f32_bf16_dpp v12, v26, v74 row_newbcast:0 row_mask:0xf bank_mask:0xf
    v_dot2c_f32_bf16_dpp v13, v27, v74 row_newbcast:0 row_mask:0xf bank_mask:0xf
    v_dot2c_f32_bf16_dpp v14, v26, v75 row_newbcast:0 row_mask:0xf bank_mask:0xf
    v_dot2c_f32_bf16_dpp v15, v27, v75 row_newbcast:0 row_mask:0xf bank_mask:0xf
    s_waitcnt vmcnt(4)
    buffer_load_dwordx4 v[96:99], v3, s[28:31], 0 offen offset:2048 nt
    v_dot2c_f32_bf16_dpp v8, v26, v76 row_newbcast:1 row_mask:0xf bank_mask:0xf
    v_dot2c_f32_bf16_dpp v9, v27, v76 row_newbcast:1 row_mask:0xf bank_mask:0xf
    v_dot2c_f32_bf16_dpp v10, v26, v77 row_newbcast:1 row_mask:0xf bank_mask:0xf
    v_dot2c_f32_bf16_dpp v11, v27, v77 row_newbcast:1 row_mask:0xf bank_mask:0xf
    v_dot2c_f32_bf16_dpp v12, v26, v78 row_newbcast:1 row_mask:0xf bank_mask:0xf
    v_dot2c_f32_bf16_dpp v13, v27, v78 row_newbcast:1 row_mask:0xf bank_mask:0xf
    v_dot2c_f32_bf16_dpp v14, v26, v79 row_newbcast:1 row_mask:0xf bank_mask:0xf
    v_dot2c_f32_bf16_dpp v15, v27, v79 row_newbcast:1 row_mask:0xf bank_mask:0xf
    s_waitcnt vmcnt(4)
    buffer_load_dwordx4 v[100:103], v3, s[28:31], 0 offen offset:3072 nt
    v_dot2c_f32_bf16_dpp v8, v26, v80 row_newbcast:4 row_mask:0xf bank_mask:0xf
    v_dot2c_f32_bf16_dpp v9, v27, v80 row_newbcast:4 row_mask:0xf bank_mask:0xf
    v_dot2c_f32_bf16_dpp v10, v26, v81 row_newbcast:4 row_mask:0xf bank_mask:0xf
    v_dot2c_f32_bf16_dpp v11, v27, v81 row_newbcast:4 row_mask:0xf bank_mask:0xf
    v_dot2c_f32_bf16_dpp v12, v26, v82 row_newbcast:4 row_mask:0xf bank_mask:0xf
    v_dot2c_f32_bf16_dpp v13, v27, v82 row_newbcast:4 row_mask:0xf bank_mask:0xf
    v_dot2c_f32_bf16_dpp v14, v26, v83 row_newbcast:4 row_mask:0xf bank_mask:0xf
    v_dot2c_f32_bf16_dpp v15, v27, v83 row_newbcast:4 row_mask:0xf bank_mask:0xf
    s_waitcnt vmcnt(4)
    v_add_u32 v2, 0x8000, v2
    v_add_u32 v3, 0x8000, v3
    buffer_load_dwordx4 v[40:43], v2, s[24:27], 0 offen offset:0 nt
    v_dot2c_f32_bf16_dpp v8, v26, v84 row_newbcast:5 row_mask:0xf bank_mask:0xf
    v_dot2c_f32_bf16_dpp v9, v27, v84 row_newbcast:5 row_mask:0xf bank_mask:0xf
    v_dot2c_f32_bf16_dpp v10, v26, v85 row_newbcast:5 row_mask:0xf bank_mask:0xf
    v_dot2c_f32_bf16_dpp v11, v27, v85 row_newbcast:5 row_mask:0xf bank_mask:0xf
    v_dot2c_f32_bf16_dpp v12, v26, v86 row_newbcast:5 row_mask:0xf bank_mask:0xf
    v_dot2c_f32_bf16_dpp v13, v27, v86 row_newbcast:5 row_mask:0xf bank_mask:0xf
    v_dot2c_f32_bf16_dpp v14, v26, v87 row_newbcast:5 row_mask:0xf bank_mask:0xf
    v_dot2c_f32_bf16_dpp v15, v27, v87 row_newbcast:5 row_mask:0xf bank_mask:0xf
    s_waitcnt vmcnt(4)
    buffer_load_dwordx4 v[44:47], v2, s[24:27], 0 offen offset:1024 nt
    v_dot2c_f32_bf16_dpp v8, v26, v88 row_newbcast:8 row_mask:0xf bank_mask:0xf
    v_dot2c_f32_bf16_dpp v9, v27, v88 row_newbcast:8 row_mask:0xf bank_mask:0xf
    v_dot2c_f32_bf16_dpp v10, v26, v89 row_newbcast:8 row_mask:0xf bank_mask:0xf
    v_dot2c_f32_bf16_dpp v11, v27, v89 row_newbcast:8 row_mask:0xf bank_mask:0xf
    v_dot2c_f32_bf16_dpp v12, v26, v90 row_newbcast:8 row_mask:0xf bank_mask:0xf
    v_dot2c_f32_bf16_dpp v13, v27, v90 row_newbcast:8 row_mask:0xf bank_mask:0xf
    v_dot2c_f32_bf16_dpp v14, v26, v91 row_newbcast:8 row_mask:0xf bank_mask:0xf
    v_dot2c_f32_bf16_dpp v15, v27, v91 row_newbcast:8 row_mask:0xf bank_mask:0xf
    s_waitcnt vmcnt(4)
    buffer_load_dwordx4 v[48:51], v2, s[24:27], 0 offen offset:2048 nt
    v_dot2c_f32_bf16_dpp v8, v26, v92 row_newbcast:9 row_mask:0xf bank_mask:0xf
    v_dot2c_f32_bf16_dpp v9, v27, v92 row_newbcast:9 row_mask:0xf bank_mask:0xf
    v_dot2c_f32_bf16_dpp v10, v26, v93 row_newbcast:9 row_mask:0xf bank_mask:0xf
    v_dot2c_f32_bf16_dpp v11, v27, v93 row_newbcast:9 row_mask:0xf bank_mask:0xf
    v_dot2c_f32_bf16_dpp v12, v26, v94 row_newbcast:9 row_mask:0xf bank_mask:0xf
    v_dot2c_f32_bf16_dpp v13, v27, v94 row_newbcast:9 row_mask:0xf bank_mask:0xf
    v_dot2c_f32_bf16_dpp v14, v26, v95 row_newbcast:9 row_mask:0xf bank_mask:0xf
    v_dot2c_f32_bf16_dpp v15, v27, v95 row_newbcast:9 row_mask:0xf bank_mask:0xf
    s_waitcnt vmcnt(4)
    buffer_load_dwordx4 v[52:55], v2, s[24:27], 0 offen offset:3072 nt
    v_dot2c_f32_bf16_dpp v8, v26, v96 row_newbcast:12 row_mask:0xf bank_mask:0xf
    v_dot2c_f32_bf16_dpp v9, v27, v96 row_newbcast:12 row_mask:0xf bank_mask:0xf
    v_dot2c_f32_bf16_dpp v10, v26, v97 row_newbcast:12 row_mask:0xf bank_mask:0xf
    v_dot2c_f32_bf16_dpp v11, v27, v97 row_newbcast:12 row_mask:0xf bank_mask:0xf
    v_dot2c_f32_bf16_dpp v12, v26, v98 row_newbcast:12 row_mask:0xf bank_mask:0xf
    v_dot2c_f32_bf16_dpp v13, v27, v98 row_newbcast:12 row_mask:0xf bank_mask:0xf
    v_dot2c_f32_bf16_dpp v14, v26, v99 row_newbcast:12 row_mask:0xf bank_mask:0xf
    v_dot2c_f32_bf16_dpp v15, v27, v99 row_newbcast:12 row_mask:0xf bank_mask:0xf
    s_waitcnt vmcnt(4)
    buffer_load_dwordx4 v[56:59], v3, s[24:27], 0 offen offset:0 nt
    buffer_load_dwordx4 v[60:63], v3, s[24:27], 0 offen offset:1024 nt
    v_dot2c_f32_bf16_dpp v8, v26, v100 row_newbcast:13 row_mask:0xf bank_mask:0xf
    v_dot2c_f32_bf16_dpp v9, v27, v100 row_newbcast:13 row_mask:0xf bank_mask:0xf
    v_dot2c_f32_bf16_dpp v10, v26, v101 row_newbcast:13 row_mask:0xf bank_mask:0xf
    v_dot2c_f32_bf16_dpp v11, v27, v101 row_newbcast:13 row_mask:0xf bank_mask:0xf
    v_dot2c_f32_bf16_dpp v12, v26, v102 row_newbcast:13 row_mask:0xf bank_mask:0xf
    v_dot2c_f32_bf16_dpp v13, v27, v102 row_newbcast:13 row_mask:0xf bank_mask:0xf
    v_dot2c_f32_bf16_dpp v14, v26, v103 row_newbcast:13 row_mask:0xf bank_mask:0xf
    v_dot2c_f32_bf16_dpp v15, v27, v103 row_newbcast:13 row_mask:0xf bank_mask:0xf
    v_perm_b32 v29, v132, v128, s72
    v_perm_b32 v132, v132, v128, s73
    v_mov_b32 v128, v29
    v_perm_b32 v29, v133, v129, s72
    v_perm_b32 v133, v133, v129, s73
    v_mov_b32 v129, v29
    v_perm_b32 v29, v134, v130, s72
    v_perm_b32 v134, v134, v130, s73
    v_mov_b32 v130, v29
    v_perm_b32 v29, v135, v131, s72
    v_perm_b32 v135, v135, v131, s73
    v_mov_b32 v131, v29
    s_waitcnt vmcnt(5)
    s_mov_b32 s64, 40960
    buffer_load_dwordx4 v[144:147], v36, s[36:39], s64 offen
    s_mov_b32 s64, 41984
    buffer_load_dwordx4 v[148:151], v36, s[36:39], s64 offen
    v_dot2_f32_bf16 v16, v40, v4, 0
    v_dot2_f32_bf16 v16, v41, v5, v16
    v_dot2_f32_bf16 v16, v42, v6, v16
    v_dot2_f32_bf16 v16, v43, v7, v16
    s_waitcnt vmcnt(6)
    buffer_load_dwordx4 v[64:67], v3, s[24:27], 0 offen offset:2048 nt
    v_dot2_f32_bf16 v17, v44, v4, 0
    v_dot2_f32_bf16 v17, v45, v5, v17
    v_dot2_f32_bf16 v17, v46, v6, v17
    v_dot2_f32_bf16 v17, v47, v7, v17
    s_waitcnt vmcnt(6)
    buffer_load_dwordx4 v[68:71], v3, s[24:27], 0 offen offset:3072 nt
    v_dot2_f32_bf16 v18, v48, v4, 0
    v_dot2_f32_bf16 v18, v49, v5, v18
    v_dot2_f32_bf16 v18, v50, v6, v18
    v_dot2_f32_bf16 v18, v51, v7, v18
    s_waitcnt vmcnt(6)
    buffer_load_dwordx4 v[72:75], v2, s[28:31], 0 offen offset:0 nt
    v_dot2_f32_bf16 v19, v52, v4, 0
    v_dot2_f32_bf16 v19, v53, v5, v19
    v_dot2_f32_bf16 v19, v54, v6, v19
    v_dot2_f32_bf16 v19, v55, v7, v19
    s_waitcnt vmcnt(6)
    buffer_load_dwordx4 v[76:79], v2, s[28:31], 0 offen offset:1024 nt
    v_dot2_f32_bf16 v20, v56, v4, 0
    v_dot2_f32_bf16 v20, v57, v5, v20
    v_dot2_f32_bf16 v20, v58, v6, v20
    v_dot2_f32_bf16 v20, v59, v7, v20
    s_waitcnt vmcnt(6)
    buffer_load_dwordx4 v[80:83], v2, s[28:31], 0 offen offset:2048 nt
    v_dot2_f32_bf16 v21, v60, v4, 0
    v_dot2_f32_bf16 v21, v61, v5, v21
    v_dot2_f32_bf16 v21, v62, v6, v21
    v_dot2_f32_bf16 v21, v63, v7, v21
    s_waitcnt vmcnt(4)
    buffer_load_dwordx4 v[84:87], v2, s[28:31], 0 offen offset:3072 nt
    v_dot2_f32_bf16 v22, v64, v4, 0
    v_dot2_f32_bf16 v22, v65, v5, v22
    v_dot2_f32_bf16 v22, v66, v6, v22
    v_dot2_f32_bf16 v22, v67, v7, v22
    s_waitcnt vmcnt(4)
    buffer_load_dwordx4 v[88:91], v3, s[28:31], 0 offen offset:0 nt
    buffer_load_dwordx4 v[92:95], v3, s[28:31], 0 offen offset:1024 nt
    v_dot2_f32_bf16 v23, v68, v4, 0
    v_dot2_f32_bf16 v23, v69, v5, v23
    v_dot2_f32_bf16 v23, v70, v6, v23
    v_dot2_f32_bf16 v23, v71, v7, v23
    s_nop 2
    v_add_f32_dpp v16, v16, v16 row_ror:8 row_mask:0xf bank_mask:0x3
    v_add_f32_dpp v17, v17, v17 row_ror:8 row_mask:0xf bank_mask:0x3
    v_add_f32_dpp v18, v18, v18 row_ror:8 row_mask:0xf bank_mask:0x3
    v_add_f32_dpp v19, v19, v19 row_ror:8 row_mask:0xf bank_mask:0x3
    v_add_f32_dpp v16, v20, v20 row_ror:8 row_mask:0xf bank_mask:0xc
    v_add_f32_dpp v17, v21, v21 row_ror:8 row_mask:0xf bank_mask:0xc
    v_add_f32_dpp v18, v22, v22 row_ror:8 row_mask:0xf bank_mask:0xc
    v_add_f32_dpp v19, v23, v23 row_ror:8 row_mask:0xf bank_mask:0xc
    v_add_f32_dpp v16, v16, v16 row_half_mirror row_mask:0xf bank_mask:0x5
    v_add_f32_dpp v17, v17, v17 row_half_mirror row_mask:0xf bank_mask:0x5
    v_add_f32_dpp v16, v18, v18 row_half_mirror row_mask:0xf bank_mask:0xa
    v_add_f32_dpp v17, v19, v19 row_half_mirror row_mask:0xf bank_mask:0xa
    s_nop 0
    v_add_f32_dpp v16, v16, v16 quad_perm:[1,0,3,2] row_mask:0xf bank_mask:0xf
    v_add_f32_dpp v17, v17, v17 quad_perm:[1,0,3,2] row_mask:0xf bank_mask:0xf
    s_nop 0
    v_cndmask_b32 v29, v16, v17, s[76:77]
    s_nop 1
    v_add_f32_dpp v29, v29, v29 quad_perm:[2,3,0,1] row_mask:0xf bank_mask:0xf
    v_mul_f32 v29, s74, v29
    s_nop 1
    v_max_f32_dpp v30, v29, v29 quad_perm:[1,0,3,2] row_mask:0xf bank_mask:0xf
    s_nop 1
    v_max_f32_dpp v30, v30, v30 row_ror:4 row_mask:0xf bank_mask:0xf
    s_nop 1
    v_max_f32_dpp v30, v30, v30 row_ror:8 row_mask:0xf bank_mask:0xf
    v_max_f32 v30, v30, v24
    v_sub_f32 v28, v24, v30
    v_sub_f32 v29, v29, v30
    v_exp_f32 v28, v28
    v_exp_f32 v29, v29
    v_mov_b32 v24, v30
    v_cvt_pk_bf16_f32 v26, v29, 0
    v_cvt_pk_bf16_f32 v27, 0, v29
    v_fma_f32 v25, v25, v28, v29
    v_mul_f32 v8, v28, v8
    v_mul_f32 v9, v28, v9
    v_mul_f32 v10, v28, v10
    v_mul_f32 v11, v28, v11
    v_mul_f32 v12, v28, v12
    v_mul_f32 v13, v28, v13
    v_mul_f32 v14, v28, v14
    v_mul_f32 v15, v28, v15
    s_waitcnt vmcnt(5)
    v_dot2c_f32_bf16_dpp v8, v26, v72 row_newbcast:0 row_mask:0xf bank_mask:0xf
    v_dot2c_f32_bf16_dpp v9, v27, v72 row_newbcast:0 row_mask:0xf bank_mask:0xf
    v_dot2c_f32_bf16_dpp v10, v26, v73 row_newbcast:0 row_mask:0xf bank_mask:0xf
    v_dot2c_f32_bf16_dpp v11, v27, v73 row_newbcast:0 row_mask:0xf bank_mask:0xf
    v_dot2c_f32_bf16_dpp v12, v26, v74 row_newbcast:0 row_mask:0xf bank_mask:0xf
    v_dot2c_f32_bf16_dpp v13, v27, v74 row_newbcast:0 row_mask:0xf bank_mask:0xf
    v_dot2c_f32_bf16_dpp v14, v26, v75 row_newbcast:0 row_mask:0xf bank_mask:0xf
    v_dot2c_f32_bf16_dpp v15, v27, v75 row_newbcast:0 row_mask:0xf bank_mask:0xf
    s_waitcnt vmcnt(4)
    buffer_load_dwordx4 v[96:99], v3, s[28:31], 0 offen offset:2048 nt
    v_dot2c_f32_bf16_dpp v8, v26, v76 row_newbcast:1 row_mask:0xf bank_mask:0xf
    v_dot2c_f32_bf16_dpp v9, v27, v76 row_newbcast:1 row_mask:0xf bank_mask:0xf
    v_dot2c_f32_bf16_dpp v10, v26, v77 row_newbcast:1 row_mask:0xf bank_mask:0xf
    v_dot2c_f32_bf16_dpp v11, v27, v77 row_newbcast:1 row_mask:0xf bank_mask:0xf
    v_dot2c_f32_bf16_dpp v12, v26, v78 row_newbcast:1 row_mask:0xf bank_mask:0xf
    v_dot2c_f32_bf16_dpp v13, v27, v78 row_newbcast:1 row_mask:0xf bank_mask:0xf
    v_dot2c_f32_bf16_dpp v14, v26, v79 row_newbcast:1 row_mask:0xf bank_mask:0xf
    v_dot2c_f32_bf16_dpp v15, v27, v79 row_newbcast:1 row_mask:0xf bank_mask:0xf
    s_waitcnt vmcnt(4)
    buffer_load_dwordx4 v[100:103], v3, s[28:31], 0 offen offset:3072 nt
    v_dot2c_f32_bf16_dpp v8, v26, v80 row_newbcast:4 row_mask:0xf bank_mask:0xf
    v_dot2c_f32_bf16_dpp v9, v27, v80 row_newbcast:4 row_mask:0xf bank_mask:0xf
    v_dot2c_f32_bf16_dpp v10, v26, v81 row_newbcast:4 row_mask:0xf bank_mask:0xf
    v_dot2c_f32_bf16_dpp v11, v27, v81 row_newbcast:4 row_mask:0xf bank_mask:0xf
    v_dot2c_f32_bf16_dpp v12, v26, v82 row_newbcast:4 row_mask:0xf bank_mask:0xf
    v_dot2c_f32_bf16_dpp v13, v27, v82 row_newbcast:4 row_mask:0xf bank_mask:0xf
    v_dot2c_f32_bf16_dpp v14, v26, v83 row_newbcast:4 row_mask:0xf bank_mask:0xf
    v_dot2c_f32_bf16_dpp v15, v27, v83 row_newbcast:4 row_mask:0xf bank_mask:0xf
    s_waitcnt vmcnt(4)
    v_add_u32 v2, 0x8000, v2
    v_add_u32 v3, 0x8000, v3
    buffer_load_dwordx4 v[40:43], v2, s[24:27], 0 offen offset:0 nt
    v_dot2c_f32_bf16_dpp v8, v26, v84 row_newbcast:5 row_mask:0xf bank_mask:0xf
    v_dot2c_f32_bf16_dpp v9, v27, v84 row_newbcast:5 row_mask:0xf bank_mask:0xf
    v_dot2c_f32_bf16_dpp v10, v26, v85 row_newbcast:5 row_mask:0xf bank_mask:0xf
    v_dot2c_f32_bf16_dpp v11, v27, v85 row_newbcast:5 row_mask:0xf bank_mask:0xf
    v_dot2c_f32_bf16_dpp v12, v26, v86 row_newbcast:5 row_mask:0xf bank_mask:0xf
    v_dot2c_f32_bf16_dpp v13, v27, v86 row_newbcast:5 row_mask:0xf bank_mask:0xf
    v_dot2c_f32_bf16_dpp v14, v26, v87 row_newbcast:5 row_mask:0xf bank_mask:0xf
    v_dot2c_f32_bf16_dpp v15, v27, v87 row_newbcast:5 row_mask:0xf bank_mask:0xf
    s_waitcnt vmcnt(4)
    buffer_load_dwordx4 v[44:47], v2, s[24:27], 0 offen offset:1024 nt
    v_dot2c_f32_bf16_dpp v8, v26, v88 row_newbcast:8 row_mask:0xf bank_mask:0xf
    v_dot2c_f32_bf16_dpp v9, v27, v88 row_newbcast:8 row_mask:0xf bank_mask:0xf
    v_dot2c_f32_bf16_dpp v10, v26, v89 row_newbcast:8 row_mask:0xf bank_mask:0xf
    v_dot2c_f32_bf16_dpp v11, v27, v89 row_newbcast:8 row_mask:0xf bank_mask:0xf
    v_dot2c_f32_bf16_dpp v12, v26, v90 row_newbcast:8 row_mask:0xf bank_mask:0xf
    v_dot2c_f32_bf16_dpp v13, v27, v90 row_newbcast:8 row_mask:0xf bank_mask:0xf
    v_dot2c_f32_bf16_dpp v14, v26, v91 row_newbcast:8 row_mask:0xf bank_mask:0xf
    v_dot2c_f32_bf16_dpp v15, v27, v91 row_newbcast:8 row_mask:0xf bank_mask:0xf
    s_waitcnt vmcnt(4)
    buffer_load_dwordx4 v[48:51], v2, s[24:27], 0 offen offset:2048 nt
    v_dot2c_f32_bf16_dpp v8, v26, v92 row_newbcast:9 row_mask:0xf bank_mask:0xf
    v_dot2c_f32_bf16_dpp v9, v27, v92 row_newbcast:9 row_mask:0xf bank_mask:0xf
    v_dot2c_f32_bf16_dpp v10, v26, v93 row_newbcast:9 row_mask:0xf bank_mask:0xf
    v_dot2c_f32_bf16_dpp v11, v27, v93 row_newbcast:9 row_mask:0xf bank_mask:0xf
    v_dot2c_f32_bf16_dpp v12, v26, v94 row_newbcast:9 row_mask:0xf bank_mask:0xf
    v_dot2c_f32_bf16_dpp v13, v27, v94 row_newbcast:9 row_mask:0xf bank_mask:0xf
    v_dot2c_f32_bf16_dpp v14, v26, v95 row_newbcast:9 row_mask:0xf bank_mask:0xf
    v_dot2c_f32_bf16_dpp v15, v27, v95 row_newbcast:9 row_mask:0xf bank_mask:0xf
    s_waitcnt vmcnt(4)
    buffer_load_dwordx4 v[52:55], v2, s[24:27], 0 offen offset:3072 nt
    v_dot2c_f32_bf16_dpp v8, v26, v96 row_newbcast:12 row_mask:0xf bank_mask:0xf
    v_dot2c_f32_bf16_dpp v9, v27, v96 row_newbcast:12 row_mask:0xf bank_mask:0xf
    v_dot2c_f32_bf16_dpp v10, v26, v97 row_newbcast:12 row_mask:0xf bank_mask:0xf
    v_dot2c_f32_bf16_dpp v11, v27, v97 row_newbcast:12 row_mask:0xf bank_mask:0xf
    v_dot2c_f32_bf16_dpp v12, v26, v98 row_newbcast:12 row_mask:0xf bank_mask:0xf
    v_dot2c_f32_bf16_dpp v13, v27, v98 row_newbcast:12 row_mask:0xf bank_mask:0xf
    v_dot2c_f32_bf16_dpp v14, v26, v99 row_newbcast:12 row_mask:0xf bank_mask:0xf
    v_dot2c_f32_bf16_dpp v15, v27, v99 row_newbcast:12 row_mask:0xf bank_mask:0xf
    s_waitcnt vmcnt(4)
    buffer_load_dwordx4 v[56:59], v3, s[24:27], 0 offen offset:0 nt
    buffer_load_dwordx4 v[60:63], v3, s[24:27], 0 offen offset:1024 nt
    v_dot2c_f32_bf16_dpp v8, v26, v100 row_newbcast:13 row_mask:0xf bank_mask:0xf
    v_dot2c_f32_bf16_dpp v9, v27, v100 row_newbcast:13 row_mask:0xf bank_mask:0xf
    v_dot2c_f32_bf16_dpp v10, v26, v101 row_newbcast:13 row_mask:0xf bank_mask:0xf
    v_dot2c_f32_bf16_dpp v11, v27, v101 row_newbcast:13 row_mask:0xf bank_mask:0xf
    v_dot2c_f32_bf16_dpp v12, v26, v102 row_newbcast:13 row_mask:0xf bank_mask:0xf
    v_dot2c_f32_bf16_dpp v13, v27, v102 row_newbcast:13 row_mask:0xf bank_mask:0xf
    v_dot2c_f32_bf16_dpp v14, v26, v103 row_newbcast:13 row_mask:0xf bank_mask:0xf
    v_dot2c_f32_bf16_dpp v15, v27, v103 row_newbcast:13 row_mask:0xf bank_mask:0xf
    v_perm_b32 v29, v140, v136, s72
    v_perm_b32 v140, v140, v136, s73
    v_mov_b32 v136, v29
    v_perm_b32 v29, v141, v137, s72
    v_perm_b32 v141, v141, v137, s73
    v_mov_b32 v137, v29
    v_perm_b32 v29, v142, v138, s72
    v_perm_b32 v142, v142, v138, s73
    v_mov_b32 v138, v29
    v_perm_b32 v29, v143, v139, s72
    v_perm_b32 v143, v143, v139, s73
    v_mov_b32 v139, v29
    s_waitcnt vmcnt(5)
    s_mov_b32 s64, 49152
    buffer_load_dwordx4 v[152:155], v36, s[36:39], s64 offen
    s_mov_b32 s64, 50176
    buffer_load_dwordx4 v[156:159], v36, s[36:39], s64 offen
    v_dot2_f32_bf16 v16, v40, v4, 0
    v_dot2_f32_bf16 v16, v41, v5, v16
    v_dot2_f32_bf16 v16, v42, v6, v16
    v_dot2_f32_bf16 v16, v43, v7, v16
    s_waitcnt vmcnt(6)
    buffer_load_dwordx4 v[64:67], v3, s[24:27], 0 offen offset:2048 nt
    v_dot2_f32_bf16 v17, v44, v4, 0
    v_dot2_f32_bf16 v17, v45, v5, v17
    v_dot2_f32_bf16 v17, v46, v6, v17
    v_dot2_f32_bf16 v17, v47, v7, v17
    s_waitcnt vmcnt(6)
    buffer_load_dwordx4 v[68:71], v3, s[24:27], 0 offen offset:3072 nt
    v_dot2_f32_bf16 v18, v48, v4, 0
    v_dot2_f32_bf16 v18, v49, v5, v18
    v_dot2_f32_bf16 v18, v50, v6, v18
    v_dot2_f32_bf16 v18, v51, v7, v18
    s_waitcnt vmcnt(6)
    buffer_load_dwordx4 v[72:75], v2, s[28:31], 0 offen offset:0 nt
    v_dot2_f32_bf16 v19, v52, v4, 0
    v_dot2_f32_bf16 v19, v53, v5, v19
    v_dot2_f32_bf16 v19, v54, v6, v19
    v_dot2_f32_bf16 v19, v55, v7, v19
    s_waitcnt vmcnt(6)
    buffer_load_dwordx4 v[76:79], v2, s[28:31], 0 offen offset:1024 nt
    v_dot2_f32_bf16 v20, v56, v4, 0
    v_dot2_f32_bf16 v20, v57, v5, v20
    v_dot2_f32_bf16 v20, v58, v6, v20
    v_dot2_f32_bf16 v20, v59, v7, v20
    s_waitcnt vmcnt(6)
    buffer_load_dwordx4 v[80:83], v2, s[28:31], 0 offen offset:2048 nt
    v_dot2_f32_bf16 v21, v60, v4, 0
    v_dot2_f32_bf16 v21, v61, v5, v21
    v_dot2_f32_bf16 v21, v62, v6, v21
    v_dot2_f32_bf16 v21, v63, v7, v21
    s_waitcnt vmcnt(4)
    buffer_load_dwordx4 v[84:87], v2, s[28:31], 0 offen offset:3072 nt
    v_dot2_f32_bf16 v22, v64, v4, 0
    v_dot2_f32_bf16 v22, v65, v5, v22
    v_dot2_f32_bf16 v22, v66, v6, v22
    v_dot2_f32_bf16 v22, v67, v7, v22
    s_waitcnt vmcnt(4)
    buffer_load_dwordx4 v[88:91], v3, s[28:31], 0 offen offset:0 nt
    buffer_load_dwordx4 v[92:95], v3, s[28:31], 0 offen offset:1024 nt
    v_dot2_f32_bf16 v23, v68, v4, 0
    v_dot2_f32_bf16 v23, v69, v5, v23
    v_dot2_f32_bf16 v23, v70, v6, v23
    v_dot2_f32_bf16 v23, v71, v7, v23
    s_nop 2
    v_add_f32_dpp v16, v16, v16 row_ror:8 row_mask:0xf bank_mask:0x3
    v_add_f32_dpp v17, v17, v17 row_ror:8 row_mask:0xf bank_mask:0x3
    v_add_f32_dpp v18, v18, v18 row_ror:8 row_mask:0xf bank_mask:0x3
    v_add_f32_dpp v19, v19, v19 row_ror:8 row_mask:0xf bank_mask:0x3
    v_add_f32_dpp v16, v20, v20 row_ror:8 row_mask:0xf bank_mask:0xc
    v_add_f32_dpp v17, v21, v21 row_ror:8 row_mask:0xf bank_mask:0xc
    v_add_f32_dpp v18, v22, v22 row_ror:8 row_mask:0xf bank_mask:0xc
    v_add_f32_dpp v19, v23, v23 row_ror:8 row_mask:0xf bank_mask:0xc
    v_add_f32_dpp v16, v16, v16 row_half_mirror row_mask:0xf bank_mask:0x5
    v_add_f32_dpp v17, v17, v17 row_half_mirror row_mask:0xf bank_mask:0x5
    v_add_f32_dpp v16, v18, v18 row_half_mirror row_mask:0xf bank_mask:0xa
    v_add_f32_dpp v17, v19, v19 row_half_mirror row_mask:0xf bank_mask:0xa
    s_nop 0
    v_add_f32_dpp v16, v16, v16 quad_perm:[1,0,3,2] row_mask:0xf bank_mask:0xf
    v_add_f32_dpp v17, v17, v17 quad_perm:[1,0,3,2] row_mask:0xf bank_mask:0xf
    s_nop 0
    v_cndmask_b32 v29, v16, v17, s[76:77]
    s_nop 1
    v_add_f32_dpp v29, v29, v29 quad_perm:[2,3,0,1] row_mask:0xf bank_mask:0xf
    v_mul_f32 v29, s74, v29
    s_nop 1
    v_max_f32_dpp v30, v29, v29 quad_perm:[1,0,3,2] row_mask:0xf bank_mask:0xf
    s_nop 1
    v_max_f32_dpp v30, v30, v30 row_ror:4 row_mask:0xf bank_mask:0xf
    s_nop 1
    v_max_f32_dpp v30, v30, v30 row_ror:8 row_mask:0xf bank_mask:0xf
    v_max_f32 v30, v30, v24
    v_sub_f32 v28, v24, v30
    v_sub_f32 v29, v29, v30
    v_exp_f32 v28, v28
    v_exp_f32 v29, v29
    v_mov_b32 v24, v30
    v_cvt_pk_bf16_f32 v26, v29, 0
    v_cvt_pk_bf16_f32 v27, 0, v29
    v_fma_f32 v25, v25, v28, v29
    v_mul_f32 v8, v28, v8
    v_mul_f32 v9, v28, v9
    v_mul_f32 v10, v28, v10
    v_mul_f32 v11, v28, v11
    v_mul_f32 v12, v28, v12
    v_mul_f32 v13, v28, v13
    v_mul_f32 v14, v28, v14
    v_mul_f32 v15, v28, v15
    s_waitcnt vmcnt(5)
    v_dot2c_f32_bf16_dpp v8, v26, v72 row_newbcast:0 row_mask:0xf bank_mask:0xf
    v_dot2c_f32_bf16_dpp v9, v27, v72 row_newbcast:0 row_mask:0xf bank_mask:0xf
    v_dot2c_f32_bf16_dpp v10, v26, v73 row_newbcast:0 row_mask:0xf bank_mask:0xf
    v_dot2c_f32_bf16_dpp v11, v27, v73 row_newbcast:0 row_mask:0xf bank_mask:0xf
    v_dot2c_f32_bf16_dpp v12, v26, v74 row_newbcast:0 row_mask:0xf bank_mask:0xf
    v_dot2c_f32_bf16_dpp v13, v27, v74 row_newbcast:0 row_mask:0xf bank_mask:0xf
    v_dot2c_f32_bf16_dpp v14, v26, v75 row_newbcast:0 row_mask:0xf bank_mask:0xf
    v_dot2c_f32_bf16_dpp v15, v27, v75 row_newbcast:0 row_mask:0xf bank_mask:0xf
    s_waitcnt vmcnt(4)
    buffer_load_dwordx4 v[96:99], v3, s[28:31], 0 offen offset:2048 nt
    v_dot2c_f32_bf16_dpp v8, v26, v76 row_newbcast:1 row_mask:0xf bank_mask:0xf
    v_dot2c_f32_bf16_dpp v9, v27, v76 row_newbcast:1 row_mask:0xf bank_mask:0xf
    v_dot2c_f32_bf16_dpp v10, v26, v77 row_newbcast:1 row_mask:0xf bank_mask:0xf
    v_dot2c_f32_bf16_dpp v11, v27, v77 row_newbcast:1 row_mask:0xf bank_mask:0xf
    v_dot2c_f32_bf16_dpp v12, v26, v78 row_newbcast:1 row_mask:0xf bank_mask:0xf
    v_dot2c_f32_bf16_dpp v13, v27, v78 row_newbcast:1 row_mask:0xf bank_mask:0xf
    v_dot2c_f32_bf16_dpp v14, v26, v79 row_newbcast:1 row_mask:0xf bank_mask:0xf
    v_dot2c_f32_bf16_dpp v15, v27, v79 row_newbcast:1 row_mask:0xf bank_mask:0xf
    s_waitcnt vmcnt(4)
    buffer_load_dwordx4 v[100:103], v3, s[28:31], 0 offen offset:3072 nt
    v_dot2c_f32_bf16_dpp v8, v26, v80 row_newbcast:4 row_mask:0xf bank_mask:0xf
    v_dot2c_f32_bf16_dpp v9, v27, v80 row_newbcast:4 row_mask:0xf bank_mask:0xf
    v_dot2c_f32_bf16_dpp v10, v26, v81 row_newbcast:4 row_mask:0xf bank_mask:0xf
    v_dot2c_f32_bf16_dpp v11, v27, v81 row_newbcast:4 row_mask:0xf bank_mask:0xf
    v_dot2c_f32_bf16_dpp v12, v26, v82 row_newbcast:4 row_mask:0xf bank_mask:0xf
    v_dot2c_f32_bf16_dpp v13, v27, v82 row_newbcast:4 row_mask:0xf bank_mask:0xf
    v_dot2c_f32_bf16_dpp v14, v26, v83 row_newbcast:4 row_mask:0xf bank_mask:0xf
    v_dot2c_f32_bf16_dpp v15, v27, v83 row_newbcast:4 row_mask:0xf bank_mask:0xf
    s_waitcnt vmcnt(4)
    v_add_u32 v2, 0x8000, v2
    v_add_u32 v3, 0x8000, v3
    buffer_load_dwordx4 v[40:43], v2, s[24:27], 0 offen offset:0 nt
    v_dot2c_f32_bf16_dpp v8, v26, v84 row_newbcast:5 row_mask:0xf bank_mask:0xf
    v_dot2c_f32_bf16_dpp v9, v27, v84 row_newbcast:5 row_mask:0xf bank_mask:0xf
    v_dot2c_f32_bf16_dpp v10, v26, v85 row_newbcast:5 row_mask:0xf bank_mask:0xf
    v_dot2c_f32_bf16_dpp v11, v27, v85 row_newbcast:5 row_mask:0xf bank_mask:0xf
    v_dot2c_f32_bf16_dpp v12, v26, v86 row_newbcast:5 row_mask:0xf bank_mask:0xf
    v_dot2c_f32_bf16_dpp v13, v27, v86 row_newbcast:5 row_mask:0xf bank_mask:0xf
    v_dot2c_f32_bf16_dpp v14, v26, v87 row_newbcast:5 row_mask:0xf bank_mask:0xf
    v_dot2c_f32_bf16_dpp v15, v27, v87 row_newbcast:5 row_mask:0xf bank_mask:0xf
    s_waitcnt vmcnt(4)
    buffer_load_dwordx4 v[44:47], v2, s[24:27], 0 offen offset:1024 nt
    v_dot2c_f32_bf16_dpp v8, v26, v88 row_newbcast:8 row_mask:0xf bank_mask:0xf
    v_dot2c_f32_bf16_dpp v9, v27, v88 row_newbcast:8 row_mask:0xf bank_mask:0xf
    v_dot2c_f32_bf16_dpp v10, v26, v89 row_newbcast:8 row_mask:0xf bank_mask:0xf
    v_dot2c_f32_bf16_dpp v11, v27, v89 row_newbcast:8 row_mask:0xf bank_mask:0xf
    v_dot2c_f32_bf16_dpp v12, v26, v90 row_newbcast:8 row_mask:0xf bank_mask:0xf
    v_dot2c_f32_bf16_dpp v13, v27, v90 row_newbcast:8 row_mask:0xf bank_mask:0xf
    v_dot2c_f32_bf16_dpp v14, v26, v91 row_newbcast:8 row_mask:0xf bank_mask:0xf
    v_dot2c_f32_bf16_dpp v15, v27, v91 row_newbcast:8 row_mask:0xf bank_mask:0xf
    s_waitcnt vmcnt(4)
    buffer_load_dwordx4 v[48:51], v2, s[24:27], 0 offen offset:2048 nt
    v_dot2c_f32_bf16_dpp v8, v26, v92 row_newbcast:9 row_mask:0xf bank_mask:0xf
    v_dot2c_f32_bf16_dpp v9, v27, v92 row_newbcast:9 row_mask:0xf bank_mask:0xf
    v_dot2c_f32_bf16_dpp v10, v26, v93 row_newbcast:9 row_mask:0xf bank_mask:0xf
    v_dot2c_f32_bf16_dpp v11, v27, v93 row_newbcast:9 row_mask:0xf bank_mask:0xf
    v_dot2c_f32_bf16_dpp v12, v26, v94 row_newbcast:9 row_mask:0xf bank_mask:0xf
    v_dot2c_f32_bf16_dpp v13, v27, v94 row_newbcast:9 row_mask:0xf bank_mask:0xf
    v_dot2c_f32_bf16_dpp v14, v26, v95 row_newbcast:9 row_mask:0xf bank_mask:0xf
    v_dot2c_f32_bf16_dpp v15, v27, v95 row_newbcast:9 row_mask:0xf bank_mask:0xf
    s_waitcnt vmcnt(4)
    buffer_load_dwordx4 v[52:55], v2, s[24:27], 0 offen offset:3072 nt
    v_dot2c_f32_bf16_dpp v8, v26, v96 row_newbcast:12 row_mask:0xf bank_mask:0xf
    v_dot2c_f32_bf16_dpp v9, v27, v96 row_newbcast:12 row_mask:0xf bank_mask:0xf
    v_dot2c_f32_bf16_dpp v10, v26, v97 row_newbcast:12 row_mask:0xf bank_mask:0xf
    v_dot2c_f32_bf16_dpp v11, v27, v97 row_newbcast:12 row_mask:0xf bank_mask:0xf
    v_dot2c_f32_bf16_dpp v12, v26, v98 row_newbcast:12 row_mask:0xf bank_mask:0xf
    v_dot2c_f32_bf16_dpp v13, v27, v98 row_newbcast:12 row_mask:0xf bank_mask:0xf
    v_dot2c_f32_bf16_dpp v14, v26, v99 row_newbcast:12 row_mask:0xf bank_mask:0xf
    v_dot2c_f32_bf16_dpp v15, v27, v99 row_newbcast:12 row_mask:0xf bank_mask:0xf
    s_waitcnt vmcnt(4)
    buffer_load_dwordx4 v[56:59], v3, s[24:27], 0 offen offset:0 nt
    buffer_load_dwordx4 v[60:63], v3, s[24:27], 0 offen offset:1024 nt
    v_dot2c_f32_bf16_dpp v8, v26, v100 row_newbcast:13 row_mask:0xf bank_mask:0xf
    v_dot2c_f32_bf16_dpp v9, v27, v100 row_newbcast:13 row_mask:0xf bank_mask:0xf
    v_dot2c_f32_bf16_dpp v10, v26, v101 row_newbcast:13 row_mask:0xf bank_mask:0xf
    v_dot2c_f32_bf16_dpp v11, v27, v101 row_newbcast:13 row_mask:0xf bank_mask:0xf
    v_dot2c_f32_bf16_dpp v12, v26, v102 row_newbcast:13 row_mask:0xf bank_mask:0xf
    v_dot2c_f32_bf16_dpp v13, v27, v102 row_newbcast:13 row_mask:0xf bank_mask:0xf
    v_dot2c_f32_bf16_dpp v14, v26, v103 row_newbcast:13 row_mask:0xf bank_mask:0xf
    v_dot2c_f32_bf16_dpp v15, v27, v103 row_newbcast:13 row_mask:0xf bank_mask:0xf
    v_perm_b32 v29, v148, v144, s72
    v_perm_b32 v148, v148, v144, s73
    v_mov_b32 v144, v29
    v_perm_b32 v29, v149, v145, s72
    v_perm_b32 v149, v149, v145, s73
    v_mov_b32 v145, v29
    v_perm_b32 v29, v150, v146, s72
    v_perm_b32 v150, v150, v146, s73
    v_mov_b32 v146, v29
    v_perm_b32 v29, v151, v147, s72
    v_perm_b32 v151, v151, v147, s73
    v_mov_b32 v147, v29
    s_waitcnt vmcnt(5)
    s_mov_b32 s64, 57344
    buffer_load_dwordx4 v[160:163], v36, s[36:39], s64 offen
    s_mov_b32 s64, 58368
    buffer_load_dwordx4 v[164:167], v36, s[36:39], s64 offen
    v_dot2_f32_bf16 v16, v40, v4, 0
    v_dot2_f32_bf16 v16, v41, v5, v16
    v_dot2_f32_bf16 v16, v42, v6, v16
    v_dot2_f32_bf16 v16, v43, v7, v16
    s_waitcnt vmcnt(6)
    buffer_load_dwordx4 v[64:67], v3, s[24:27], 0 offen offset:2048 nt
    v_dot2_f32_bf16 v17, v44, v4, 0
    v_dot2_f32_bf16 v17, v45, v5, v17
    v_dot2_f32_bf16 v17, v46, v6, v17
    v_dot2_f32_bf16 v17, v47, v7, v17
    s_waitcnt vmcnt(6)
    buffer_load_dwordx4 v[68:71], v3, s[24:27], 0 offen offset:3072 nt
    v_dot2_f32_bf16 v18, v48, v4, 0
    v_dot2_f32_bf16 v18, v49, v5, v18
    v_dot2_f32_bf16 v18, v50, v6, v18
    v_dot2_f32_bf16 v18, v51, v7, v18
    s_waitcnt vmcnt(6)
    buffer_load_dwordx4 v[72:75], v2, s[28:31], 0 offen offset:0 nt
    v_dot2_f32_bf16 v19, v52, v4, 0
    v_dot2_f32_bf16 v19, v53, v5, v19
    v_dot2_f32_bf16 v19, v54, v6, v19
    v_dot2_f32_bf16 v19, v55, v7, v19
    s_waitcnt vmcnt(6)
    buffer_load_dwordx4 v[76:79], v2, s[28:31], 0 offen offset:1024 nt
    v_dot2_f32_bf16 v20, v56, v4, 0
    v_dot2_f32_bf16 v20, v57, v5, v20
    v_dot2_f32_bf16 v20, v58, v6, v20
    v_dot2_f32_bf16 v20, v59, v7, v20
    s_waitcnt vmcnt(6)
    buffer_load_dwordx4 v[80:83], v2, s[28:31], 0 offen offset:2048 nt
    v_dot2_f32_bf16 v21, v60, v4, 0
    v_dot2_f32_bf16 v21, v61, v5, v21
    v_dot2_f32_bf16 v21, v62, v6, v21
    v_dot2_f32_bf16 v21, v63, v7, v21
    s_waitcnt vmcnt(4)
    buffer_load_dwordx4 v[84:87], v2, s[28:31], 0 offen offset:3072 nt
    v_dot2_f32_bf16 v22, v64, v4, 0
    v_dot2_f32_bf16 v22, v65, v5, v22
    v_dot2_f32_bf16 v22, v66, v6, v22
    v_dot2_f32_bf16 v22, v67, v7, v22
    s_waitcnt vmcnt(4)
    buffer_load_dwordx4 v[88:91], v3, s[28:31], 0 offen offset:0 nt
    buffer_load_dwordx4 v[92:95], v3, s[28:31], 0 offen offset:1024 nt
    v_dot2_f32_bf16 v23, v68, v4, 0
    v_dot2_f32_bf16 v23, v69, v5, v23
    v_dot2_f32_bf16 v23, v70, v6, v23
    v_dot2_f32_bf16 v23, v71, v7, v23
    s_nop 2
    v_add_f32_dpp v16, v16, v16 row_ror:8 row_mask:0xf bank_mask:0x3
    v_add_f32_dpp v17, v17, v17 row_ror:8 row_mask:0xf bank_mask:0x3
    v_add_f32_dpp v18, v18, v18 row_ror:8 row_mask:0xf bank_mask:0x3
    v_add_f32_dpp v19, v19, v19 row_ror:8 row_mask:0xf bank_mask:0x3
    v_add_f32_dpp v16, v20, v20 row_ror:8 row_mask:0xf bank_mask:0xc
    v_add_f32_dpp v17, v21, v21 row_ror:8 row_mask:0xf bank_mask:0xc
    v_add_f32_dpp v18, v22, v22 row_ror:8 row_mask:0xf bank_mask:0xc
    v_add_f32_dpp v19, v23, v23 row_ror:8 row_mask:0xf bank_mask:0xc
    v_add_f32_dpp v16, v16, v16 row_half_mirror row_mask:0xf bank_mask:0x5
    v_add_f32_dpp v17, v17, v17 row_half_mirror row_mask:0xf bank_mask:0x5
    v_add_f32_dpp v16, v18, v18 row_half_mirror row_mask:0xf bank_mask:0xa
    v_add_f32_dpp v17, v19, v19 row_half_mirror row_mask:0xf bank_mask:0xa
    s_nop 0
    v_add_f32_dpp v16, v16, v16 quad_perm:[1,0,3,2] row_mask:0xf bank_mask:0xf
    v_add_f32_dpp v17, v17, v17 quad_perm:[1,0,3,2] row_mask:0xf bank_mask:0xf
    s_nop 0
    v_cndmask_b32 v29, v16, v17, s[76:77]
    s_nop 1
    v_add_f32_dpp v29, v29, v29 quad_perm:[2,3,0,1] row_mask:0xf bank_mask:0xf
    v_mul_f32 v29, s74, v29
    s_nop 1
    v_max_f32_dpp v30, v29, v29 quad_perm:[1,0,3,2] row_mask:0xf bank_mask:0xf
    s_nop 1
    v_max_f32_dpp v30, v30, v30 row_ror:4 row_mask:0xf bank_mask:0xf
    s_nop 1
    v_max_f32_dpp v30, v30, v30 row_ror:8 row_mask:0xf bank_mask:0xf
    v_max_f32 v30, v30, v24
    v_sub_f32 v28, v24, v30
    v_sub_f32 v29, v29, v30
    v_exp_f32 v28, v28
    v_exp_f32 v29, v29
    v_mov_b32 v24, v30
    v_cvt_pk_bf16_f32 v26, v29, 0
    v_cvt_pk_bf16_f32 v27, 0, v29
    v_fma_f32 v25, v25, v28, v29
    v_mul_f32 v8, v28, v8
    v_mul_f32 v9, v28, v9
    v_mul_f32 v10, v28, v10
    v_mul_f32 v11, v28, v11
    v_mul_f32 v12, v28, v12
    v_mul_f32 v13, v28, v13
    v_mul_f32 v14, v28, v14
    v_mul_f32 v15, v28, v15
    s_waitcnt vmcnt(5)
    v_dot2c_f32_bf16_dpp v8, v26, v72 row_newbcast:0 row_mask:0xf bank_mask:0xf
    v_dot2c_f32_bf16_dpp v9, v27, v72 row_newbcast:0 row_mask:0xf bank_mask:0xf
    v_dot2c_f32_bf16_dpp v10, v26, v73 row_newbcast:0 row_mask:0xf bank_mask:0xf
    v_dot2c_f32_bf16_dpp v11, v27, v73 row_newbcast:0 row_mask:0xf bank_mask:0xf
    v_dot2c_f32_bf16_dpp v12, v26, v74 row_newbcast:0 row_mask:0xf bank_mask:0xf
    v_dot2c_f32_bf16_dpp v13, v27, v74 row_newbcast:0 row_mask:0xf bank_mask:0xf
    v_dot2c_f32_bf16_dpp v14, v26, v75 row_newbcast:0 row_mask:0xf bank_mask:0xf
    v_dot2c_f32_bf16_dpp v15, v27, v75 row_newbcast:0 row_mask:0xf bank_mask:0xf
    s_waitcnt vmcnt(4)
    buffer_load_dwordx4 v[96:99], v3, s[28:31], 0 offen offset:2048 nt
    v_dot2c_f32_bf16_dpp v8, v26, v76 row_newbcast:1 row_mask:0xf bank_mask:0xf
    v_dot2c_f32_bf16_dpp v9, v27, v76 row_newbcast:1 row_mask:0xf bank_mask:0xf
    v_dot2c_f32_bf16_dpp v10, v26, v77 row_newbcast:1 row_mask:0xf bank_mask:0xf
    v_dot2c_f32_bf16_dpp v11, v27, v77 row_newbcast:1 row_mask:0xf bank_mask:0xf
    v_dot2c_f32_bf16_dpp v12, v26, v78 row_newbcast:1 row_mask:0xf bank_mask:0xf
    v_dot2c_f32_bf16_dpp v13, v27, v78 row_newbcast:1 row_mask:0xf bank_mask:0xf
    v_dot2c_f32_bf16_dpp v14, v26, v79 row_newbcast:1 row_mask:0xf bank_mask:0xf
    v_dot2c_f32_bf16_dpp v15, v27, v79 row_newbcast:1 row_mask:0xf bank_mask:0xf
    s_waitcnt vmcnt(4)
    buffer_load_dwordx4 v[100:103], v3, s[28:31], 0 offen offset:3072 nt
    v_dot2c_f32_bf16_dpp v8, v26, v80 row_newbcast:4 row_mask:0xf bank_mask:0xf
    v_dot2c_f32_bf16_dpp v9, v27, v80 row_newbcast:4 row_mask:0xf bank_mask:0xf
    v_dot2c_f32_bf16_dpp v10, v26, v81 row_newbcast:4 row_mask:0xf bank_mask:0xf
    v_dot2c_f32_bf16_dpp v11, v27, v81 row_newbcast:4 row_mask:0xf bank_mask:0xf
    v_dot2c_f32_bf16_dpp v12, v26, v82 row_newbcast:4 row_mask:0xf bank_mask:0xf
    v_dot2c_f32_bf16_dpp v13, v27, v82 row_newbcast:4 row_mask:0xf bank_mask:0xf
    v_dot2c_f32_bf16_dpp v14, v26, v83 row_newbcast:4 row_mask:0xf bank_mask:0xf
    v_dot2c_f32_bf16_dpp v15, v27, v83 row_newbcast:4 row_mask:0xf bank_mask:0xf
    s_waitcnt vmcnt(4)
    v_add_u32 v2, 0x8000, v2
    v_add_u32 v3, 0x8000, v3
    buffer_load_dwordx4 v[40:43], v2, s[24:27], 0 offen offset:0 nt
    v_dot2c_f32_bf16_dpp v8, v26, v84 row_newbcast:5 row_mask:0xf bank_mask:0xf
    v_dot2c_f32_bf16_dpp v9, v27, v84 row_newbcast:5 row_mask:0xf bank_mask:0xf
    v_dot2c_f32_bf16_dpp v10, v26, v85 row_newbcast:5 row_mask:0xf bank_mask:0xf
    v_dot2c_f32_bf16_dpp v11, v27, v85 row_newbcast:5 row_mask:0xf bank_mask:0xf
    v_dot2c_f32_bf16_dpp v12, v26, v86 row_newbcast:5 row_mask:0xf bank_mask:0xf
    v_dot2c_f32_bf16_dpp v13, v27, v86 row_newbcast:5 row_mask:0xf bank_mask:0xf
    v_dot2c_f32_bf16_dpp v14, v26, v87 row_newbcast:5 row_mask:0xf bank_mask:0xf
    v_dot2c_f32_bf16_dpp v15, v27, v87 row_newbcast:5 row_mask:0xf bank_mask:0xf
    s_waitcnt vmcnt(4)
    buffer_load_dwordx4 v[44:47], v2, s[24:27], 0 offen offset:1024 nt
    v_dot2c_f32_bf16_dpp v8, v26, v88 row_newbcast:8 row_mask:0xf bank_mask:0xf
    v_dot2c_f32_bf16_dpp v9, v27, v88 row_newbcast:8 row_mask:0xf bank_mask:0xf
    v_dot2c_f32_bf16_dpp v10, v26, v89 row_newbcast:8 row_mask:0xf bank_mask:0xf
    v_dot2c_f32_bf16_dpp v11, v27, v89 row_newbcast:8 row_mask:0xf bank_mask:0xf
    v_dot2c_f32_bf16_dpp v12, v26, v90 row_newbcast:8 row_mask:0xf bank_mask:0xf
    v_dot2c_f32_bf16_dpp v13, v27, v90 row_newbcast:8 row_mask:0xf bank_mask:0xf
    v_dot2c_f32_bf16_dpp v14, v26, v91 row_newbcast:8 row_mask:0xf bank_mask:0xf
    v_dot2c_f32_bf16_dpp v15, v27, v91 row_newbcast:8 row_mask:0xf bank_mask:0xf
    s_waitcnt vmcnt(4)
    buffer_load_dwordx4 v[48:51], v2, s[24:27], 0 offen offset:2048 nt
    v_dot2c_f32_bf16_dpp v8, v26, v92 row_newbcast:9 row_mask:0xf bank_mask:0xf
    v_dot2c_f32_bf16_dpp v9, v27, v92 row_newbcast:9 row_mask:0xf bank_mask:0xf
    v_dot2c_f32_bf16_dpp v10, v26, v93 row_newbcast:9 row_mask:0xf bank_mask:0xf
    v_dot2c_f32_bf16_dpp v11, v27, v93 row_newbcast:9 row_mask:0xf bank_mask:0xf
    v_dot2c_f32_bf16_dpp v12, v26, v94 row_newbcast:9 row_mask:0xf bank_mask:0xf
    v_dot2c_f32_bf16_dpp v13, v27, v94 row_newbcast:9 row_mask:0xf bank_mask:0xf
    v_dot2c_f32_bf16_dpp v14, v26, v95 row_newbcast:9 row_mask:0xf bank_mask:0xf
    v_dot2c_f32_bf16_dpp v15, v27, v95 row_newbcast:9 row_mask:0xf bank_mask:0xf
    s_waitcnt vmcnt(4)
    buffer_load_dwordx4 v[52:55], v2, s[24:27], 0 offen offset:3072 nt
    v_dot2c_f32_bf16_dpp v8, v26, v96 row_newbcast:12 row_mask:0xf bank_mask:0xf
    v_dot2c_f32_bf16_dpp v9, v27, v96 row_newbcast:12 row_mask:0xf bank_mask:0xf
    v_dot2c_f32_bf16_dpp v10, v26, v97 row_newbcast:12 row_mask:0xf bank_mask:0xf
    v_dot2c_f32_bf16_dpp v11, v27, v97 row_newbcast:12 row_mask:0xf bank_mask:0xf
    v_dot2c_f32_bf16_dpp v12, v26, v98 row_newbcast:12 row_mask:0xf bank_mask:0xf
    v_dot2c_f32_bf16_dpp v13, v27, v98 row_newbcast:12 row_mask:0xf bank_mask:0xf
    v_dot2c_f32_bf16_dpp v14, v26, v99 row_newbcast:12 row_mask:0xf bank_mask:0xf
    v_dot2c_f32_bf16_dpp v15, v27, v99 row_newbcast:12 row_mask:0xf bank_mask:0xf
    s_waitcnt vmcnt(4)
    buffer_load_dwordx4 v[56:59], v3, s[24:27], 0 offen offset:0 nt
    buffer_load_dwordx4 v[60:63], v3, s[24:27], 0 offen offset:1024 nt
    v_dot2c_f32_bf16_dpp v8, v26, v100 row_newbcast:13 row_mask:0xf bank_mask:0xf
    v_dot2c_f32_bf16_dpp v9, v27, v100 row_newbcast:13 row_mask:0xf bank_mask:0xf
    v_dot2c_f32_bf16_dpp v10, v26, v101 row_newbcast:13 row_mask:0xf bank_mask:0xf
    v_dot2c_f32_bf16_dpp v11, v27, v101 row_newbcast:13 row_mask:0xf bank_mask:0xf
    v_dot2c_f32_bf16_dpp v12, v26, v102 row_newbcast:13 row_mask:0xf bank_mask:0xf
    v_dot2c_f32_bf16_dpp v13, v27, v102 row_newbcast:13 row_mask:0xf bank_mask:0xf
    v_dot2c_f32_bf16_dpp v14, v26, v103 row_newbcast:13 row_mask:0xf bank_mask:0xf
    v_dot2c_f32_bf16_dpp v15, v27, v103 row_newbcast:13 row_mask:0xf bank_mask:0xf
    v_perm_b32 v29, v156, v152, s72
    v_perm_b32 v156, v156, v152, s73
    v_mov_b32 v152, v29
    v_perm_b32 v29, v157, v153, s72
    v_perm_b32 v157, v157, v153, s73
    v_mov_b32 v153, v29
    v_perm_b32 v29, v158, v154, s72
    v_perm_b32 v158, v158, v154, s73
    v_mov_b32 v154, v29
    v_perm_b32 v29, v159, v155, s72
    v_perm_b32 v159, v159, v155, s73
    v_mov_b32 v155, v29
    s_waitcnt vmcnt(5)
    s_mov_b32 s64, 65536
    buffer_load_dwordx4 v[168:171], v36, s[36:39], s64 offen
    s_mov_b32 s64, 66560
    buffer_load_dwordx4 v[172:175], v36, s[36:39], s64 offen
    v_dot2_f32_bf16 v16, v40, v4, 0
    v_dot2_f32_bf16 v16, v41, v5, v16
    v_dot2_f32_bf16 v16, v42, v6, v16
    v_dot2_f32_bf16 v16, v43, v7, v16
    s_waitcnt vmcnt(6)
    buffer_load_dwordx4 v[64:67], v3, s[24:27], 0 offen offset:2048 nt
    v_dot2_f32_bf16 v17, v44, v4, 0
    v_dot2_f32_bf16 v17, v45, v5, v17
    v_dot2_f32_bf16 v17, v46, v6, v17
    v_dot2_f32_bf16 v17, v47, v7, v17
    s_waitcnt vmcnt(6)
    buffer_load_dwordx4 v[68:71], v3, s[24:27], 0 offen offset:3072 nt
    v_dot2_f32_bf16 v18, v48, v4, 0
    v_dot2_f32_bf16 v18, v49, v5, v18
    v_dot2_f32_bf16 v18, v50, v6, v18
    v_dot2_f32_bf16 v18, v51, v7, v18
    s_waitcnt vmcnt(6)
    buffer_load_dwordx4 v[72:75], v2, s[28:31], 0 offen offset:0 nt
    v_dot2_f32_bf16 v19, v52, v4, 0
    v_dot2_f32_bf16 v19, v53, v5, v19
    v_dot2_f32_bf16 v19, v54, v6, v19
    v_dot2_f32_bf16 v19, v55, v7, v19
    s_waitcnt vmcnt(6)
    buffer_load_dwordx4 v[76:79], v2, s[28:31], 0 offen offset:1024 nt
    v_dot2_f32_bf16 v20, v56, v4, 0
    v_dot2_f32_bf16 v20, v57, v5, v20
    v_dot2_f32_bf16 v20, v58, v6, v20
    v_dot2_f32_bf16 v20, v59, v7, v20
    s_waitcnt vmcnt(6)
    buffer_load_dwordx4 v[80:83], v2, s[28:31], 0 offen offset:2048 nt
    v_dot2_f32_bf16 v21, v60, v4, 0
    v_dot2_f32_bf16 v21, v61, v5, v21
    v_dot2_f32_bf16 v21, v62, v6, v21
    v_dot2_f32_bf16 v21, v63, v7, v21
    s_waitcnt vmcnt(4)
    buffer_load_dwordx4 v[84:87], v2, s[28:31], 0 offen offset:3072 nt
    v_dot2_f32_bf16 v22, v64, v4, 0
    v_dot2_f32_bf16 v22, v65, v5, v22
    v_dot2_f32_bf16 v22, v66, v6, v22
    v_dot2_f32_bf16 v22, v67, v7, v22
    s_waitcnt vmcnt(4)
    buffer_load_dwordx4 v[88:91], v3, s[28:31], 0 offen offset:0 nt
    buffer_load_dwordx4 v[92:95], v3, s[28:31], 0 offen offset:1024 nt
    v_dot2_f32_bf16 v23, v68, v4, 0
    v_dot2_f32_bf16 v23, v69, v5, v23
    v_dot2_f32_bf16 v23, v70, v6, v23
    v_dot2_f32_bf16 v23, v71, v7, v23
    s_nop 2
    v_add_f32_dpp v16, v16, v16 row_ror:8 row_mask:0xf bank_mask:0x3
    v_add_f32_dpp v17, v17, v17 row_ror:8 row_mask:0xf bank_mask:0x3
    v_add_f32_dpp v18, v18, v18 row_ror:8 row_mask:0xf bank_mask:0x3
    v_add_f32_dpp v19, v19, v19 row_ror:8 row_mask:0xf bank_mask:0x3
    v_add_f32_dpp v16, v20, v20 row_ror:8 row_mask:0xf bank_mask:0xc
    v_add_f32_dpp v17, v21, v21 row_ror:8 row_mask:0xf bank_mask:0xc
    v_add_f32_dpp v18, v22, v22 row_ror:8 row_mask:0xf bank_mask:0xc
    v_add_f32_dpp v19, v23, v23 row_ror:8 row_mask:0xf bank_mask:0xc
    v_add_f32_dpp v16, v16, v16 row_half_mirror row_mask:0xf bank_mask:0x5
    v_add_f32_dpp v17, v17, v17 row_half_mirror row_mask:0xf bank_mask:0x5
    v_add_f32_dpp v16, v18, v18 row_half_mirror row_mask:0xf bank_mask:0xa
    v_add_f32_dpp v17, v19, v19 row_half_mirror row_mask:0xf bank_mask:0xa
    s_nop 0
    v_add_f32_dpp v16, v16, v16 quad_perm:[1,0,3,2] row_mask:0xf bank_mask:0xf
    v_add_f32_dpp v17, v17, v17 quad_perm:[1,0,3,2] row_mask:0xf bank_mask:0xf
    s_nop 0
    v_cndmask_b32 v29, v16, v17, s[76:77]
    s_nop 1
    v_add_f32_dpp v29, v29, v29 quad_perm:[2,3,0,1] row_mask:0xf bank_mask:0xf
    v_mul_f32 v29, s74, v29
    s_nop 1
    v_max_f32_dpp v30, v29, v29 quad_perm:[1,0,3,2] row_mask:0xf bank_mask:0xf
    s_nop 1
    v_max_f32_dpp v30, v30, v30 row_ror:4 row_mask:0xf bank_mask:0xf
    s_nop 1
    v_max_f32_dpp v30, v30, v30 row_ror:8 row_mask:0xf bank_mask:0xf
    v_max_f32 v30, v30, v24
    v_sub_f32 v28, v24, v30
    v_sub_f32 v29, v29, v30
    v_exp_f32 v28, v28
    v_exp_f32 v29, v29
    v_mov_b32 v24, v30
    v_cvt_pk_bf16_f32 v26, v29, 0
    v_cvt_pk_bf16_f32 v27, 0, v29
    v_fma_f32 v25, v25, v28, v29
    v_mul_f32 v8, v28, v8
    v_mul_f32 v9, v28, v9
    v_mul_f32 v10, v28, v10
    v_mul_f32 v11, v28, v11
    v_mul_f32 v12, v28, v12
    v_mul_f32 v13, v28, v13
    v_mul_f32 v14, v28, v14
    v_mul_f32 v15, v28, v15
    s_waitcnt vmcnt(5)
    v_dot2c_f32_bf16_dpp v8, v26, v72 row_newbcast:0 row_mask:0xf bank_mask:0xf
    v_dot2c_f32_bf16_dpp v9, v27, v72 row_newbcast:0 row_mask:0xf bank_mask:0xf
    v_dot2c_f32_bf16_dpp v10, v26, v73 row_newbcast:0 row_mask:0xf bank_mask:0xf
    v_dot2c_f32_bf16_dpp v11, v27, v73 row_newbcast:0 row_mask:0xf bank_mask:0xf
    v_dot2c_f32_bf16_dpp v12, v26, v74 row_newbcast:0 row_mask:0xf bank_mask:0xf
    v_dot2c_f32_bf16_dpp v13, v27, v74 row_newbcast:0 row_mask:0xf bank_mask:0xf
    v_dot2c_f32_bf16_dpp v14, v26, v75 row_newbcast:0 row_mask:0xf bank_mask:0xf
    v_dot2c_f32_bf16_dpp v15, v27, v75 row_newbcast:0 row_mask:0xf bank_mask:0xf
    s_waitcnt vmcnt(4)
    buffer_load_dwordx4 v[96:99], v3, s[28:31], 0 offen offset:2048 nt
    v_dot2c_f32_bf16_dpp v8, v26, v76 row_newbcast:1 row_mask:0xf bank_mask:0xf
    v_dot2c_f32_bf16_dpp v9, v27, v76 row_newbcast:1 row_mask:0xf bank_mask:0xf
    v_dot2c_f32_bf16_dpp v10, v26, v77 row_newbcast:1 row_mask:0xf bank_mask:0xf
    v_dot2c_f32_bf16_dpp v11, v27, v77 row_newbcast:1 row_mask:0xf bank_mask:0xf
    v_dot2c_f32_bf16_dpp v12, v26, v78 row_newbcast:1 row_mask:0xf bank_mask:0xf
    v_dot2c_f32_bf16_dpp v13, v27, v78 row_newbcast:1 row_mask:0xf bank_mask:0xf
    v_dot2c_f32_bf16_dpp v14, v26, v79 row_newbcast:1 row_mask:0xf bank_mask:0xf
    v_dot2c_f32_bf16_dpp v15, v27, v79 row_newbcast:1 row_mask:0xf bank_mask:0xf
    s_waitcnt vmcnt(4)
    buffer_load_dwordx4 v[100:103], v3, s[28:31], 0 offen offset:3072 nt
    v_dot2c_f32_bf16_dpp v8, v26, v80 row_newbcast:4 row_mask:0xf bank_mask:0xf
    v_dot2c_f32_bf16_dpp v9, v27, v80 row_newbcast:4 row_mask:0xf bank_mask:0xf
    v_dot2c_f32_bf16_dpp v10, v26, v81 row_newbcast:4 row_mask:0xf bank_mask:0xf
    v_dot2c_f32_bf16_dpp v11, v27, v81 row_newbcast:4 row_mask:0xf bank_mask:0xf
    v_dot2c_f32_bf16_dpp v12, v26, v82 row_newbcast:4 row_mask:0xf bank_mask:0xf
    v_dot2c_f32_bf16_dpp v13, v27, v82 row_newbcast:4 row_mask:0xf bank_mask:0xf
    v_dot2c_f32_bf16_dpp v14, v26, v83 row_newbcast:4 row_mask:0xf bank_mask:0xf
    v_dot2c_f32_bf16_dpp v15, v27, v83 row_newbcast:4 row_mask:0xf bank_mask:0xf
    s_waitcnt vmcnt(4)
    v_add_u32 v2, 0x8000, v2
    v_add_u32 v3, 0x8000, v3
    buffer_load_dwordx4 v[40:43], v2, s[24:27], 0 offen offset:0 nt
    v_dot2c_f32_bf16_dpp v8, v26, v84 row_newbcast:5 row_mask:0xf bank_mask:0xf
    v_dot2c_f32_bf16_dpp v9, v27, v84 row_newbcast:5 row_mask:0xf bank_mask:0xf
    v_dot2c_f32_bf16_dpp v10, v26, v85 row_newbcast:5 row_mask:0xf bank_mask:0xf
    v_dot2c_f32_bf16_dpp v11, v27, v85 row_newbcast:5 row_mask:0xf bank_mask:0xf
    v_dot2c_f32_bf16_dpp v12, v26, v86 row_newbcast:5 row_mask:0xf bank_mask:0xf
    v_dot2c_f32_bf16_dpp v13, v27, v86 row_newbcast:5 row_mask:0xf bank_mask:0xf
    v_dot2c_f32_bf16_dpp v14, v26, v87 row_newbcast:5 row_mask:0xf bank_mask:0xf
    v_dot2c_f32_bf16_dpp v15, v27, v87 row_newbcast:5 row_mask:0xf bank_mask:0xf
    s_waitcnt vmcnt(4)
    buffer_load_dwordx4 v[44:47], v2, s[24:27], 0 offen offset:1024 nt
    v_dot2c_f32_bf16_dpp v8, v26, v88 row_newbcast:8 row_mask:0xf bank_mask:0xf
    v_dot2c_f32_bf16_dpp v9, v27, v88 row_newbcast:8 row_mask:0xf bank_mask:0xf
    v_dot2c_f32_bf16_dpp v10, v26, v89 row_newbcast:8 row_mask:0xf bank_mask:0xf
    v_dot2c_f32_bf16_dpp v11, v27, v89 row_newbcast:8 row_mask:0xf bank_mask:0xf
    v_dot2c_f32_bf16_dpp v12, v26, v90 row_newbcast:8 row_mask:0xf bank_mask:0xf
    v_dot2c_f32_bf16_dpp v13, v27, v90 row_newbcast:8 row_mask:0xf bank_mask:0xf
    v_dot2c_f32_bf16_dpp v14, v26, v91 row_newbcast:8 row_mask:0xf bank_mask:0xf
    v_dot2c_f32_bf16_dpp v15, v27, v91 row_newbcast:8 row_mask:0xf bank_mask:0xf
    s_waitcnt vmcnt(4)
    buffer_load_dwordx4 v[48:51], v2, s[24:27], 0 offen offset:2048 nt
    v_dot2c_f32_bf16_dpp v8, v26, v92 row_newbcast:9 row_mask:0xf bank_mask:0xf
    v_dot2c_f32_bf16_dpp v9, v27, v92 row_newbcast:9 row_mask:0xf bank_mask:0xf
    v_dot2c_f32_bf16_dpp v10, v26, v93 row_newbcast:9 row_mask:0xf bank_mask:0xf
    v_dot2c_f32_bf16_dpp v11, v27, v93 row_newbcast:9 row_mask:0xf bank_mask:0xf
    v_dot2c_f32_bf16_dpp v12, v26, v94 row_newbcast:9 row_mask:0xf bank_mask:0xf
    v_dot2c_f32_bf16_dpp v13, v27, v94 row_newbcast:9 row_mask:0xf bank_mask:0xf
    v_dot2c_f32_bf16_dpp v14, v26, v95 row_newbcast:9 row_mask:0xf bank_mask:0xf
    v_dot2c_f32_bf16_dpp v15, v27, v95 row_newbcast:9 row_mask:0xf bank_mask:0xf
    s_waitcnt vmcnt(4)
    buffer_load_dwordx4 v[52:55], v2, s[24:27], 0 offen offset:3072 nt
    v_dot2c_f32_bf16_dpp v8, v26, v96 row_newbcast:12 row_mask:0xf bank_mask:0xf
    v_dot2c_f32_bf16_dpp v9, v27, v96 row_newbcast:12 row_mask:0xf bank_mask:0xf
    v_dot2c_f32_bf16_dpp v10, v26, v97 row_newbcast:12 row_mask:0xf bank_mask:0xf
    v_dot2c_f32_bf16_dpp v11, v27, v97 row_newbcast:12 row_mask:0xf bank_mask:0xf
    v_dot2c_f32_bf16_dpp v12, v26, v98 row_newbcast:12 row_mask:0xf bank_mask:0xf
    v_dot2c_f32_bf16_dpp v13, v27, v98 row_newbcast:12 row_mask:0xf bank_mask:0xf
    v_dot2c_f32_bf16_dpp v14, v26, v99 row_newbcast:12 row_mask:0xf bank_mask:0xf
    v_dot2c_f32_bf16_dpp v15, v27, v99 row_newbcast:12 row_mask:0xf bank_mask:0xf
    s_waitcnt vmcnt(4)
    buffer_load_dwordx4 v[56:59], v3, s[24:27], 0 offen offset:0 nt
    buffer_load_dwordx4 v[60:63], v3, s[24:27], 0 offen offset:1024 nt
    v_dot2c_f32_bf16_dpp v8, v26, v100 row_newbcast:13 row_mask:0xf bank_mask:0xf
    v_dot2c_f32_bf16_dpp v9, v27, v100 row_newbcast:13 row_mask:0xf bank_mask:0xf
    v_dot2c_f32_bf16_dpp v10, v26, v101 row_newbcast:13 row_mask:0xf bank_mask:0xf
    v_dot2c_f32_bf16_dpp v11, v27, v101 row_newbcast:13 row_mask:0xf bank_mask:0xf
    v_dot2c_f32_bf16_dpp v12, v26, v102 row_newbcast:13 row_mask:0xf bank_mask:0xf
    v_dot2c_f32_bf16_dpp v13, v27, v102 row_newbcast:13 row_mask:0xf bank_mask:0xf
    v_dot2c_f32_bf16_dpp v14, v26, v103 row_newbcast:13 row_mask:0xf bank_mask:0xf
    v_dot2c_f32_bf16_dpp v15, v27, v103 row_newbcast:13 row_mask:0xf bank_mask:0xf
    v_perm_b32 v29, v164, v160, s72
    v_perm_b32 v164, v164, v160, s73
    v_mov_b32 v160, v29
    v_perm_b32 v29, v165, v161, s72
    v_perm_b32 v165, v165, v161, s73
    v_mov_b32 v161, v29
    v_perm_b32 v29, v166, v162, s72
    v_perm_b32 v166, v166, v162, s73
    v_mov_b32 v162, v29
    v_perm_b32 v29, v167, v163, s72
    v_perm_b32 v167, v167, v163, s73
    v_mov_b32 v163, v29
    s_waitcnt vmcnt(5)
    s_mov_b32 s64, 73728
    buffer_load_dwordx4 v[176:179], v36, s[36:39], s64 offen
    s_mov_b32 s64, 74752
    buffer_load_dwordx4 v[180:183], v36, s[36:39], s64 offen
    v_dot2_f32_bf16 v16, v40, v4, 0
    v_dot2_f32_bf16 v16, v41, v5, v16
    v_dot2_f32_bf16 v16, v42, v6, v16
    v_dot2_f32_bf16 v16, v43, v7, v16
    s_waitcnt vmcnt(6)
    buffer_load_dwordx4 v[64:67], v3, s[24:27], 0 offen offset:2048 nt
    v_dot2_f32_bf16 v17, v44, v4, 0
    v_dot2_f32_bf16 v17, v45, v5, v17
    v_dot2_f32_bf16 v17, v46, v6, v17
    v_dot2_f32_bf16 v17, v47, v7, v17
    s_waitcnt vmcnt(6)
    buffer_load_dwordx4 v[68:71], v3, s[24:27], 0 offen offset:3072 nt
    v_dot2_f32_bf16 v18, v48, v4, 0
    v_dot2_f32_bf16 v18, v49, v5, v18
    v_dot2_f32_bf16 v18, v50, v6, v18
    v_dot2_f32_bf16 v18, v51, v7, v18
    s_waitcnt vmcnt(6)
    buffer_load_dwordx4 v[72:75], v2, s[28:31], 0 offen offset:0 nt
    v_dot2_f32_bf16 v19, v52, v4, 0
    v_dot2_f32_bf16 v19, v53, v5, v19
    v_dot2_f32_bf16 v19, v54, v6, v19
    v_dot2_f32_bf16 v19, v55, v7, v19
    s_waitcnt vmcnt(6)
    buffer_load_dwordx4 v[76:79], v2, s[28:31], 0 offen offset:1024 nt
    v_dot2_f32_bf16 v20, v56, v4, 0
    v_dot2_f32_bf16 v20, v57, v5, v20
    v_dot2_f32_bf16 v20, v58, v6, v20
    v_dot2_f32_bf16 v20, v59, v7, v20
    s_waitcnt vmcnt(6)
    buffer_load_dwordx4 v[80:83], v2, s[28:31], 0 offen offset:2048 nt
    v_dot2_f32_bf16 v21, v60, v4, 0
    v_dot2_f32_bf16 v21, v61, v5, v21
    v_dot2_f32_bf16 v21, v62, v6, v21
    v_dot2_f32_bf16 v21, v63, v7, v21
    s_waitcnt vmcnt(4)
    buffer_load_dwordx4 v[84:87], v2, s[28:31], 0 offen offset:3072 nt
    v_dot2_f32_bf16 v22, v64, v4, 0
    v_dot2_f32_bf16 v22, v65, v5, v22
    v_dot2_f32_bf16 v22, v66, v6, v22
    v_dot2_f32_bf16 v22, v67, v7, v22
    s_waitcnt vmcnt(4)
    buffer_load_dwordx4 v[88:91], v3, s[28:31], 0 offen offset:0 nt
    buffer_load_dwordx4 v[92:95], v3, s[28:31], 0 offen offset:1024 nt
    v_dot2_f32_bf16 v23, v68, v4, 0
    v_dot2_f32_bf16 v23, v69, v5, v23
    v_dot2_f32_bf16 v23, v70, v6, v23
    v_dot2_f32_bf16 v23, v71, v7, v23
    s_nop 2
    v_add_f32_dpp v16, v16, v16 row_ror:8 row_mask:0xf bank_mask:0x3
    v_add_f32_dpp v17, v17, v17 row_ror:8 row_mask:0xf bank_mask:0x3
    v_add_f32_dpp v18, v18, v18 row_ror:8 row_mask:0xf bank_mask:0x3
    v_add_f32_dpp v19, v19, v19 row_ror:8 row_mask:0xf bank_mask:0x3
    v_add_f32_dpp v16, v20, v20 row_ror:8 row_mask:0xf bank_mask:0xc
    v_add_f32_dpp v17, v21, v21 row_ror:8 row_mask:0xf bank_mask:0xc
    v_add_f32_dpp v18, v22, v22 row_ror:8 row_mask:0xf bank_mask:0xc
    v_add_f32_dpp v19, v23, v23 row_ror:8 row_mask:0xf bank_mask:0xc
    v_add_f32_dpp v16, v16, v16 row_half_mirror row_mask:0xf bank_mask:0x5
    v_add_f32_dpp v17, v17, v17 row_half_mirror row_mask:0xf bank_mask:0x5
    v_add_f32_dpp v16, v18, v18 row_half_mirror row_mask:0xf bank_mask:0xa
    v_add_f32_dpp v17, v19, v19 row_half_mirror row_mask:0xf bank_mask:0xa
    s_nop 0
    v_add_f32_dpp v16, v16, v16 quad_perm:[1,0,3,2] row_mask:0xf bank_mask:0xf
    v_add_f32_dpp v17, v17, v17 quad_perm:[1,0,3,2] row_mask:0xf bank_mask:0xf
    s_nop 0
    v_cndmask_b32 v29, v16, v17, s[76:77]
    s_nop 1
    v_add_f32_dpp v29, v29, v29 quad_perm:[2,3,0,1] row_mask:0xf bank_mask:0xf
    v_mul_f32 v29, s74, v29
    s_nop 1
    v_max_f32_dpp v30, v29, v29 quad_perm:[1,0,3,2] row_mask:0xf bank_mask:0xf
    s_nop 1
    v_max_f32_dpp v30, v30, v30 row_ror:4 row_mask:0xf bank_mask:0xf
    s_nop 1
    v_max_f32_dpp v30, v30, v30 row_ror:8 row_mask:0xf bank_mask:0xf
    v_max_f32 v30, v30, v24
    v_sub_f32 v28, v24, v30
    v_sub_f32 v29, v29, v30
    v_exp_f32 v28, v28
    v_exp_f32 v29, v29
    v_mov_b32 v24, v30
    v_cvt_pk_bf16_f32 v26, v29, 0
    v_cvt_pk_bf16_f32 v27, 0, v29
    v_fma_f32 v25, v25, v28, v29
    v_mul_f32 v8, v28, v8
    v_mul_f32 v9, v28, v9
    v_mul_f32 v10, v28, v10
    v_mul_f32 v11, v28, v11
    v_mul_f32 v12, v28, v12
    v_mul_f32 v13, v28, v13
    v_mul_f32 v14, v28, v14
    v_mul_f32 v15, v28, v15
    s_waitcnt vmcnt(5)
    v_dot2c_f32_bf16_dpp v8, v26, v72 row_newbcast:0 row_mask:0xf bank_mask:0xf
    v_dot2c_f32_bf16_dpp v9, v27, v72 row_newbcast:0 row_mask:0xf bank_mask:0xf
    v_dot2c_f32_bf16_dpp v10, v26, v73 row_newbcast:0 row_mask:0xf bank_mask:0xf
    v_dot2c_f32_bf16_dpp v11, v27, v73 row_newbcast:0 row_mask:0xf bank_mask:0xf
    v_dot2c_f32_bf16_dpp v12, v26, v74 row_newbcast:0 row_mask:0xf bank_mask:0xf
    v_dot2c_f32_bf16_dpp v13, v27, v74 row_newbcast:0 row_mask:0xf bank_mask:0xf
    v_dot2c_f32_bf16_dpp v14, v26, v75 row_newbcast:0 row_mask:0xf bank_mask:0xf
    v_dot2c_f32_bf16_dpp v15, v27, v75 row_newbcast:0 row_mask:0xf bank_mask:0xf
    s_waitcnt vmcnt(4)
    buffer_load_dwordx4 v[96:99], v3, s[28:31], 0 offen offset:2048 nt
    v_dot2c_f32_bf16_dpp v8, v26, v76 row_newbcast:1 row_mask:0xf bank_mask:0xf
    v_dot2c_f32_bf16_dpp v9, v27, v76 row_newbcast:1 row_mask:0xf bank_mask:0xf
    v_dot2c_f32_bf16_dpp v10, v26, v77 row_newbcast:1 row_mask:0xf bank_mask:0xf
    v_dot2c_f32_bf16_dpp v11, v27, v77 row_newbcast:1 row_mask:0xf bank_mask:0xf
    v_dot2c_f32_bf16_dpp v12, v26, v78 row_newbcast:1 row_mask:0xf bank_mask:0xf
    v_dot2c_f32_bf16_dpp v13, v27, v78 row_newbcast:1 row_mask:0xf bank_mask:0xf
    v_dot2c_f32_bf16_dpp v14, v26, v79 row_newbcast:1 row_mask:0xf bank_mask:0xf
    v_dot2c_f32_bf16_dpp v15, v27, v79 row_newbcast:1 row_mask:0xf bank_mask:0xf
    s_waitcnt vmcnt(4)
    buffer_load_dwordx4 v[100:103], v3, s[28:31], 0 offen offset:3072 nt
    v_dot2c_f32_bf16_dpp v8, v26, v80 row_newbcast:4 row_mask:0xf bank_mask:0xf
    v_dot2c_f32_bf16_dpp v9, v27, v80 row_newbcast:4 row_mask:0xf bank_mask:0xf
    v_dot2c_f32_bf16_dpp v10, v26, v81 row_newbcast:4 row_mask:0xf bank_mask:0xf
    v_dot2c_f32_bf16_dpp v11, v27, v81 row_newbcast:4 row_mask:0xf bank_mask:0xf
    v_dot2c_f32_bf16_dpp v12, v26, v82 row_newbcast:4 row_mask:0xf bank_mask:0xf
    v_dot2c_f32_bf16_dpp v13, v27, v82 row_newbcast:4 row_mask:0xf bank_mask:0xf
    v_dot2c_f32_bf16_dpp v14, v26, v83 row_newbcast:4 row_mask:0xf bank_mask:0xf
    v_dot2c_f32_bf16_dpp v15, v27, v83 row_newbcast:4 row_mask:0xf bank_mask:0xf
    s_waitcnt vmcnt(4)
    v_add_u32 v2, 0x8000, v2
    v_add_u32 v3, 0x8000, v3
    buffer_load_dwordx4 v[40:43], v2, s[24:27], 0 offen offset:0 nt
    v_dot2c_f32_bf16_dpp v8, v26, v84 row_newbcast:5 row_mask:0xf bank_mask:0xf
    v_dot2c_f32_bf16_dpp v9, v27, v84 row_newbcast:5 row_mask:0xf bank_mask:0xf
    v_dot2c_f32_bf16_dpp v10, v26, v85 row_newbcast:5 row_mask:0xf bank_mask:0xf
    v_dot2c_f32_bf16_dpp v11, v27, v85 row_newbcast:5 row_mask:0xf bank_mask:0xf
    v_dot2c_f32_bf16_dpp v12, v26, v86 row_newbcast:5 row_mask:0xf bank_mask:0xf
    v_dot2c_f32_bf16_dpp v13, v27, v86 row_newbcast:5 row_mask:0xf bank_mask:0xf
    v_dot2c_f32_bf16_dpp v14, v26, v87 row_newbcast:5 row_mask:0xf bank_mask:0xf
    v_dot2c_f32_bf16_dpp v15, v27, v87 row_newbcast:5 row_mask:0xf bank_mask:0xf
    s_waitcnt vmcnt(4)
    buffer_load_dwordx4 v[44:47], v2, s[24:27], 0 offen offset:1024 nt
    v_dot2c_f32_bf16_dpp v8, v26, v88 row_newbcast:8 row_mask:0xf bank_mask:0xf
    v_dot2c_f32_bf16_dpp v9, v27, v88 row_newbcast:8 row_mask:0xf bank_mask:0xf
    v_dot2c_f32_bf16_dpp v10, v26, v89 row_newbcast:8 row_mask:0xf bank_mask:0xf
    v_dot2c_f32_bf16_dpp v11, v27, v89 row_newbcast:8 row_mask:0xf bank_mask:0xf
    v_dot2c_f32_bf16_dpp v12, v26, v90 row_newbcast:8 row_mask:0xf bank_mask:0xf
    v_dot2c_f32_bf16_dpp v13, v27, v90 row_newbcast:8 row_mask:0xf bank_mask:0xf
    v_dot2c_f32_bf16_dpp v14, v26, v91 row_newbcast:8 row_mask:0xf bank_mask:0xf
    v_dot2c_f32_bf16_dpp v15, v27, v91 row_newbcast:8 row_mask:0xf bank_mask:0xf
    s_waitcnt vmcnt(4)
    buffer_load_dwordx4 v[48:51], v2, s[24:27], 0 offen offset:2048 nt
    v_dot2c_f32_bf16_dpp v8, v26, v92 row_newbcast:9 row_mask:0xf bank_mask:0xf
    v_dot2c_f32_bf16_dpp v9, v27, v92 row_newbcast:9 row_mask:0xf bank_mask:0xf
    v_dot2c_f32_bf16_dpp v10, v26, v93 row_newbcast:9 row_mask:0xf bank_mask:0xf
    v_dot2c_f32_bf16_dpp v11, v27, v93 row_newbcast:9 row_mask:0xf bank_mask:0xf
    v_dot2c_f32_bf16_dpp v12, v26, v94 row_newbcast:9 row_mask:0xf bank_mask:0xf
    v_dot2c_f32_bf16_dpp v13, v27, v94 row_newbcast:9 row_mask:0xf bank_mask:0xf
    v_dot2c_f32_bf16_dpp v14, v26, v95 row_newbcast:9 row_mask:0xf bank_mask:0xf
    v_dot2c_f32_bf16_dpp v15, v27, v95 row_newbcast:9 row_mask:0xf bank_mask:0xf
    s_waitcnt vmcnt(4)
    buffer_load_dwordx4 v[52:55], v2, s[24:27], 0 offen offset:3072 nt
    v_dot2c_f32_bf16_dpp v8, v26, v96 row_newbcast:12 row_mask:0xf bank_mask:0xf
    v_dot2c_f32_bf16_dpp v9, v27, v96 row_newbcast:12 row_mask:0xf bank_mask:0xf
    v_dot2c_f32_bf16_dpp v10, v26, v97 row_newbcast:12 row_mask:0xf bank_mask:0xf
    v_dot2c_f32_bf16_dpp v11, v27, v97 row_newbcast:12 row_mask:0xf bank_mask:0xf
    v_dot2c_f32_bf16_dpp v12, v26, v98 row_newbcast:12 row_mask:0xf bank_mask:0xf
    v_dot2c_f32_bf16_dpp v13, v27, v98 row_newbcast:12 row_mask:0xf bank_mask:0xf
    v_dot2c_f32_bf16_dpp v14, v26, v99 row_newbcast:12 row_mask:0xf bank_mask:0xf
    v_dot2c_f32_bf16_dpp v15, v27, v99 row_newbcast:12 row_mask:0xf bank_mask:0xf
    s_waitcnt vmcnt(4)
    buffer_load_dwordx4 v[56:59], v3, s[24:27], 0 offen offset:0 nt
    buffer_load_dwordx4 v[60:63], v3, s[24:27], 0 offen offset:1024 nt
    v_dot2c_f32_bf16_dpp v8, v26, v100 row_newbcast:13 row_mask:0xf bank_mask:0xf
    v_dot2c_f32_bf16_dpp v9, v27, v100 row_newbcast:13 row_mask:0xf bank_mask:0xf
    v_dot2c_f32_bf16_dpp v10, v26, v101 row_newbcast:13 row_mask:0xf bank_mask:0xf
    v_dot2c_f32_bf16_dpp v11, v27, v101 row_newbcast:13 row_mask:0xf bank_mask:0xf
    v_dot2c_f32_bf16_dpp v12, v26, v102 row_newbcast:13 row_mask:0xf bank_mask:0xf
    v_dot2c_f32_bf16_dpp v13, v27, v102 row_newbcast:13 row_mask:0xf bank_mask:0xf
    v_dot2c_f32_bf16_dpp v14, v26, v103 row_newbcast:13 row_mask:0xf bank_mask:0xf
    v_dot2c_f32_bf16_dpp v15, v27, v103 row_newbcast:13 row_mask:0xf bank_mask:0xf
    v_perm_b32 v29, v172, v168, s72
    v_perm_b32 v172, v172, v168, s73
    v_mov_b32 v168, v29
    v_perm_b32 v29, v173, v169, s72
    v_perm_b32 v173, v173, v169, s73
    v_mov_b32 v169, v29
    v_perm_b32 v29, v174, v170, s72
    v_perm_b32 v174, v174, v170, s73
    v_mov_b32 v170, v29
    v_perm_b32 v29, v175, v171, s72
    v_perm_b32 v175, v175, v171, s73
    v_mov_b32 v171, v29
    s_waitcnt vmcnt(5)
    s_mov_b32 s64, 81920
    buffer_load_dwordx4 v[184:187], v36, s[36:39], s64 offen
    s_mov_b32 s64, 82944
    buffer_load_dwordx4 v[188:191], v36, s[36:39], s64 offen
    v_dot2_f32_bf16 v16, v40, v4, 0
    v_dot2_f32_bf16 v16, v41, v5, v16
    v_dot2_f32_bf16 v16, v42, v6, v16
    v_dot2_f32_bf16 v16, v43, v7, v16
    s_waitcnt vmcnt(6)
    buffer_load_dwordx4 v[64:67], v3, s[24:27], 0 offen offset:2048 nt
    v_dot2_f32_bf16 v17, v44, v4, 0
    v_dot2_f32_bf16 v17, v45, v5, v17
    v_dot2_f32_bf16 v17, v46, v6, v17
    v_dot2_f32_bf16 v17, v47, v7, v17
    s_waitcnt vmcnt(6)
    buffer_load_dwordx4 v[68:71], v3, s[24:27], 0 offen offset:3072 nt
    v_dot2_f32_bf16 v18, v48, v4, 0
    v_dot2_f32_bf16 v18, v49, v5, v18
    v_dot2_f32_bf16 v18, v50, v6, v18
    v_dot2_f32_bf16 v18, v51, v7, v18
    s_waitcnt vmcnt(6)
    buffer_load_dwordx4 v[72:75], v2, s[28:31], 0 offen offset:0 nt
    v_dot2_f32_bf16 v19, v52, v4, 0
    v_dot2_f32_bf16 v19, v53, v5, v19
    v_dot2_f32_bf16 v19, v54, v6, v19
    v_dot2_f32_bf16 v19, v55, v7, v19
    s_waitcnt vmcnt(6)
    buffer_load_dwordx4 v[76:79], v2, s[28:31], 0 offen offset:1024 nt
    v_dot2_f32_bf16 v20, v56, v4, 0
    v_dot2_f32_bf16 v20, v57, v5, v20
    v_dot2_f32_bf16 v20, v58, v6, v20
    v_dot2_f32_bf16 v20, v59, v7, v20
    s_waitcnt vmcnt(6)
    buffer_load_dwordx4 v[80:83], v2, s[28:31], 0 offen offset:2048 nt
    v_dot2_f32_bf16 v21, v60, v4, 0
    v_dot2_f32_bf16 v21, v61, v5, v21
    v_dot2_f32_bf16 v21, v62, v6, v21
    v_dot2_f32_bf16 v21, v63, v7, v21
    s_waitcnt vmcnt(4)
    buffer_load_dwordx4 v[84:87], v2, s[28:31], 0 offen offset:3072 nt
    v_dot2_f32_bf16 v22, v64, v4, 0
    v_dot2_f32_bf16 v22, v65, v5, v22
    v_dot2_f32_bf16 v22, v66, v6, v22
    v_dot2_f32_bf16 v22, v67, v7, v22
    s_waitcnt vmcnt(4)
    buffer_load_dwordx4 v[88:91], v3, s[28:31], 0 offen offset:0 nt
    buffer_load_dwordx4 v[92:95], v3, s[28:31], 0 offen offset:1024 nt
    v_dot2_f32_bf16 v23, v68, v4, 0
    v_dot2_f32_bf16 v23, v69, v5, v23
    v_dot2_f32_bf16 v23, v70, v6, v23
    v_dot2_f32_bf16 v23, v71, v7, v23
    s_nop 2
    v_add_f32_dpp v16, v16, v16 row_ror:8 row_mask:0xf bank_mask:0x3
    v_add_f32_dpp v17, v17, v17 row_ror:8 row_mask:0xf bank_mask:0x3
    v_add_f32_dpp v18, v18, v18 row_ror:8 row_mask:0xf bank_mask:0x3
    v_add_f32_dpp v19, v19, v19 row_ror:8 row_mask:0xf bank_mask:0x3
    v_add_f32_dpp v16, v20, v20 row_ror:8 row_mask:0xf bank_mask:0xc
    v_add_f32_dpp v17, v21, v21 row_ror:8 row_mask:0xf bank_mask:0xc
    v_add_f32_dpp v18, v22, v22 row_ror:8 row_mask:0xf bank_mask:0xc
    v_add_f32_dpp v19, v23, v23 row_ror:8 row_mask:0xf bank_mask:0xc
    v_add_f32_dpp v16, v16, v16 row_half_mirror row_mask:0xf bank_mask:0x5
    v_add_f32_dpp v17, v17, v17 row_half_mirror row_mask:0xf bank_mask:0x5
    v_add_f32_dpp v16, v18, v18 row_half_mirror row_mask:0xf bank_mask:0xa
    v_add_f32_dpp v17, v19, v19 row_half_mirror row_mask:0xf bank_mask:0xa
    s_nop 0
    v_add_f32_dpp v16, v16, v16 quad_perm:[1,0,3,2] row_mask:0xf bank_mask:0xf
    v_add_f32_dpp v17, v17, v17 quad_perm:[1,0,3,2] row_mask:0xf bank_mask:0xf
    s_nop 0
    v_cndmask_b32 v29, v16, v17, s[76:77]
    s_nop 1
    v_add_f32_dpp v29, v29, v29 quad_perm:[2,3,0,1] row_mask:0xf bank_mask:0xf
    v_mul_f32 v29, s74, v29
    s_nop 1
    v_max_f32_dpp v30, v29, v29 quad_perm:[1,0,3,2] row_mask:0xf bank_mask:0xf
    s_nop 1
    v_max_f32_dpp v30, v30, v30 row_ror:4 row_mask:0xf bank_mask:0xf
    s_nop 1
    v_max_f32_dpp v30, v30, v30 row_ror:8 row_mask:0xf bank_mask:0xf
    v_max_f32 v30, v30, v24
    v_sub_f32 v28, v24, v30
    v_sub_f32 v29, v29, v30
    v_exp_f32 v28, v28
    v_exp_f32 v29, v29
    v_mov_b32 v24, v30
    v_cvt_pk_bf16_f32 v26, v29, 0
    v_cvt_pk_bf16_f32 v27, 0, v29
    v_fma_f32 v25, v25, v28, v29
    v_mul_f32 v8, v28, v8
    v_mul_f32 v9, v28, v9
    v_mul_f32 v10, v28, v10
    v_mul_f32 v11, v28, v11
    v_mul_f32 v12, v28, v12
    v_mul_f32 v13, v28, v13
    v_mul_f32 v14, v28, v14
    v_mul_f32 v15, v28, v15
    s_waitcnt vmcnt(5)
    v_dot2c_f32_bf16_dpp v8, v26, v72 row_newbcast:0 row_mask:0xf bank_mask:0xf
    v_dot2c_f32_bf16_dpp v9, v27, v72 row_newbcast:0 row_mask:0xf bank_mask:0xf
    v_dot2c_f32_bf16_dpp v10, v26, v73 row_newbcast:0 row_mask:0xf bank_mask:0xf
    v_dot2c_f32_bf16_dpp v11, v27, v73 row_newbcast:0 row_mask:0xf bank_mask:0xf
    v_dot2c_f32_bf16_dpp v12, v26, v74 row_newbcast:0 row_mask:0xf bank_mask:0xf
    v_dot2c_f32_bf16_dpp v13, v27, v74 row_newbcast:0 row_mask:0xf bank_mask:0xf
    v_dot2c_f32_bf16_dpp v14, v26, v75 row_newbcast:0 row_mask:0xf bank_mask:0xf
    v_dot2c_f32_bf16_dpp v15, v27, v75 row_newbcast:0 row_mask:0xf bank_mask:0xf
    s_waitcnt vmcnt(4)
    buffer_load_dwordx4 v[96:99], v3, s[28:31], 0 offen offset:2048 nt
    v_dot2c_f32_bf16_dpp v8, v26, v76 row_newbcast:1 row_mask:0xf bank_mask:0xf
    v_dot2c_f32_bf16_dpp v9, v27, v76 row_newbcast:1 row_mask:0xf bank_mask:0xf
    v_dot2c_f32_bf16_dpp v10, v26, v77 row_newbcast:1 row_mask:0xf bank_mask:0xf
    v_dot2c_f32_bf16_dpp v11, v27, v77 row_newbcast:1 row_mask:0xf bank_mask:0xf
    v_dot2c_f32_bf16_dpp v12, v26, v78 row_newbcast:1 row_mask:0xf bank_mask:0xf
    v_dot2c_f32_bf16_dpp v13, v27, v78 row_newbcast:1 row_mask:0xf bank_mask:0xf
    v_dot2c_f32_bf16_dpp v14, v26, v79 row_newbcast:1 row_mask:0xf bank_mask:0xf
    v_dot2c_f32_bf16_dpp v15, v27, v79 row_newbcast:1 row_mask:0xf bank_mask:0xf
    s_waitcnt vmcnt(4)
    buffer_load_dwordx4 v[100:103], v3, s[28:31], 0 offen offset:3072 nt
    v_dot2c_f32_bf16_dpp v8, v26, v80 row_newbcast:4 row_mask:0xf bank_mask:0xf
    v_dot2c_f32_bf16_dpp v9, v27, v80 row_newbcast:4 row_mask:0xf bank_mask:0xf
    v_dot2c_f32_bf16_dpp v10, v26, v81 row_newbcast:4 row_mask:0xf bank_mask:0xf
    v_dot2c_f32_bf16_dpp v11, v27, v81 row_newbcast:4 row_mask:0xf bank_mask:0xf
    v_dot2c_f32_bf16_dpp v12, v26, v82 row_newbcast:4 row_mask:0xf bank_mask:0xf
    v_dot2c_f32_bf16_dpp v13, v27, v82 row_newbcast:4 row_mask:0xf bank_mask:0xf
    v_dot2c_f32_bf16_dpp v14, v26, v83 row_newbcast:4 row_mask:0xf bank_mask:0xf
    v_dot2c_f32_bf16_dpp v15, v27, v83 row_newbcast:4 row_mask:0xf bank_mask:0xf
    s_waitcnt vmcnt(4)
    v_add_u32 v2, 0x8000, v2
    v_add_u32 v3, 0x8000, v3
    buffer_load_dwordx4 v[40:43], v2, s[24:27], 0 offen offset:0 nt
    v_dot2c_f32_bf16_dpp v8, v26, v84 row_newbcast:5 row_mask:0xf bank_mask:0xf
    v_dot2c_f32_bf16_dpp v9, v27, v84 row_newbcast:5 row_mask:0xf bank_mask:0xf
    v_dot2c_f32_bf16_dpp v10, v26, v85 row_newbcast:5 row_mask:0xf bank_mask:0xf
    v_dot2c_f32_bf16_dpp v11, v27, v85 row_newbcast:5 row_mask:0xf bank_mask:0xf
    v_dot2c_f32_bf16_dpp v12, v26, v86 row_newbcast:5 row_mask:0xf bank_mask:0xf
    v_dot2c_f32_bf16_dpp v13, v27, v86 row_newbcast:5 row_mask:0xf bank_mask:0xf
    v_dot2c_f32_bf16_dpp v14, v26, v87 row_newbcast:5 row_mask:0xf bank_mask:0xf
    v_dot2c_f32_bf16_dpp v15, v27, v87 row_newbcast:5 row_mask:0xf bank_mask:0xf
    s_waitcnt vmcnt(4)
    buffer_load_dwordx4 v[44:47], v2, s[24:27], 0 offen offset:1024 nt
    v_dot2c_f32_bf16_dpp v8, v26, v88 row_newbcast:8 row_mask:0xf bank_mask:0xf
    v_dot2c_f32_bf16_dpp v9, v27, v88 row_newbcast:8 row_mask:0xf bank_mask:0xf
    v_dot2c_f32_bf16_dpp v10, v26, v89 row_newbcast:8 row_mask:0xf bank_mask:0xf
    v_dot2c_f32_bf16_dpp v11, v27, v89 row_newbcast:8 row_mask:0xf bank_mask:0xf
    v_dot2c_f32_bf16_dpp v12, v26, v90 row_newbcast:8 row_mask:0xf bank_mask:0xf
    v_dot2c_f32_bf16_dpp v13, v27, v90 row_newbcast:8 row_mask:0xf bank_mask:0xf
    v_dot2c_f32_bf16_dpp v14, v26, v91 row_newbcast:8 row_mask:0xf bank_mask:0xf
    v_dot2c_f32_bf16_dpp v15, v27, v91 row_newbcast:8 row_mask:0xf bank_mask:0xf
    s_waitcnt vmcnt(4)
    buffer_load_dwordx4 v[48:51], v2, s[24:27], 0 offen offset:2048 nt
    v_dot2c_f32_bf16_dpp v8, v26, v92 row_newbcast:9 row_mask:0xf bank_mask:0xf
    v_dot2c_f32_bf16_dpp v9, v27, v92 row_newbcast:9 row_mask:0xf bank_mask:0xf
    v_dot2c_f32_bf16_dpp v10, v26, v93 row_newbcast:9 row_mask:0xf bank_mask:0xf
    v_dot2c_f32_bf16_dpp v11, v27, v93 row_newbcast:9 row_mask:0xf bank_mask:0xf
    v_dot2c_f32_bf16_dpp v12, v26, v94 row_newbcast:9 row_mask:0xf bank_mask:0xf
    v_dot2c_f32_bf16_dpp v13, v27, v94 row_newbcast:9 row_mask:0xf bank_mask:0xf
    v_dot2c_f32_bf16_dpp v14, v26, v95 row_newbcast:9 row_mask:0xf bank_mask:0xf
    v_dot2c_f32_bf16_dpp v15, v27, v95 row_newbcast:9 row_mask:0xf bank_mask:0xf
    s_waitcnt vmcnt(4)
    buffer_load_dwordx4 v[52:55], v2, s[24:27], 0 offen offset:3072 nt
    v_dot2c_f32_bf16_dpp v8, v26, v96 row_newbcast:12 row_mask:0xf bank_mask:0xf
    v_dot2c_f32_bf16_dpp v9, v27, v96 row_newbcast:12 row_mask:0xf bank_mask:0xf
    v_dot2c_f32_bf16_dpp v10, v26, v97 row_newbcast:12 row_mask:0xf bank_mask:0xf
    v_dot2c_f32_bf16_dpp v11, v27, v97 row_newbcast:12 row_mask:0xf bank_mask:0xf
    v_dot2c_f32_bf16_dpp v12, v26, v98 row_newbcast:12 row_mask:0xf bank_mask:0xf
    v_dot2c_f32_bf16_dpp v13, v27, v98 row_newbcast:12 row_mask:0xf bank_mask:0xf
    v_dot2c_f32_bf16_dpp v14, v26, v99 row_newbcast:12 row_mask:0xf bank_mask:0xf
    v_dot2c_f32_bf16_dpp v15, v27, v99 row_newbcast:12 row_mask:0xf bank_mask:0xf
    s_waitcnt vmcnt(4)
    buffer_load_dwordx4 v[56:59], v3, s[24:27], 0 offen offset:0 nt
    buffer_load_dwordx4 v[60:63], v3, s[24:27], 0 offen offset:1024 nt
    v_dot2c_f32_bf16_dpp v8, v26, v100 row_newbcast:13 row_mask:0xf bank_mask:0xf
    v_dot2c_f32_bf16_dpp v9, v27, v100 row_newbcast:13 row_mask:0xf bank_mask:0xf
    v_dot2c_f32_bf16_dpp v10, v26, v101 row_newbcast:13 row_mask:0xf bank_mask:0xf
    v_dot2c_f32_bf16_dpp v11, v27, v101 row_newbcast:13 row_mask:0xf bank_mask:0xf
    v_dot2c_f32_bf16_dpp v12, v26, v102 row_newbcast:13 row_mask:0xf bank_mask:0xf
    v_dot2c_f32_bf16_dpp v13, v27, v102 row_newbcast:13 row_mask:0xf bank_mask:0xf
    v_dot2c_f32_bf16_dpp v14, v26, v103 row_newbcast:13 row_mask:0xf bank_mask:0xf
    v_dot2c_f32_bf16_dpp v15, v27, v103 row_newbcast:13 row_mask:0xf bank_mask:0xf
    v_perm_b32 v29, v180, v176, s72
    v_perm_b32 v180, v180, v176, s73
    v_mov_b32 v176, v29
    v_perm_b32 v29, v181, v177, s72
    v_perm_b32 v181, v181, v177, s73
    v_mov_b32 v177, v29
    v_perm_b32 v29, v182, v178, s72
    v_perm_b32 v182, v182, v178, s73
    v_mov_b32 v178, v29
    v_perm_b32 v29, v183, v179, s72
    v_perm_b32 v183, v183, v179, s73
    v_mov_b32 v179, v29
    s_waitcnt vmcnt(5)
    s_mov_b32 s64, 90112
    buffer_load_dwordx4 v[192:195], v36, s[36:39], s64 offen
    s_mov_b32 s64, 91136
    buffer_load_dwordx4 v[196:199], v36, s[36:39], s64 offen
    v_dot2_f32_bf16 v16, v40, v4, 0
    v_dot2_f32_bf16 v16, v41, v5, v16
    v_dot2_f32_bf16 v16, v42, v6, v16
    v_dot2_f32_bf16 v16, v43, v7, v16
    s_waitcnt vmcnt(6)
    buffer_load_dwordx4 v[64:67], v3, s[24:27], 0 offen offset:2048 nt
    v_dot2_f32_bf16 v17, v44, v4, 0
    v_dot2_f32_bf16 v17, v45, v5, v17
    v_dot2_f32_bf16 v17, v46, v6, v17
    v_dot2_f32_bf16 v17, v47, v7, v17
    s_waitcnt vmcnt(6)
    buffer_load_dwordx4 v[68:71], v3, s[24:27], 0 offen offset:3072 nt
    v_dot2_f32_bf16 v18, v48, v4, 0
    v_dot2_f32_bf16 v18, v49, v5, v18
    v_dot2_f32_bf16 v18, v50, v6, v18
    v_dot2_f32_bf16 v18, v51, v7, v18
    s_waitcnt vmcnt(6)
    buffer_load_dwordx4 v[72:75], v2, s[28:31], 0 offen offset:0 nt
    v_dot2_f32_bf16 v19, v52, v4, 0
    v_dot2_f32_bf16 v19, v53, v5, v19
    v_dot2_f32_bf16 v19, v54, v6, v19
    v_dot2_f32_bf16 v19, v55, v7, v19
    s_waitcnt vmcnt(6)
    buffer_load_dwordx4 v[76:79], v2, s[28:31], 0 offen offset:1024 nt
    v_dot2_f32_bf16 v20, v56, v4, 0
    v_dot2_f32_bf16 v20, v57, v5, v20
    v_dot2_f32_bf16 v20, v58, v6, v20
    v_dot2_f32_bf16 v20, v59, v7, v20
    s_waitcnt vmcnt(6)
    buffer_load_dwordx4 v[80:83], v2, s[28:31], 0 offen offset:2048 nt
    v_dot2_f32_bf16 v21, v60, v4, 0
    v_dot2_f32_bf16 v21, v61, v5, v21
    v_dot2_f32_bf16 v21, v62, v6, v21
    v_dot2_f32_bf16 v21, v63, v7, v21
    s_waitcnt vmcnt(4)
    buffer_load_dwordx4 v[84:87], v2, s[28:31], 0 offen offset:3072 nt
    v_dot2_f32_bf16 v22, v64, v4, 0
    v_dot2_f32_bf16 v22, v65, v5, v22
    v_dot2_f32_bf16 v22, v66, v6, v22
    v_dot2_f32_bf16 v22, v67, v7, v22
    s_waitcnt vmcnt(4)
    buffer_load_dwordx4 v[88:91], v3, s[28:31], 0 offen offset:0 nt
    buffer_load_dwordx4 v[92:95], v3, s[28:31], 0 offen offset:1024 nt
    v_dot2_f32_bf16 v23, v68, v4, 0
    v_dot2_f32_bf16 v23, v69, v5, v23
    v_dot2_f32_bf16 v23, v70, v6, v23
    v_dot2_f32_bf16 v23, v71, v7, v23
    s_nop 2
    v_add_f32_dpp v16, v16, v16 row_ror:8 row_mask:0xf bank_mask:0x3
    v_add_f32_dpp v17, v17, v17 row_ror:8 row_mask:0xf bank_mask:0x3
    v_add_f32_dpp v18, v18, v18 row_ror:8 row_mask:0xf bank_mask:0x3
    v_add_f32_dpp v19, v19, v19 row_ror:8 row_mask:0xf bank_mask:0x3
    v_add_f32_dpp v16, v20, v20 row_ror:8 row_mask:0xf bank_mask:0xc
    v_add_f32_dpp v17, v21, v21 row_ror:8 row_mask:0xf bank_mask:0xc
    v_add_f32_dpp v18, v22, v22 row_ror:8 row_mask:0xf bank_mask:0xc
    v_add_f32_dpp v19, v23, v23 row_ror:8 row_mask:0xf bank_mask:0xc
    v_add_f32_dpp v16, v16, v16 row_half_mirror row_mask:0xf bank_mask:0x5
    v_add_f32_dpp v17, v17, v17 row_half_mirror row_mask:0xf bank_mask:0x5
    v_add_f32_dpp v16, v18, v18 row_half_mirror row_mask:0xf bank_mask:0xa
    v_add_f32_dpp v17, v19, v19 row_half_mirror row_mask:0xf bank_mask:0xa
    s_nop 0
    v_add_f32_dpp v16, v16, v16 quad_perm:[1,0,3,2] row_mask:0xf bank_mask:0xf
    v_add_f32_dpp v17, v17, v17 quad_perm:[1,0,3,2] row_mask:0xf bank_mask:0xf
    s_nop 0
    v_cndmask_b32 v29, v16, v17, s[76:77]
    s_nop 1
    v_add_f32_dpp v29, v29, v29 quad_perm:[2,3,0,1] row_mask:0xf bank_mask:0xf
    v_mul_f32 v29, s74, v29
    s_nop 1
    v_max_f32_dpp v30, v29, v29 quad_perm:[1,0,3,2] row_mask:0xf bank_mask:0xf
    s_nop 1
    v_max_f32_dpp v30, v30, v30 row_ror:4 row_mask:0xf bank_mask:0xf
    s_nop 1
    v_max_f32_dpp v30, v30, v30 row_ror:8 row_mask:0xf bank_mask:0xf
    v_max_f32 v30, v30, v24
    v_sub_f32 v28, v24, v30
    v_sub_f32 v29, v29, v30
    v_exp_f32 v28, v28
    v_exp_f32 v29, v29
    v_mov_b32 v24, v30
    v_cvt_pk_bf16_f32 v26, v29, 0
    v_cvt_pk_bf16_f32 v27, 0, v29
    v_fma_f32 v25, v25, v28, v29
    v_mul_f32 v8, v28, v8
    v_mul_f32 v9, v28, v9
    v_mul_f32 v10, v28, v10
    v_mul_f32 v11, v28, v11
    v_mul_f32 v12, v28, v12
    v_mul_f32 v13, v28, v13
    v_mul_f32 v14, v28, v14
    v_mul_f32 v15, v28, v15
    s_waitcnt vmcnt(5)
    v_dot2c_f32_bf16_dpp v8, v26, v72 row_newbcast:0 row_mask:0xf bank_mask:0xf
    v_dot2c_f32_bf16_dpp v9, v27, v72 row_newbcast:0 row_mask:0xf bank_mask:0xf
    v_dot2c_f32_bf16_dpp v10, v26, v73 row_newbcast:0 row_mask:0xf bank_mask:0xf
    v_dot2c_f32_bf16_dpp v11, v27, v73 row_newbcast:0 row_mask:0xf bank_mask:0xf
    v_dot2c_f32_bf16_dpp v12, v26, v74 row_newbcast:0 row_mask:0xf bank_mask:0xf
    v_dot2c_f32_bf16_dpp v13, v27, v74 row_newbcast:0 row_mask:0xf bank_mask:0xf
    v_dot2c_f32_bf16_dpp v14, v26, v75 row_newbcast:0 row_mask:0xf bank_mask:0xf
    v_dot2c_f32_bf16_dpp v15, v27, v75 row_newbcast:0 row_mask:0xf bank_mask:0xf
    s_waitcnt vmcnt(4)
    buffer_load_dwordx4 v[96:99], v3, s[28:31], 0 offen offset:2048 nt
    v_dot2c_f32_bf16_dpp v8, v26, v76 row_newbcast:1 row_mask:0xf bank_mask:0xf
    v_dot2c_f32_bf16_dpp v9, v27, v76 row_newbcast:1 row_mask:0xf bank_mask:0xf
    v_dot2c_f32_bf16_dpp v10, v26, v77 row_newbcast:1 row_mask:0xf bank_mask:0xf
    v_dot2c_f32_bf16_dpp v11, v27, v77 row_newbcast:1 row_mask:0xf bank_mask:0xf
    v_dot2c_f32_bf16_dpp v12, v26, v78 row_newbcast:1 row_mask:0xf bank_mask:0xf
    v_dot2c_f32_bf16_dpp v13, v27, v78 row_newbcast:1 row_mask:0xf bank_mask:0xf
    v_dot2c_f32_bf16_dpp v14, v26, v79 row_newbcast:1 row_mask:0xf bank_mask:0xf
    v_dot2c_f32_bf16_dpp v15, v27, v79 row_newbcast:1 row_mask:0xf bank_mask:0xf
    s_waitcnt vmcnt(4)
    buffer_load_dwordx4 v[100:103], v3, s[28:31], 0 offen offset:3072 nt
    v_dot2c_f32_bf16_dpp v8, v26, v80 row_newbcast:4 row_mask:0xf bank_mask:0xf
    v_dot2c_f32_bf16_dpp v9, v27, v80 row_newbcast:4 row_mask:0xf bank_mask:0xf
    v_dot2c_f32_bf16_dpp v10, v26, v81 row_newbcast:4 row_mask:0xf bank_mask:0xf
    v_dot2c_f32_bf16_dpp v11, v27, v81 row_newbcast:4 row_mask:0xf bank_mask:0xf
    v_dot2c_f32_bf16_dpp v12, v26, v82 row_newbcast:4 row_mask:0xf bank_mask:0xf
    v_dot2c_f32_bf16_dpp v13, v27, v82 row_newbcast:4 row_mask:0xf bank_mask:0xf
    v_dot2c_f32_bf16_dpp v14, v26, v83 row_newbcast:4 row_mask:0xf bank_mask:0xf
    v_dot2c_f32_bf16_dpp v15, v27, v83 row_newbcast:4 row_mask:0xf bank_mask:0xf
    s_waitcnt vmcnt(4)
    v_add_u32 v2, 0x8000, v2
    v_add_u32 v3, 0x8000, v3
    buffer_load_dwordx4 v[40:43], v2, s[24:27], 0 offen offset:0 nt
    v_dot2c_f32_bf16_dpp v8, v26, v84 row_newbcast:5 row_mask:0xf bank_mask:0xf
    v_dot2c_f32_bf16_dpp v9, v27, v84 row_newbcast:5 row_mask:0xf bank_mask:0xf
    v_dot2c_f32_bf16_dpp v10, v26, v85 row_newbcast:5 row_mask:0xf bank_mask:0xf
    v_dot2c_f32_bf16_dpp v11, v27, v85 row_newbcast:5 row_mask:0xf bank_mask:0xf
    v_dot2c_f32_bf16_dpp v12, v26, v86 row_newbcast:5 row_mask:0xf bank_mask:0xf
    v_dot2c_f32_bf16_dpp v13, v27, v86 row_newbcast:5 row_mask:0xf bank_mask:0xf
    v_dot2c_f32_bf16_dpp v14, v26, v87 row_newbcast:5 row_mask:0xf bank_mask:0xf
    v_dot2c_f32_bf16_dpp v15, v27, v87 row_newbcast:5 row_mask:0xf bank_mask:0xf
    s_waitcnt vmcnt(4)
    buffer_load_dwordx4 v[44:47], v2, s[24:27], 0 offen offset:1024 nt
    v_dot2c_f32_bf16_dpp v8, v26, v88 row_newbcast:8 row_mask:0xf bank_mask:0xf
    v_dot2c_f32_bf16_dpp v9, v27, v88 row_newbcast:8 row_mask:0xf bank_mask:0xf
    v_dot2c_f32_bf16_dpp v10, v26, v89 row_newbcast:8 row_mask:0xf bank_mask:0xf
    v_dot2c_f32_bf16_dpp v11, v27, v89 row_newbcast:8 row_mask:0xf bank_mask:0xf
    v_dot2c_f32_bf16_dpp v12, v26, v90 row_newbcast:8 row_mask:0xf bank_mask:0xf
    v_dot2c_f32_bf16_dpp v13, v27, v90 row_newbcast:8 row_mask:0xf bank_mask:0xf
    v_dot2c_f32_bf16_dpp v14, v26, v91 row_newbcast:8 row_mask:0xf bank_mask:0xf
    v_dot2c_f32_bf16_dpp v15, v27, v91 row_newbcast:8 row_mask:0xf bank_mask:0xf
    s_waitcnt vmcnt(4)
    buffer_load_dwordx4 v[48:51], v2, s[24:27], 0 offen offset:2048 nt
    v_dot2c_f32_bf16_dpp v8, v26, v92 row_newbcast:9 row_mask:0xf bank_mask:0xf
    v_dot2c_f32_bf16_dpp v9, v27, v92 row_newbcast:9 row_mask:0xf bank_mask:0xf
    v_dot2c_f32_bf16_dpp v10, v26, v93 row_newbcast:9 row_mask:0xf bank_mask:0xf
    v_dot2c_f32_bf16_dpp v11, v27, v93 row_newbcast:9 row_mask:0xf bank_mask:0xf
    v_dot2c_f32_bf16_dpp v12, v26, v94 row_newbcast:9 row_mask:0xf bank_mask:0xf
    v_dot2c_f32_bf16_dpp v13, v27, v94 row_newbcast:9 row_mask:0xf bank_mask:0xf
    v_dot2c_f32_bf16_dpp v14, v26, v95 row_newbcast:9 row_mask:0xf bank_mask:0xf
    v_dot2c_f32_bf16_dpp v15, v27, v95 row_newbcast:9 row_mask:0xf bank_mask:0xf
    s_waitcnt vmcnt(4)
    buffer_load_dwordx4 v[52:55], v2, s[24:27], 0 offen offset:3072 nt
    v_dot2c_f32_bf16_dpp v8, v26, v96 row_newbcast:12 row_mask:0xf bank_mask:0xf
    v_dot2c_f32_bf16_dpp v9, v27, v96 row_newbcast:12 row_mask:0xf bank_mask:0xf
    v_dot2c_f32_bf16_dpp v10, v26, v97 row_newbcast:12 row_mask:0xf bank_mask:0xf
    v_dot2c_f32_bf16_dpp v11, v27, v97 row_newbcast:12 row_mask:0xf bank_mask:0xf
    v_dot2c_f32_bf16_dpp v12, v26, v98 row_newbcast:12 row_mask:0xf bank_mask:0xf
    v_dot2c_f32_bf16_dpp v13, v27, v98 row_newbcast:12 row_mask:0xf bank_mask:0xf
    v_dot2c_f32_bf16_dpp v14, v26, v99 row_newbcast:12 row_mask:0xf bank_mask:0xf
    v_dot2c_f32_bf16_dpp v15, v27, v99 row_newbcast:12 row_mask:0xf bank_mask:0xf
    s_waitcnt vmcnt(4)
    buffer_load_dwordx4 v[56:59], v3, s[24:27], 0 offen offset:0 nt
    buffer_load_dwordx4 v[60:63], v3, s[24:27], 0 offen offset:1024 nt
    v_dot2c_f32_bf16_dpp v8, v26, v100 row_newbcast:13 row_mask:0xf bank_mask:0xf
    v_dot2c_f32_bf16_dpp v9, v27, v100 row_newbcast:13 row_mask:0xf bank_mask:0xf
    v_dot2c_f32_bf16_dpp v10, v26, v101 row_newbcast:13 row_mask:0xf bank_mask:0xf
    v_dot2c_f32_bf16_dpp v11, v27, v101 row_newbcast:13 row_mask:0xf bank_mask:0xf
    v_dot2c_f32_bf16_dpp v12, v26, v102 row_newbcast:13 row_mask:0xf bank_mask:0xf
    v_dot2c_f32_bf16_dpp v13, v27, v102 row_newbcast:13 row_mask:0xf bank_mask:0xf
    v_dot2c_f32_bf16_dpp v14, v26, v103 row_newbcast:13 row_mask:0xf bank_mask:0xf
    v_dot2c_f32_bf16_dpp v15, v27, v103 row_newbcast:13 row_mask:0xf bank_mask:0xf
    v_perm_b32 v29, v188, v184, s72
    v_perm_b32 v188, v188, v184, s73
    v_mov_b32 v184, v29
    v_perm_b32 v29, v189, v185, s72
    v_perm_b32 v189, v189, v185, s73
    v_mov_b32 v185, v29
    v_perm_b32 v29, v190, v186, s72
    v_perm_b32 v190, v190, v186, s73
    v_mov_b32 v186, v29
    v_perm_b32 v29, v191, v187, s72
    v_perm_b32 v191, v191, v187, s73
    v_mov_b32 v187, v29
    s_waitcnt vmcnt(5)
    s_mov_b32 s64, 98304
    buffer_load_dwordx4 v[200:203], v36, s[36:39], s64 offen
    s_mov_b32 s64, 99328
    buffer_load_dwordx4 v[204:207], v36, s[36:39], s64 offen
    v_dot2_f32_bf16 v16, v40, v4, 0
    v_dot2_f32_bf16 v16, v41, v5, v16
    v_dot2_f32_bf16 v16, v42, v6, v16
    v_dot2_f32_bf16 v16, v43, v7, v16
    s_waitcnt vmcnt(6)
    buffer_load_dwordx4 v[64:67], v3, s[24:27], 0 offen offset:2048 nt
    v_dot2_f32_bf16 v17, v44, v4, 0
    v_dot2_f32_bf16 v17, v45, v5, v17
    v_dot2_f32_bf16 v17, v46, v6, v17
    v_dot2_f32_bf16 v17, v47, v7, v17
    s_waitcnt vmcnt(6)
    buffer_load_dwordx4 v[68:71], v3, s[24:27], 0 offen offset:3072 nt
    v_dot2_f32_bf16 v18, v48, v4, 0
    v_dot2_f32_bf16 v18, v49, v5, v18
    v_dot2_f32_bf16 v18, v50, v6, v18
    v_dot2_f32_bf16 v18, v51, v7, v18
    s_waitcnt vmcnt(6)
    buffer_load_dwordx4 v[72:75], v2, s[28:31], 0 offen offset:0 nt
    v_dot2_f32_bf16 v19, v52, v4, 0
    v_dot2_f32_bf16 v19, v53, v5, v19
    v_dot2_f32_bf16 v19, v54, v6, v19
    v_dot2_f32_bf16 v19, v55, v7, v19
    s_waitcnt vmcnt(6)
    buffer_load_dwordx4 v[76:79], v2, s[28:31], 0 offen offset:1024 nt
    v_dot2_f32_bf16 v20, v56, v4, 0
    v_dot2_f32_bf16 v20, v57, v5, v20
    v_dot2_f32_bf16 v20, v58, v6, v20
    v_dot2_f32_bf16 v20, v59, v7, v20
    s_waitcnt vmcnt(6)
    buffer_load_dwordx4 v[80:83], v2, s[28:31], 0 offen offset:2048 nt
    v_dot2_f32_bf16 v21, v60, v4, 0
    v_dot2_f32_bf16 v21, v61, v5, v21
    v_dot2_f32_bf16 v21, v62, v6, v21
    v_dot2_f32_bf16 v21, v63, v7, v21
    s_waitcnt vmcnt(4)
    buffer_load_dwordx4 v[84:87], v2, s[28:31], 0 offen offset:3072 nt
    v_dot2_f32_bf16 v22, v64, v4, 0
    v_dot2_f32_bf16 v22, v65, v5, v22
    v_dot2_f32_bf16 v22, v66, v6, v22
    v_dot2_f32_bf16 v22, v67, v7, v22
    s_waitcnt vmcnt(4)
    buffer_load_dwordx4 v[88:91], v3, s[28:31], 0 offen offset:0 nt
    buffer_load_dwordx4 v[92:95], v3, s[28:31], 0 offen offset:1024 nt
    v_dot2_f32_bf16 v23, v68, v4, 0
    v_dot2_f32_bf16 v23, v69, v5, v23
    v_dot2_f32_bf16 v23, v70, v6, v23
    v_dot2_f32_bf16 v23, v71, v7, v23
    s_nop 2
    v_add_f32_dpp v16, v16, v16 row_ror:8 row_mask:0xf bank_mask:0x3
    v_add_f32_dpp v17, v17, v17 row_ror:8 row_mask:0xf bank_mask:0x3
    v_add_f32_dpp v18, v18, v18 row_ror:8 row_mask:0xf bank_mask:0x3
    v_add_f32_dpp v19, v19, v19 row_ror:8 row_mask:0xf bank_mask:0x3
    v_add_f32_dpp v16, v20, v20 row_ror:8 row_mask:0xf bank_mask:0xc
    v_add_f32_dpp v17, v21, v21 row_ror:8 row_mask:0xf bank_mask:0xc
    v_add_f32_dpp v18, v22, v22 row_ror:8 row_mask:0xf bank_mask:0xc
    v_add_f32_dpp v19, v23, v23 row_ror:8 row_mask:0xf bank_mask:0xc
    v_add_f32_dpp v16, v16, v16 row_half_mirror row_mask:0xf bank_mask:0x5
    v_add_f32_dpp v17, v17, v17 row_half_mirror row_mask:0xf bank_mask:0x5
    v_add_f32_dpp v16, v18, v18 row_half_mirror row_mask:0xf bank_mask:0xa
    v_add_f32_dpp v17, v19, v19 row_half_mirror row_mask:0xf bank_mask:0xa
    s_nop 0
    v_add_f32_dpp v16, v16, v16 quad_perm:[1,0,3,2] row_mask:0xf bank_mask:0xf
    v_add_f32_dpp v17, v17, v17 quad_perm:[1,0,3,2] row_mask:0xf bank_mask:0xf
    s_nop 0
    v_cndmask_b32 v29, v16, v17, s[76:77]
    s_nop 1
    v_add_f32_dpp v29, v29, v29 quad_perm:[2,3,0,1] row_mask:0xf bank_mask:0xf
    v_mul_f32 v29, s74, v29
    s_nop 1
    v_max_f32_dpp v30, v29, v29 quad_perm:[1,0,3,2] row_mask:0xf bank_mask:0xf
    s_nop 1
    v_max_f32_dpp v30, v30, v30 row_ror:4 row_mask:0xf bank_mask:0xf
    s_nop 1
    v_max_f32_dpp v30, v30, v30 row_ror:8 row_mask:0xf bank_mask:0xf
    v_max_f32 v30, v30, v24
    v_sub_f32 v28, v24, v30
    v_sub_f32 v29, v29, v30
    v_exp_f32 v28, v28
    v_exp_f32 v29, v29
    v_mov_b32 v24, v30
    v_cvt_pk_bf16_f32 v26, v29, 0
    v_cvt_pk_bf16_f32 v27, 0, v29
    v_fma_f32 v25, v25, v28, v29
    v_mul_f32 v8, v28, v8
    v_mul_f32 v9, v28, v9
    v_mul_f32 v10, v28, v10
    v_mul_f32 v11, v28, v11
    v_mul_f32 v12, v28, v12
    v_mul_f32 v13, v28, v13
    v_mul_f32 v14, v28, v14
    v_mul_f32 v15, v28, v15
    s_waitcnt vmcnt(5)
    v_dot2c_f32_bf16_dpp v8, v26, v72 row_newbcast:0 row_mask:0xf bank_mask:0xf
    v_dot2c_f32_bf16_dpp v9, v27, v72 row_newbcast:0 row_mask:0xf bank_mask:0xf
    v_dot2c_f32_bf16_dpp v10, v26, v73 row_newbcast:0 row_mask:0xf bank_mask:0xf
    v_dot2c_f32_bf16_dpp v11, v27, v73 row_newbcast:0 row_mask:0xf bank_mask:0xf
    v_dot2c_f32_bf16_dpp v12, v26, v74 row_newbcast:0 row_mask:0xf bank_mask:0xf
    v_dot2c_f32_bf16_dpp v13, v27, v74 row_newbcast:0 row_mask:0xf bank_mask:0xf
    v_dot2c_f32_bf16_dpp v14, v26, v75 row_newbcast:0 row_mask:0xf bank_mask:0xf
    v_dot2c_f32_bf16_dpp v15, v27, v75 row_newbcast:0 row_mask:0xf bank_mask:0xf
    s_waitcnt vmcnt(4)
    buffer_load_dwordx4 v[96:99], v3, s[28:31], 0 offen offset:2048 nt
    v_dot2c_f32_bf16_dpp v8, v26, v76 row_newbcast:1 row_mask:0xf bank_mask:0xf
    v_dot2c_f32_bf16_dpp v9, v27, v76 row_newbcast:1 row_mask:0xf bank_mask:0xf
    v_dot2c_f32_bf16_dpp v10, v26, v77 row_newbcast:1 row_mask:0xf bank_mask:0xf
    v_dot2c_f32_bf16_dpp v11, v27, v77 row_newbcast:1 row_mask:0xf bank_mask:0xf
    v_dot2c_f32_bf16_dpp v12, v26, v78 row_newbcast:1 row_mask:0xf bank_mask:0xf
    v_dot2c_f32_bf16_dpp v13, v27, v78 row_newbcast:1 row_mask:0xf bank_mask:0xf
    v_dot2c_f32_bf16_dpp v14, v26, v79 row_newbcast:1 row_mask:0xf bank_mask:0xf
    v_dot2c_f32_bf16_dpp v15, v27, v79 row_newbcast:1 row_mask:0xf bank_mask:0xf
    s_waitcnt vmcnt(4)
    buffer_load_dwordx4 v[100:103], v3, s[28:31], 0 offen offset:3072 nt
    v_dot2c_f32_bf16_dpp v8, v26, v80 row_newbcast:4 row_mask:0xf bank_mask:0xf
    v_dot2c_f32_bf16_dpp v9, v27, v80 row_newbcast:4 row_mask:0xf bank_mask:0xf
    v_dot2c_f32_bf16_dpp v10, v26, v81 row_newbcast:4 row_mask:0xf bank_mask:0xf
    v_dot2c_f32_bf16_dpp v11, v27, v81 row_newbcast:4 row_mask:0xf bank_mask:0xf
    v_dot2c_f32_bf16_dpp v12, v26, v82 row_newbcast:4 row_mask:0xf bank_mask:0xf
    v_dot2c_f32_bf16_dpp v13, v27, v82 row_newbcast:4 row_mask:0xf bank_mask:0xf
    v_dot2c_f32_bf16_dpp v14, v26, v83 row_newbcast:4 row_mask:0xf bank_mask:0xf
    v_dot2c_f32_bf16_dpp v15, v27, v83 row_newbcast:4 row_mask:0xf bank_mask:0xf
    s_waitcnt vmcnt(4)
    v_add_u32 v2, 0x8000, v2
    v_add_u32 v3, 0x8000, v3
    buffer_load_dwordx4 v[40:43], v2, s[24:27], 0 offen offset:0 nt
    v_dot2c_f32_bf16_dpp v8, v26, v84 row_newbcast:5 row_mask:0xf bank_mask:0xf
    v_dot2c_f32_bf16_dpp v9, v27, v84 row_newbcast:5 row_mask:0xf bank_mask:0xf
    v_dot2c_f32_bf16_dpp v10, v26, v85 row_newbcast:5 row_mask:0xf bank_mask:0xf
    v_dot2c_f32_bf16_dpp v11, v27, v85 row_newbcast:5 row_mask:0xf bank_mask:0xf
    v_dot2c_f32_bf16_dpp v12, v26, v86 row_newbcast:5 row_mask:0xf bank_mask:0xf
    v_dot2c_f32_bf16_dpp v13, v27, v86 row_newbcast:5 row_mask:0xf bank_mask:0xf
    v_dot2c_f32_bf16_dpp v14, v26, v87 row_newbcast:5 row_mask:0xf bank_mask:0xf
    v_dot2c_f32_bf16_dpp v15, v27, v87 row_newbcast:5 row_mask:0xf bank_mask:0xf
    s_waitcnt vmcnt(4)
    buffer_load_dwordx4 v[44:47], v2, s[24:27], 0 offen offset:1024 nt
    v_dot2c_f32_bf16_dpp v8, v26, v88 row_newbcast:8 row_mask:0xf bank_mask:0xf
    v_dot2c_f32_bf16_dpp v9, v27, v88 row_newbcast:8 row_mask:0xf bank_mask:0xf
    v_dot2c_f32_bf16_dpp v10, v26, v89 row_newbcast:8 row_mask:0xf bank_mask:0xf
    v_dot2c_f32_bf16_dpp v11, v27, v89 row_newbcast:8 row_mask:0xf bank_mask:0xf
    v_dot2c_f32_bf16_dpp v12, v26, v90 row_newbcast:8 row_mask:0xf bank_mask:0xf
    v_dot2c_f32_bf16_dpp v13, v27, v90 row_newbcast:8 row_mask:0xf bank_mask:0xf
    v_dot2c_f32_bf16_dpp v14, v26, v91 row_newbcast:8 row_mask:0xf bank_mask:0xf
    v_dot2c_f32_bf16_dpp v15, v27, v91 row_newbcast:8 row_mask:0xf bank_mask:0xf
    s_waitcnt vmcnt(4)
    buffer_load_dwordx4 v[48:51], v2, s[24:27], 0 offen offset:2048 nt
    v_dot2c_f32_bf16_dpp v8, v26, v92 row_newbcast:9 row_mask:0xf bank_mask:0xf
    v_dot2c_f32_bf16_dpp v9, v27, v92 row_newbcast:9 row_mask:0xf bank_mask:0xf
    v_dot2c_f32_bf16_dpp v10, v26, v93 row_newbcast:9 row_mask:0xf bank_mask:0xf
    v_dot2c_f32_bf16_dpp v11, v27, v93 row_newbcast:9 row_mask:0xf bank_mask:0xf
    v_dot2c_f32_bf16_dpp v12, v26, v94 row_newbcast:9 row_mask:0xf bank_mask:0xf
    v_dot2c_f32_bf16_dpp v13, v27, v94 row_newbcast:9 row_mask:0xf bank_mask:0xf
    v_dot2c_f32_bf16_dpp v14, v26, v95 row_newbcast:9 row_mask:0xf bank_mask:0xf
    v_dot2c_f32_bf16_dpp v15, v27, v95 row_newbcast:9 row_mask:0xf bank_mask:0xf
    s_waitcnt vmcnt(4)
    buffer_load_dwordx4 v[52:55], v2, s[24:27], 0 offen offset:3072 nt
    v_dot2c_f32_bf16_dpp v8, v26, v96 row_newbcast:12 row_mask:0xf bank_mask:0xf
    v_dot2c_f32_bf16_dpp v9, v27, v96 row_newbcast:12 row_mask:0xf bank_mask:0xf
    v_dot2c_f32_bf16_dpp v10, v26, v97 row_newbcast:12 row_mask:0xf bank_mask:0xf
    v_dot2c_f32_bf16_dpp v11, v27, v97 row_newbcast:12 row_mask:0xf bank_mask:0xf
    v_dot2c_f32_bf16_dpp v12, v26, v98 row_newbcast:12 row_mask:0xf bank_mask:0xf
    v_dot2c_f32_bf16_dpp v13, v27, v98 row_newbcast:12 row_mask:0xf bank_mask:0xf
    v_dot2c_f32_bf16_dpp v14, v26, v99 row_newbcast:12 row_mask:0xf bank_mask:0xf
    v_dot2c_f32_bf16_dpp v15, v27, v99 row_newbcast:12 row_mask:0xf bank_mask:0xf
    s_waitcnt vmcnt(4)
    buffer_load_dwordx4 v[56:59], v3, s[24:27], 0 offen offset:0 nt
    buffer_load_dwordx4 v[60:63], v3, s[24:27], 0 offen offset:1024 nt
    v_dot2c_f32_bf16_dpp v8, v26, v100 row_newbcast:13 row_mask:0xf bank_mask:0xf
    v_dot2c_f32_bf16_dpp v9, v27, v100 row_newbcast:13 row_mask:0xf bank_mask:0xf
    v_dot2c_f32_bf16_dpp v10, v26, v101 row_newbcast:13 row_mask:0xf bank_mask:0xf
    v_dot2c_f32_bf16_dpp v11, v27, v101 row_newbcast:13 row_mask:0xf bank_mask:0xf
    v_dot2c_f32_bf16_dpp v12, v26, v102 row_newbcast:13 row_mask:0xf bank_mask:0xf
    v_dot2c_f32_bf16_dpp v13, v27, v102 row_newbcast:13 row_mask:0xf bank_mask:0xf
    v_dot2c_f32_bf16_dpp v14, v26, v103 row_newbcast:13 row_mask:0xf bank_mask:0xf
    v_dot2c_f32_bf16_dpp v15, v27, v103 row_newbcast:13 row_mask:0xf bank_mask:0xf
    v_perm_b32 v29, v196, v192, s72
    v_perm_b32 v196, v196, v192, s73
    v_mov_b32 v192, v29
    v_perm_b32 v29, v197, v193, s72
    v_perm_b32 v197, v197, v193, s73
    v_mov_b32 v193, v29
    v_perm_b32 v29, v198, v194, s72
    v_perm_b32 v198, v198, v194, s73
    v_mov_b32 v194, v29
    v_perm_b32 v29, v199, v195, s72
    v_perm_b32 v199, v199, v195, s73
    v_mov_b32 v195, v29
    s_waitcnt vmcnt(5)
    s_mov_b32 s64, 106496
    buffer_load_dwordx4 v[208:211], v36, s[36:39], s64 offen
    s_mov_b32 s64, 107520
    buffer_load_dwordx4 v[212:215], v36, s[36:39], s64 offen
    v_dot2_f32_bf16 v16, v40, v4, 0
    v_dot2_f32_bf16 v16, v41, v5, v16
    v_dot2_f32_bf16 v16, v42, v6, v16
    v_dot2_f32_bf16 v16, v43, v7, v16
    s_waitcnt vmcnt(6)
    buffer_load_dwordx4 v[64:67], v3, s[24:27], 0 offen offset:2048 nt
    v_dot2_f32_bf16 v17, v44, v4, 0
    v_dot2_f32_bf16 v17, v45, v5, v17
    v_dot2_f32_bf16 v17, v46, v6, v17
    v_dot2_f32_bf16 v17, v47, v7, v17
    s_waitcnt vmcnt(6)
    buffer_load_dwordx4 v[68:71], v3, s[24:27], 0 offen offset:3072 nt
    v_dot2_f32_bf16 v18, v48, v4, 0
    v_dot2_f32_bf16 v18, v49, v5, v18
    v_dot2_f32_bf16 v18, v50, v6, v18
    v_dot2_f32_bf16 v18, v51, v7, v18
    s_waitcnt vmcnt(6)
    buffer_load_dwordx4 v[72:75], v2, s[28:31], 0 offen offset:0 nt
    v_dot2_f32_bf16 v19, v52, v4, 0
    v_dot2_f32_bf16 v19, v53, v5, v19
    v_dot2_f32_bf16 v19, v54, v6, v19
    v_dot2_f32_bf16 v19, v55, v7, v19
    s_waitcnt vmcnt(6)
    buffer_load_dwordx4 v[76:79], v2, s[28:31], 0 offen offset:1024 nt
    v_dot2_f32_bf16 v20, v56, v4, 0
    v_dot2_f32_bf16 v20, v57, v5, v20
    v_dot2_f32_bf16 v20, v58, v6, v20
    v_dot2_f32_bf16 v20, v59, v7, v20
    s_waitcnt vmcnt(6)
    buffer_load_dwordx4 v[80:83], v2, s[28:31], 0 offen offset:2048 nt
    v_dot2_f32_bf16 v21, v60, v4, 0
    v_dot2_f32_bf16 v21, v61, v5, v21
    v_dot2_f32_bf16 v21, v62, v6, v21
    v_dot2_f32_bf16 v21, v63, v7, v21
    s_waitcnt vmcnt(4)
    buffer_load_dwordx4 v[84:87], v2, s[28:31], 0 offen offset:3072 nt
    v_dot2_f32_bf16 v22, v64, v4, 0
    v_dot2_f32_bf16 v22, v65, v5, v22
    v_dot2_f32_bf16 v22, v66, v6, v22
    v_dot2_f32_bf16 v22, v67, v7, v22
    s_waitcnt vmcnt(4)
    buffer_load_dwordx4 v[88:91], v3, s[28:31], 0 offen offset:0 nt
    buffer_load_dwordx4 v[92:95], v3, s[28:31], 0 offen offset:1024 nt
    v_dot2_f32_bf16 v23, v68, v4, 0
    v_dot2_f32_bf16 v23, v69, v5, v23
    v_dot2_f32_bf16 v23, v70, v6, v23
    v_dot2_f32_bf16 v23, v71, v7, v23
    s_nop 2
    v_add_f32_dpp v16, v16, v16 row_ror:8 row_mask:0xf bank_mask:0x3
    v_add_f32_dpp v17, v17, v17 row_ror:8 row_mask:0xf bank_mask:0x3
    v_add_f32_dpp v18, v18, v18 row_ror:8 row_mask:0xf bank_mask:0x3
    v_add_f32_dpp v19, v19, v19 row_ror:8 row_mask:0xf bank_mask:0x3
    v_add_f32_dpp v16, v20, v20 row_ror:8 row_mask:0xf bank_mask:0xc
    v_add_f32_dpp v17, v21, v21 row_ror:8 row_mask:0xf bank_mask:0xc
    v_add_f32_dpp v18, v22, v22 row_ror:8 row_mask:0xf bank_mask:0xc
    v_add_f32_dpp v19, v23, v23 row_ror:8 row_mask:0xf bank_mask:0xc
    v_add_f32_dpp v16, v16, v16 row_half_mirror row_mask:0xf bank_mask:0x5
    v_add_f32_dpp v17, v17, v17 row_half_mirror row_mask:0xf bank_mask:0x5
    v_add_f32_dpp v16, v18, v18 row_half_mirror row_mask:0xf bank_mask:0xa
    v_add_f32_dpp v17, v19, v19 row_half_mirror row_mask:0xf bank_mask:0xa
    s_nop 0
    v_add_f32_dpp v16, v16, v16 quad_perm:[1,0,3,2] row_mask:0xf bank_mask:0xf
    v_add_f32_dpp v17, v17, v17 quad_perm:[1,0,3,2] row_mask:0xf bank_mask:0xf
    s_nop 0
    v_cndmask_b32 v29, v16, v17, s[76:77]
    s_nop 1
    v_add_f32_dpp v29, v29, v29 quad_perm:[2,3,0,1] row_mask:0xf bank_mask:0xf
    v_mul_f32 v29, s74, v29
    s_nop 1
    v_max_f32_dpp v30, v29, v29 quad_perm:[1,0,3,2] row_mask:0xf bank_mask:0xf
    s_nop 1
    v_max_f32_dpp v30, v30, v30 row_ror:4 row_mask:0xf bank_mask:0xf
    s_nop 1
    v_max_f32_dpp v30, v30, v30 row_ror:8 row_mask:0xf bank_mask:0xf
    v_max_f32 v30, v30, v24
    v_sub_f32 v28, v24, v30
    v_sub_f32 v29, v29, v30
    v_exp_f32 v28, v28
    v_exp_f32 v29, v29
    v_mov_b32 v24, v30
    v_cvt_pk_bf16_f32 v26, v29, 0
    v_cvt_pk_bf16_f32 v27, 0, v29
    v_fma_f32 v25, v25, v28, v29
    v_mul_f32 v8, v28, v8
    v_mul_f32 v9, v28, v9
    v_mul_f32 v10, v28, v10
    v_mul_f32 v11, v28, v11
    v_mul_f32 v12, v28, v12
    v_mul_f32 v13, v28, v13
    v_mul_f32 v14, v28, v14
    v_mul_f32 v15, v28, v15
    s_waitcnt vmcnt(5)
    v_dot2c_f32_bf16_dpp v8, v26, v72 row_newbcast:0 row_mask:0xf bank_mask:0xf
    v_dot2c_f32_bf16_dpp v9, v27, v72 row_newbcast:0 row_mask:0xf bank_mask:0xf
    v_dot2c_f32_bf16_dpp v10, v26, v73 row_newbcast:0 row_mask:0xf bank_mask:0xf
    v_dot2c_f32_bf16_dpp v11, v27, v73 row_newbcast:0 row_mask:0xf bank_mask:0xf
    v_dot2c_f32_bf16_dpp v12, v26, v74 row_newbcast:0 row_mask:0xf bank_mask:0xf
    v_dot2c_f32_bf16_dpp v13, v27, v74 row_newbcast:0 row_mask:0xf bank_mask:0xf
    v_dot2c_f32_bf16_dpp v14, v26, v75 row_newbcast:0 row_mask:0xf bank_mask:0xf
    v_dot2c_f32_bf16_dpp v15, v27, v75 row_newbcast:0 row_mask:0xf bank_mask:0xf
    s_waitcnt vmcnt(4)
    buffer_load_dwordx4 v[96:99], v3, s[28:31], 0 offen offset:2048 nt
    v_dot2c_f32_bf16_dpp v8, v26, v76 row_newbcast:1 row_mask:0xf bank_mask:0xf
    v_dot2c_f32_bf16_dpp v9, v27, v76 row_newbcast:1 row_mask:0xf bank_mask:0xf
    v_dot2c_f32_bf16_dpp v10, v26, v77 row_newbcast:1 row_mask:0xf bank_mask:0xf
    v_dot2c_f32_bf16_dpp v11, v27, v77 row_newbcast:1 row_mask:0xf bank_mask:0xf
    v_dot2c_f32_bf16_dpp v12, v26, v78 row_newbcast:1 row_mask:0xf bank_mask:0xf
    v_dot2c_f32_bf16_dpp v13, v27, v78 row_newbcast:1 row_mask:0xf bank_mask:0xf
    v_dot2c_f32_bf16_dpp v14, v26, v79 row_newbcast:1 row_mask:0xf bank_mask:0xf
    v_dot2c_f32_bf16_dpp v15, v27, v79 row_newbcast:1 row_mask:0xf bank_mask:0xf
    s_waitcnt vmcnt(4)
    buffer_load_dwordx4 v[100:103], v3, s[28:31], 0 offen offset:3072 nt
    v_dot2c_f32_bf16_dpp v8, v26, v80 row_newbcast:4 row_mask:0xf bank_mask:0xf
    v_dot2c_f32_bf16_dpp v9, v27, v80 row_newbcast:4 row_mask:0xf bank_mask:0xf
    v_dot2c_f32_bf16_dpp v10, v26, v81 row_newbcast:4 row_mask:0xf bank_mask:0xf
    v_dot2c_f32_bf16_dpp v11, v27, v81 row_newbcast:4 row_mask:0xf bank_mask:0xf
    v_dot2c_f32_bf16_dpp v12, v26, v82 row_newbcast:4 row_mask:0xf bank_mask:0xf
    v_dot2c_f32_bf16_dpp v13, v27, v82 row_newbcast:4 row_mask:0xf bank_mask:0xf
    v_dot2c_f32_bf16_dpp v14, v26, v83 row_newbcast:4 row_mask:0xf bank_mask:0xf
    v_dot2c_f32_bf16_dpp v15, v27, v83 row_newbcast:4 row_mask:0xf bank_mask:0xf
    s_waitcnt vmcnt(4)
    v_add_u32 v2, 0x8000, v2
    v_add_u32 v3, 0x8000, v3
    buffer_load_dwordx4 v[40:43], v2, s[24:27], 0 offen offset:0 nt
    v_dot2c_f32_bf16_dpp v8, v26, v84 row_newbcast:5 row_mask:0xf bank_mask:0xf
    v_dot2c_f32_bf16_dpp v9, v27, v84 row_newbcast:5 row_mask:0xf bank_mask:0xf
    v_dot2c_f32_bf16_dpp v10, v26, v85 row_newbcast:5 row_mask:0xf bank_mask:0xf
    v_dot2c_f32_bf16_dpp v11, v27, v85 row_newbcast:5 row_mask:0xf bank_mask:0xf
    v_dot2c_f32_bf16_dpp v12, v26, v86 row_newbcast:5 row_mask:0xf bank_mask:0xf
    v_dot2c_f32_bf16_dpp v13, v27, v86 row_newbcast:5 row_mask:0xf bank_mask:0xf
    v_dot2c_f32_bf16_dpp v14, v26, v87 row_newbcast:5 row_mask:0xf bank_mask:0xf
    v_dot2c_f32_bf16_dpp v15, v27, v87 row_newbcast:5 row_mask:0xf bank_mask:0xf
    s_waitcnt vmcnt(4)
    buffer_load_dwordx4 v[44:47], v2, s[24:27], 0 offen offset:1024 nt
    v_dot2c_f32_bf16_dpp v8, v26, v88 row_newbcast:8 row_mask:0xf bank_mask:0xf
    v_dot2c_f32_bf16_dpp v9, v27, v88 row_newbcast:8 row_mask:0xf bank_mask:0xf
    v_dot2c_f32_bf16_dpp v10, v26, v89 row_newbcast:8 row_mask:0xf bank_mask:0xf
    v_dot2c_f32_bf16_dpp v11, v27, v89 row_newbcast:8 row_mask:0xf bank_mask:0xf
    v_dot2c_f32_bf16_dpp v12, v26, v90 row_newbcast:8 row_mask:0xf bank_mask:0xf
    v_dot2c_f32_bf16_dpp v13, v27, v90 row_newbcast:8 row_mask:0xf bank_mask:0xf
    v_dot2c_f32_bf16_dpp v14, v26, v91 row_newbcast:8 row_mask:0xf bank_mask:0xf
    v_dot2c_f32_bf16_dpp v15, v27, v91 row_newbcast:8 row_mask:0xf bank_mask:0xf
    s_waitcnt vmcnt(4)
    buffer_load_dwordx4 v[48:51], v2, s[24:27], 0 offen offset:2048 nt
    v_dot2c_f32_bf16_dpp v8, v26, v92 row_newbcast:9 row_mask:0xf bank_mask:0xf
    v_dot2c_f32_bf16_dpp v9, v27, v92 row_newbcast:9 row_mask:0xf bank_mask:0xf
    v_dot2c_f32_bf16_dpp v10, v26, v93 row_newbcast:9 row_mask:0xf bank_mask:0xf
    v_dot2c_f32_bf16_dpp v11, v27, v93 row_newbcast:9 row_mask:0xf bank_mask:0xf
    v_dot2c_f32_bf16_dpp v12, v26, v94 row_newbcast:9 row_mask:0xf bank_mask:0xf
    v_dot2c_f32_bf16_dpp v13, v27, v94 row_newbcast:9 row_mask:0xf bank_mask:0xf
    v_dot2c_f32_bf16_dpp v14, v26, v95 row_newbcast:9 row_mask:0xf bank_mask:0xf
    v_dot2c_f32_bf16_dpp v15, v27, v95 row_newbcast:9 row_mask:0xf bank_mask:0xf
    s_waitcnt vmcnt(4)
    buffer_load_dwordx4 v[52:55], v2, s[24:27], 0 offen offset:3072 nt
    v_dot2c_f32_bf16_dpp v8, v26, v96 row_newbcast:12 row_mask:0xf bank_mask:0xf
    v_dot2c_f32_bf16_dpp v9, v27, v96 row_newbcast:12 row_mask:0xf bank_mask:0xf
    v_dot2c_f32_bf16_dpp v10, v26, v97 row_newbcast:12 row_mask:0xf bank_mask:0xf
    v_dot2c_f32_bf16_dpp v11, v27, v97 row_newbcast:12 row_mask:0xf bank_mask:0xf
    v_dot2c_f32_bf16_dpp v12, v26, v98 row_newbcast:12 row_mask:0xf bank_mask:0xf
    v_dot2c_f32_bf16_dpp v13, v27, v98 row_newbcast:12 row_mask:0xf bank_mask:0xf
    v_dot2c_f32_bf16_dpp v14, v26, v99 row_newbcast:12 row_mask:0xf bank_mask:0xf
    v_dot2c_f32_bf16_dpp v15, v27, v99 row_newbcast:12 row_mask:0xf bank_mask:0xf
    s_waitcnt vmcnt(4)
    buffer_load_dwordx4 v[56:59], v3, s[24:27], 0 offen offset:0 nt
    buffer_load_dwordx4 v[60:63], v3, s[24:27], 0 offen offset:1024 nt
    v_dot2c_f32_bf16_dpp v8, v26, v100 row_newbcast:13 row_mask:0xf bank_mask:0xf
    v_dot2c_f32_bf16_dpp v9, v27, v100 row_newbcast:13 row_mask:0xf bank_mask:0xf
    v_dot2c_f32_bf16_dpp v10, v26, v101 row_newbcast:13 row_mask:0xf bank_mask:0xf
    v_dot2c_f32_bf16_dpp v11, v27, v101 row_newbcast:13 row_mask:0xf bank_mask:0xf
    v_dot2c_f32_bf16_dpp v12, v26, v102 row_newbcast:13 row_mask:0xf bank_mask:0xf
    v_dot2c_f32_bf16_dpp v13, v27, v102 row_newbcast:13 row_mask:0xf bank_mask:0xf
    v_dot2c_f32_bf16_dpp v14, v26, v103 row_newbcast:13 row_mask:0xf bank_mask:0xf
    v_dot2c_f32_bf16_dpp v15, v27, v103 row_newbcast:13 row_mask:0xf bank_mask:0xf
    v_perm_b32 v29, v204, v200, s72
    v_perm_b32 v204, v204, v200, s73
    v_mov_b32 v200, v29
    v_perm_b32 v29, v205, v201, s72
    v_perm_b32 v205, v205, v201, s73
    v_mov_b32 v201, v29
    v_perm_b32 v29, v206, v202, s72
    v_perm_b32 v206, v206, v202, s73
    v_mov_b32 v202, v29
    v_perm_b32 v29, v207, v203, s72
    v_perm_b32 v207, v207, v203, s73
    v_mov_b32 v203, v29
    s_cmp_lg_u32 s59, 0
    s_cbranch_scc1 L_noflag
    v_mov_b32 v29, 4160
    v_mov_b32 v30, 1
    ds_write_b32 v29, v30
L_noflag:
    s_waitcnt vmcnt(5)
    s_mov_b32 s64, 114688
    buffer_load_dwordx4 v[216:219], v36, s[36:39], s64 offen
    s_mov_b32 s64, 115712
    buffer_load_dwordx4 v[220:223], v36, s[36:39], s64 offen
    v_dot2_f32_bf16 v16, v40, v4, 0
    v_dot2_f32_bf16 v16, v41, v5, v16
    v_dot2_f32_bf16 v16, v42, v6, v16
    v_dot2_f32_bf16 v16, v43, v7, v16
    s_waitcnt vmcnt(6)
    buffer_load_dwordx4 v[64:67], v3, s[24:27], 0 offen offset:2048 nt
    v_dot2_f32_bf16 v17, v44, v4, 0
    v_dot2_f32_bf16 v17, v45, v5, v17
    v_dot2_f32_bf16 v17, v46, v6, v17
    v_dot2_f32_bf16 v17, v47, v7, v17
    s_waitcnt vmcnt(6)
    buffer_load_dwordx4 v[68:71], v3, s[24:27], 0 offen offset:3072 nt
    v_dot2_f32_bf16 v18, v48, v4, 0
    v_dot2_f32_bf16 v18, v49, v5, v18
    v_dot2_f32_bf16 v18, v50, v6, v18
    v_dot2_f32_bf16 v18, v51, v7, v18
    s_waitcnt vmcnt(6)
    buffer_load_dwordx4 v[72:75], v2, s[28:31], 0 offen offset:0 nt
    v_dot2_f32_bf16 v19, v52, v4, 0
    v_dot2_f32_bf16 v19, v53, v5, v19
    v_dot2_f32_bf16 v19, v54, v6, v19
    v_dot2_f32_bf16 v19, v55, v7, v19
    s_waitcnt vmcnt(6)
    buffer_load_dwordx4 v[76:79], v2, s[28:31], 0 offen offset:1024 nt
    v_dot2_f32_bf16 v20, v56, v4, 0
    v_dot2_f32_bf16 v20, v57, v5, v20
    v_dot2_f32_bf16 v20, v58, v6, v20
    v_dot2_f32_bf16 v20, v59, v7, v20
    s_waitcnt vmcnt(6)
    buffer_load_dwordx4 v[80:83], v2, s[28:31], 0 offen offset:2048 nt
    v_dot2_f32_bf16 v21, v60, v4, 0
    v_dot2_f32_bf16 v21, v61, v5, v21
    v_dot2_f32_bf16 v21, v62, v6, v21
    v_dot2_f32_bf16 v21, v63, v7, v21
    s_waitcnt vmcnt(4)
    buffer_load_dwordx4 v[84:87], v2, s[28:31], 0 offen offset:3072 nt
    v_dot2_f32_bf16 v22, v64, v4, 0
    v_dot2_f32_bf16 v22, v65, v5, v22
    v_dot2_f32_bf16 v22, v66, v6, v22
    v_dot2_f32_bf16 v22, v67, v7, v22
    s_waitcnt vmcnt(4)
    buffer_load_dwordx4 v[88:91], v3, s[28:31], 0 offen offset:0 nt
    buffer_load_dwordx4 v[92:95], v3, s[28:31], 0 offen offset:1024 nt
    v_dot2_f32_bf16 v23, v68, v4, 0
    v_dot2_f32_bf16 v23, v69, v5, v23
    v_dot2_f32_bf16 v23, v70, v6, v23
    v_dot2_f32_bf16 v23, v71, v7, v23
    s_nop 2
    v_add_f32_dpp v16, v16, v16 row_ror:8 row_mask:0xf bank_mask:0x3
    v_add_f32_dpp v17, v17, v17 row_ror:8 row_mask:0xf bank_mask:0x3
    v_add_f32_dpp v18, v18, v18 row_ror:8 row_mask:0xf bank_mask:0x3
    v_add_f32_dpp v19, v19, v19 row_ror:8 row_mask:0xf bank_mask:0x3
    v_add_f32_dpp v16, v20, v20 row_ror:8 row_mask:0xf bank_mask:0xc
    v_add_f32_dpp v17, v21, v21 row_ror:8 row_mask:0xf bank_mask:0xc
    v_add_f32_dpp v18, v22, v22 row_ror:8 row_mask:0xf bank_mask:0xc
    v_add_f32_dpp v19, v23, v23 row_ror:8 row_mask:0xf bank_mask:0xc
    v_add_f32_dpp v16, v16, v16 row_half_mirror row_mask:0xf bank_mask:0x5
    v_add_f32_dpp v17, v17, v17 row_half_mirror row_mask:0xf bank_mask:0x5
    v_add_f32_dpp v16, v18, v18 row_half_mirror row_mask:0xf bank_mask:0xa
    v_add_f32_dpp v17, v19, v19 row_half_mirror row_mask:0xf bank_mask:0xa
    s_nop 0
    v_add_f32_dpp v16, v16, v16 quad_perm:[1,0,3,2] row_mask:0xf bank_mask:0xf
    v_add_f32_dpp v17, v17, v17 quad_perm:[1,0,3,2] row_mask:0xf bank_mask:0xf
    s_nop 0
    v_cndmask_b32 v29, v16, v17, s[76:77]
    s_nop 1
    v_add_f32_dpp v29, v29, v29 quad_perm:[2,3,0,1] row_mask:0xf bank_mask:0xf
    v_mul_f32 v29, s74, v29
    s_nop 1
    v_max_f32_dpp v30, v29, v29 quad_perm:[1,0,3,2] row_mask:0xf bank_mask:0xf
    s_nop 1
    v_max_f32_dpp v30, v30, v30 row_ror:4 row_mask:0xf bank_mask:0xf
    s_nop 1
    v_max_f32_dpp v30, v30, v30 row_ror:8 row_mask:0xf bank_mask:0xf
    v_max_f32 v30, v30, v24
    v_sub_f32 v28, v24, v30
    v_sub_f32 v29, v29, v30
    v_exp_f32 v28, v28
    v_exp_f32 v29, v29
    v_mov_b32 v24, v30
    v_cvt_pk_bf16_f32 v26, v29, 0
    v_cvt_pk_bf16_f32 v27, 0, v29
    v_fma_f32 v25, v25, v28, v29
    v_mul_f32 v8, v28, v8
    v_mul_f32 v9, v28, v9
    v_mul_f32 v10, v28, v10
    v_mul_f32 v11, v28, v11
    v_mul_f32 v12, v28, v12
    v_mul_f32 v13, v28, v13
    v_mul_f32 v14, v28, v14
    v_mul_f32 v15, v28, v15
    s_waitcnt vmcnt(5)
    v_dot2c_f32_bf16_dpp v8, v26, v72 row_newbcast:0 row_mask:0xf bank_mask:0xf
    v_dot2c_f32_bf16_dpp v9, v27, v72 row_newbcast:0 row_mask:0xf bank_mask:0xf
    v_dot2c_f32_bf16_dpp v10, v26, v73 row_newbcast:0 row_mask:0xf bank_mask:0xf
    v_dot2c_f32_bf16_dpp v11, v27, v73 row_newbcast:0 row_mask:0xf bank_mask:0xf
    v_dot2c_f32_bf16_dpp v12, v26, v74 row_newbcast:0 row_mask:0xf bank_mask:0xf
    v_dot2c_f32_bf16_dpp v13, v27, v74 row_newbcast:0 row_mask:0xf bank_mask:0xf
    v_dot2c_f32_bf16_dpp v14, v26, v75 row_newbcast:0 row_mask:0xf bank_mask:0xf
    v_dot2c_f32_bf16_dpp v15, v27, v75 row_newbcast:0 row_mask:0xf bank_mask:0xf
    s_waitcnt vmcnt(4)
    buffer_load_dwordx4 v[96:99], v3, s[28:31], 0 offen offset:2048 nt
    v_dot2c_f32_bf16_dpp v8, v26, v76 row_newbcast:1 row_mask:0xf bank_mask:0xf
    v_dot2c_f32_bf16_dpp v9, v27, v76 row_newbcast:1 row_mask:0xf bank_mask:0xf
    v_dot2c_f32_bf16_dpp v10, v26, v77 row_newbcast:1 row_mask:0xf bank_mask:0xf
    v_dot2c_f32_bf16_dpp v11, v27, v77 row_newbcast:1 row_mask:0xf bank_mask:0xf
    v_dot2c_f32_bf16_dpp v12, v26, v78 row_newbcast:1 row_mask:0xf bank_mask:0xf
    v_dot2c_f32_bf16_dpp v13, v27, v78 row_newbcast:1 row_mask:0xf bank_mask:0xf
    v_dot2c_f32_bf16_dpp v14, v26, v79 row_newbcast:1 row_mask:0xf bank_mask:0xf
    v_dot2c_f32_bf16_dpp v15, v27, v79 row_newbcast:1 row_mask:0xf bank_mask:0xf
    s_waitcnt vmcnt(4)
    buffer_load_dwordx4 v[100:103], v3, s[28:31], 0 offen offset:3072 nt
    v_dot2c_f32_bf16_dpp v8, v26, v80 row_newbcast:4 row_mask:0xf bank_mask:0xf
    v_dot2c_f32_bf16_dpp v9, v27, v80 row_newbcast:4 row_mask:0xf bank_mask:0xf
    v_dot2c_f32_bf16_dpp v10, v26, v81 row_newbcast:4 row_mask:0xf bank_mask:0xf
    v_dot2c_f32_bf16_dpp v11, v27, v81 row_newbcast:4 row_mask:0xf bank_mask:0xf
    v_dot2c_f32_bf16_dpp v12, v26, v82 row_newbcast:4 row_mask:0xf bank_mask:0xf
    v_dot2c_f32_bf16_dpp v13, v27, v82 row_newbcast:4 row_mask:0xf bank_mask:0xf
    v_dot2c_f32_bf16_dpp v14, v26, v83 row_newbcast:4 row_mask:0xf bank_mask:0xf
    v_dot2c_f32_bf16_dpp v15, v27, v83 row_newbcast:4 row_mask:0xf bank_mask:0xf
    s_waitcnt vmcnt(4)
    v_add_u32 v2, 0x8000, v2
    v_add_u32 v3, 0x8000, v3
    buffer_load_dwordx4 v[40:43], v2, s[24:27], 0 offen offset:0 nt
    v_dot2c_f32_bf16_dpp v8, v26, v84 row_newbcast:5 row_mask:0xf bank_mask:0xf
    v_dot2c_f32_bf16_dpp v9, v27, v84 row_newbcast:5 row_mask:0xf bank_mask:0xf
    v_dot2c_f32_bf16_dpp v10, v26, v85 row_newbcast:5 row_mask:0xf bank_mask:0xf
    v_dot2c_f32_bf16_dpp v11, v27, v85 row_newbcast:5 row_mask:0xf bank_mask:0xf
    v_dot2c_f32_bf16_dpp v12, v26, v86 row_newbcast:5 row_mask:0xf bank_mask:0xf
    v_dot2c_f32_bf16_dpp v13, v27, v86 row_newbcast:5 row_mask:0xf bank_mask:0xf
    v_dot2c_f32_bf16_dpp v14, v26, v87 row_newbcast:5 row_mask:0xf bank_mask:0xf
    v_dot2c_f32_bf16_dpp v15, v27, v87 row_newbcast:5 row_mask:0xf bank_mask:0xf
    s_waitcnt vmcnt(4)
    buffer_load_dwordx4 v[44:47], v2, s[24:27], 0 offen offset:1024 nt
    v_dot2c_f32_bf16_dpp v8, v26, v88 row_newbcast:8 row_mask:0xf bank_mask:0xf
    v_dot2c_f32_bf16_dpp v9, v27, v88 row_newbcast:8 row_mask:0xf bank_mask:0xf
    v_dot2c_f32_bf16_dpp v10, v26, v89 row_newbcast:8 row_mask:0xf bank_mask:0xf
    v_dot2c_f32_bf16_dpp v11, v27, v89 row_newbcast:8 row_mask:0xf bank_mask:0xf
    v_dot2c_f32_bf16_dpp v12, v26, v90 row_newbcast:8 row_mask:0xf bank_mask:0xf
    v_dot2c_f32_bf16_dpp v13, v27, v90 row_newbcast:8 row_mask:0xf bank_mask:0xf
    v_dot2c_f32_bf16_dpp v14, v26, v91 row_newbcast:8 row_mask:0xf bank_mask:0xf
    v_dot2c_f32_bf16_dpp v15, v27, v91 row_newbcast:8 row_mask:0xf bank_mask:0xf
    s_waitcnt vmcnt(4)
    buffer_load_dwordx4 v[48:51], v2, s[24:27], 0 offen offset:2048 nt
    v_dot2c_f32_bf16_dpp v8, v26, v92 row_newbcast:9 row_mask:0xf bank_mask:0xf
    v_dot2c_f32_bf16_dpp v9, v27, v92 row_newbcast:9 row_mask:0xf bank_mask:0xf
    v_dot2c_f32_bf16_dpp v10, v26, v93 row_newbcast:9 row_mask:0xf bank_mask:0xf
    v_dot2c_f32_bf16_dpp v11, v27, v93 row_newbcast:9 row_mask:0xf bank_mask:0xf
    v_dot2c_f32_bf16_dpp v12, v26, v94 row_newbcast:9 row_mask:0xf bank_mask:0xf
    v_dot2c_f32_bf16_dpp v13, v27, v94 row_newbcast:9 row_mask:0xf bank_mask:0xf
    v_dot2c_f32_bf16_dpp v14, v26, v95 row_newbcast:9 row_mask:0xf bank_mask:0xf
    v_dot2c_f32_bf16_dpp v15, v27, v95 row_newbcast:9 row_mask:0xf bank_mask:0xf
    s_waitcnt vmcnt(4)
    buffer_load_dwordx4 v[52:55], v2, s[24:27], 0 offen offset:3072 nt
    v_dot2c_f32_bf16_dpp v8, v26, v96 row_newbcast:12 row_mask:0xf bank_mask:0xf
    v_dot2c_f32_bf16_dpp v9, v27, v96 row_newbcast:12 row_mask:0xf bank_mask:0xf
    v_dot2c_f32_bf16_dpp v10, v26, v97 row_newbcast:12 row_mask:0xf bank_mask:0xf
    v_dot2c_f32_bf16_dpp v11, v27, v97 row_newbcast:12 row_mask:0xf bank_mask:0xf
    v_dot2c_f32_bf16_dpp v12, v26, v98 row_newbcast:12 row_mask:0xf bank_mask:0xf
    v_dot2c_f32_bf16_dpp v13, v27, v98 row_newbcast:12 row_mask:0xf bank_mask:0xf
    v_dot2c_f32_bf16_dpp v14, v26, v99 row_newbcast:12 row_mask:0xf bank_mask:0xf
    v_dot2c_f32_bf16_dpp v15, v27, v99 row_newbcast:12 row_mask:0xf bank_mask:0xf
    s_waitcnt vmcnt(4)
    buffer_load_dwordx4 v[56:59], v3, s[24:27], 0 offen offset:0 nt
    buffer_load_dwordx4 v[60:63], v3, s[24:27], 0 offen offset:1024 nt
    v_dot2c_f32_bf16_dpp v8, v26, v100 row_newbcast:13 row_mask:0xf bank_mask:0xf
    v_dot2c_f32_bf16_dpp v9, v27, v100 row_newbcast:13 row_mask:0xf bank_mask:0xf
    v_dot2c_f32_bf16_dpp v10, v26, v101 row_newbcast:13 row_mask:0xf bank_mask:0xf
    v_dot2c_f32_bf16_dpp v11, v27, v101 row_newbcast:13 row_mask:0xf bank_mask:0xf
    v_dot2c_f32_bf16_dpp v12, v26, v102 row_newbcast:13 row_mask:0xf bank_mask:0xf
    v_dot2c_f32_bf16_dpp v13, v27, v102 row_newbcast:13 row_mask:0xf bank_mask:0xf
    v_dot2c_f32_bf16_dpp v14, v26, v103 row_newbcast:13 row_mask:0xf bank_mask:0xf
    v_dot2c_f32_bf16_dpp v15, v27, v103 row_newbcast:13 row_mask:0xf bank_mask:0xf
    v_perm_b32 v29, v212, v208, s72
    v_perm_b32 v212, v212, v208, s73
    v_mov_b32 v208, v29
    v_perm_b32 v29, v213, v209, s72
    v_perm_b32 v213, v213, v209, s73
    v_mov_b32 v209, v29
    v_perm_b32 v29, v214, v210, s72
    v_perm_b32 v214, v214, v210, s73
    v_mov_b32 v210, v29
    v_perm_b32 v29, v215, v211, s72
    v_perm_b32 v215, v215, v211, s73
    v_mov_b32 v211, v29
    s_waitcnt vmcnt(5)
    s_mov_b32 s64, 122880
    buffer_load_dwordx4 v[224:227], v36, s[36:39], s64 offen
    s_mov_b32 s64, 123904
    buffer_load_dwordx4 v[228:231], v36, s[36:39], s64 offen
    v_dot2_f32_bf16 v16, v40, v4, 0
    v_dot2_f32_bf16 v16, v41, v5, v16
    v_dot2_f32_bf16 v16, v42, v6, v16
    v_dot2_f32_bf16 v16, v43, v7, v16
    s_waitcnt vmcnt(6)
    buffer_load_dwordx4 v[64:67], v3, s[24:27], 0 offen offset:2048 nt
    v_dot2_f32_bf16 v17, v44, v4, 0
    v_dot2_f32_bf16 v17, v45, v5, v17
    v_dot2_f32_bf16 v17, v46, v6, v17
    v_dot2_f32_bf16 v17, v47, v7, v17
    s_waitcnt vmcnt(6)
    buffer_load_dwordx4 v[68:71], v3, s[24:27], 0 offen offset:3072 nt
    v_dot2_f32_bf16 v18, v48, v4, 0
    v_dot2_f32_bf16 v18, v49, v5, v18
    v_dot2_f32_bf16 v18, v50, v6, v18
    v_dot2_f32_bf16 v18, v51, v7, v18
    s_waitcnt vmcnt(6)
    buffer_load_dwordx4 v[72:75], v2, s[28:31], 0 offen offset:0 nt
    v_dot2_f32_bf16 v19, v52, v4, 0
    v_dot2_f32_bf16 v19, v53, v5, v19
    v_dot2_f32_bf16 v19, v54, v6, v19
    v_dot2_f32_bf16 v19, v55, v7, v19
    s_waitcnt vmcnt(6)
    buffer_load_dwordx4 v[76:79], v2, s[28:31], 0 offen offset:1024 nt
    v_dot2_f32_bf16 v20, v56, v4, 0
    v_dot2_f32_bf16 v20, v57, v5, v20
    v_dot2_f32_bf16 v20, v58, v6, v20
    v_dot2_f32_bf16 v20, v59, v7, v20
    s_waitcnt vmcnt(6)
    buffer_load_dwordx4 v[80:83], v2, s[28:31], 0 offen offset:2048 nt
    v_dot2_f32_bf16 v21, v60, v4, 0
    v_dot2_f32_bf16 v21, v61, v5, v21
    v_dot2_f32_bf16 v21, v62, v6, v21
    v_dot2_f32_bf16 v21, v63, v7, v21
    s_waitcnt vmcnt(4)
    buffer_load_dwordx4 v[84:87], v2, s[28:31], 0 offen offset:3072 nt
    v_dot2_f32_bf16 v22, v64, v4, 0
    v_dot2_f32_bf16 v22, v65, v5, v22
    v_dot2_f32_bf16 v22, v66, v6, v22
    v_dot2_f32_bf16 v22, v67, v7, v22
    s_waitcnt vmcnt(4)
    buffer_load_dwordx4 v[88:91], v3, s[28:31], 0 offen offset:0 nt
    buffer_load_dwordx4 v[92:95], v3, s[28:31], 0 offen offset:1024 nt
    v_dot2_f32_bf16 v23, v68, v4, 0
    v_dot2_f32_bf16 v23, v69, v5, v23
    v_dot2_f32_bf16 v23, v70, v6, v23
    v_dot2_f32_bf16 v23, v71, v7, v23
    s_nop 2
    v_add_f32_dpp v16, v16, v16 row_ror:8 row_mask:0xf bank_mask:0x3
    v_add_f32_dpp v17, v17, v17 row_ror:8 row_mask:0xf bank_mask:0x3
    v_add_f32_dpp v18, v18, v18 row_ror:8 row_mask:0xf bank_mask:0x3
    v_add_f32_dpp v19, v19, v19 row_ror:8 row_mask:0xf bank_mask:0x3
    v_add_f32_dpp v16, v20, v20 row_ror:8 row_mask:0xf bank_mask:0xc
    v_add_f32_dpp v17, v21, v21 row_ror:8 row_mask:0xf bank_mask:0xc
    v_add_f32_dpp v18, v22, v22 row_ror:8 row_mask:0xf bank_mask:0xc
    v_add_f32_dpp v19, v23, v23 row_ror:8 row_mask:0xf bank_mask:0xc
    v_add_f32_dpp v16, v16, v16 row_half_mirror row_mask:0xf bank_mask:0x5
    v_add_f32_dpp v17, v17, v17 row_half_mirror row_mask:0xf bank_mask:0x5
    v_add_f32_dpp v16, v18, v18 row_half_mirror row_mask:0xf bank_mask:0xa
    v_add_f32_dpp v17, v19, v19 row_half_mirror row_mask:0xf bank_mask:0xa
    s_nop 0
    v_add_f32_dpp v16, v16, v16 quad_perm:[1,0,3,2] row_mask:0xf bank_mask:0xf
    v_add_f32_dpp v17, v17, v17 quad_perm:[1,0,3,2] row_mask:0xf bank_mask:0xf
    s_nop 0
    v_cndmask_b32 v29, v16, v17, s[76:77]
    s_nop 1
    v_add_f32_dpp v29, v29, v29 quad_perm:[2,3,0,1] row_mask:0xf bank_mask:0xf
    v_mul_f32 v29, s74, v29
    s_nop 1
    v_max_f32_dpp v30, v29, v29 quad_perm:[1,0,3,2] row_mask:0xf bank_mask:0xf
    s_nop 1
    v_max_f32_dpp v30, v30, v30 row_ror:4 row_mask:0xf bank_mask:0xf
    s_nop 1
    v_max_f32_dpp v30, v30, v30 row_ror:8 row_mask:0xf bank_mask:0xf
    v_max_f32 v30, v30, v24
    v_sub_f32 v28, v24, v30
    v_sub_f32 v29, v29, v30
    v_exp_f32 v28, v28
    v_exp_f32 v29, v29
    v_mov_b32 v24, v30
    v_cvt_pk_bf16_f32 v26, v29, 0
    v_cvt_pk_bf16_f32 v27, 0, v29
    v_fma_f32 v25, v25, v28, v29
    v_mul_f32 v8, v28, v8
    v_mul_f32 v9, v28, v9
    v_mul_f32 v10, v28, v10
    v_mul_f32 v11, v28, v11
    v_mul_f32 v12, v28, v12
    v_mul_f32 v13, v28, v13
    v_mul_f32 v14, v28, v14
    v_mul_f32 v15, v28, v15
    s_waitcnt vmcnt(5)
    v_dot2c_f32_bf16_dpp v8, v26, v72 row_newbcast:0 row_mask:0xf bank_mask:0xf
    v_dot2c_f32_bf16_dpp v9, v27, v72 row_newbcast:0 row_mask:0xf bank_mask:0xf
    v_dot2c_f32_bf16_dpp v10, v26, v73 row_newbcast:0 row_mask:0xf bank_mask:0xf
    v_dot2c_f32_bf16_dpp v11, v27, v73 row_newbcast:0 row_mask:0xf bank_mask:0xf
    v_dot2c_f32_bf16_dpp v12, v26, v74 row_newbcast:0 row_mask:0xf bank_mask:0xf
    v_dot2c_f32_bf16_dpp v13, v27, v74 row_newbcast:0 row_mask:0xf bank_mask:0xf
    v_dot2c_f32_bf16_dpp v14, v26, v75 row_newbcast:0 row_mask:0xf bank_mask:0xf
    v_dot2c_f32_bf16_dpp v15, v27, v75 row_newbcast:0 row_mask:0xf bank_mask:0xf
    s_waitcnt vmcnt(4)
    buffer_load_dwordx4 v[96:99], v3, s[28:31], 0 offen offset:2048 nt
    v_dot2c_f32_bf16_dpp v8, v26, v76 row_newbcast:1 row_mask:0xf bank_mask:0xf
    v_dot2c_f32_bf16_dpp v9, v27, v76 row_newbcast:1 row_mask:0xf bank_mask:0xf
    v_dot2c_f32_bf16_dpp v10, v26, v77 row_newbcast:1 row_mask:0xf bank_mask:0xf
    v_dot2c_f32_bf16_dpp v11, v27, v77 row_newbcast:1 row_mask:0xf bank_mask:0xf
    v_dot2c_f32_bf16_dpp v12, v26, v78 row_newbcast:1 row_mask:0xf bank_mask:0xf
    v_dot2c_f32_bf16_dpp v13, v27, v78 row_newbcast:1 row_mask:0xf bank_mask:0xf
    v_dot2c_f32_bf16_dpp v14, v26, v79 row_newbcast:1 row_mask:0xf bank_mask:0xf
    v_dot2c_f32_bf16_dpp v15, v27, v79 row_newbcast:1 row_mask:0xf bank_mask:0xf
    s_waitcnt vmcnt(4)
    buffer_load_dwordx4 v[100:103], v3, s[28:31], 0 offen offset:3072 nt
    v_dot2c_f32_bf16_dpp v8, v26, v80 row_newbcast:4 row_mask:0xf bank_mask:0xf
    v_dot2c_f32_bf16_dpp v9, v27, v80 row_newbcast:4 row_mask:0xf bank_mask:0xf
    v_dot2c_f32_bf16_dpp v10, v26, v81 row_newbcast:4 row_mask:0xf bank_mask:0xf
    v_dot2c_f32_bf16_dpp v11, v27, v81 row_newbcast:4 row_mask:0xf bank_mask:0xf
    v_dot2c_f32_bf16_dpp v12, v26, v82 row_newbcast:4 row_mask:0xf bank_mask:0xf
    v_dot2c_f32_bf16_dpp v13, v27, v82 row_newbcast:4 row_mask:0xf bank_mask:0xf
    v_dot2c_f32_bf16_dpp v14, v26, v83 row_newbcast:4 row_mask:0xf bank_mask:0xf
    v_dot2c_f32_bf16_dpp v15, v27, v83 row_newbcast:4 row_mask:0xf bank_mask:0xf
    s_waitcnt vmcnt(4)
    v_add_u32 v2, 0x8000, v2
    v_add_u32 v3, 0x8000, v3
    buffer_load_dwordx4 v[40:43], v2, s[24:27], 0 offen offset:0 nt
    v_dot2c_f32_bf16_dpp v8, v26, v84 row_newbcast:5 row_mask:0xf bank_mask:0xf
    v_dot2c_f32_bf16_dpp v9, v27, v84 row_newbcast:5 row_mask:0xf bank_mask:0xf
    v_dot2c_f32_bf16_dpp v10, v26, v85 row_newbcast:5 row_mask:0xf bank_mask:0xf
    v_dot2c_f32_bf16_dpp v11, v27, v85 row_newbcast:5 row_mask:0xf bank_mask:0xf
    v_dot2c_f32_bf16_dpp v12, v26, v86 row_newbcast:5 row_mask:0xf bank_mask:0xf
    v_dot2c_f32_bf16_dpp v13, v27, v86 row_newbcast:5 row_mask:0xf bank_mask:0xf
    v_dot2c_f32_bf16_dpp v14, v26, v87 row_newbcast:5 row_mask:0xf bank_mask:0xf
    v_dot2c_f32_bf16_dpp v15, v27, v87 row_newbcast:5 row_mask:0xf bank_mask:0xf
    s_waitcnt vmcnt(4)
    buffer_load_dwordx4 v[44:47], v2, s[24:27], 0 offen offset:1024 nt
    v_dot2c_f32_bf16_dpp v8, v26, v88 row_newbcast:8 row_mask:0xf bank_mask:0xf
    v_dot2c_f32_bf16_dpp v9, v27, v88 row_newbcast:8 row_mask:0xf bank_mask:0xf
    v_dot2c_f32_bf16_dpp v10, v26, v89 row_newbcast:8 row_mask:0xf bank_mask:0xf
    v_dot2c_f32_bf16_dpp v11, v27, v89 row_newbcast:8 row_mask:0xf bank_mask:0xf
    v_dot2c_f32_bf16_dpp v12, v26, v90 row_newbcast:8 row_mask:0xf bank_mask:0xf
    v_dot2c_f32_bf16_dpp v13, v27, v90 row_newbcast:8 row_mask:0xf bank_mask:0xf
    v_dot2c_f32_bf16_dpp v14, v26, v91 row_newbcast:8 row_mask:0xf bank_mask:0xf
    v_dot2c_f32_bf16_dpp v15, v27, v91 row_newbcast:8 row_mask:0xf bank_mask:0xf
    s_waitcnt vmcnt(4)
    buffer_load_dwordx4 v[48:51], v2, s[24:27], 0 offen offset:2048 nt
    v_dot2c_f32_bf16_dpp v8, v26, v92 row_newbcast:9 row_mask:0xf bank_mask:0xf
    v_dot2c_f32_bf16_dpp v9, v27, v92 row_newbcast:9 row_mask:0xf bank_mask:0xf
    v_dot2c_f32_bf16_dpp v10, v26, v93 row_newbcast:9 row_mask:0xf bank_mask:0xf
    v_dot2c_f32_bf16_dpp v11, v27, v93 row_newbcast:9 row_mask:0xf bank_mask:0xf
    v_dot2c_f32_bf16_dpp v12, v26, v94 row_newbcast:9 row_mask:0xf bank_mask:0xf
    v_dot2c_f32_bf16_dpp v13, v27, v94 row_newbcast:9 row_mask:0xf bank_mask:0xf
    v_dot2c_f32_bf16_dpp v14, v26, v95 row_newbcast:9 row_mask:0xf bank_mask:0xf
    v_dot2c_f32_bf16_dpp v15, v27, v95 row_newbcast:9 row_mask:0xf bank_mask:0xf
    s_waitcnt vmcnt(4)
    buffer_load_dwordx4 v[52:55], v2, s[24:27], 0 offen offset:3072 nt
    v_dot2c_f32_bf16_dpp v8, v26, v96 row_newbcast:12 row_mask:0xf bank_mask:0xf
    v_dot2c_f32_bf16_dpp v9, v27, v96 row_newbcast:12 row_mask:0xf bank_mask:0xf
    v_dot2c_f32_bf16_dpp v10, v26, v97 row_newbcast:12 row_mask:0xf bank_mask:0xf
    v_dot2c_f32_bf16_dpp v11, v27, v97 row_newbcast:12 row_mask:0xf bank_mask:0xf
    v_dot2c_f32_bf16_dpp v12, v26, v98 row_newbcast:12 row_mask:0xf bank_mask:0xf
    v_dot2c_f32_bf16_dpp v13, v27, v98 row_newbcast:12 row_mask:0xf bank_mask:0xf
    v_dot2c_f32_bf16_dpp v14, v26, v99 row_newbcast:12 row_mask:0xf bank_mask:0xf
    v_dot2c_f32_bf16_dpp v15, v27, v99 row_newbcast:12 row_mask:0xf bank_mask:0xf
    s_waitcnt vmcnt(4)
    buffer_load_dwordx4 v[56:59], v3, s[24:27], 0 offen offset:0 nt
    buffer_load_dwordx4 v[60:63], v3, s[24:27], 0 offen offset:1024 nt
    v_dot2c_f32_bf16_dpp v8, v26, v100 row_newbcast:13 row_mask:0xf bank_mask:0xf
    v_dot2c_f32_bf16_dpp v9, v27, v100 row_newbcast:13 row_mask:0xf bank_mask:0xf
    v_dot2c_f32_bf16_dpp v10, v26, v101 row_newbcast:13 row_mask:0xf bank_mask:0xf
    v_dot2c_f32_bf16_dpp v11, v27, v101 row_newbcast:13 row_mask:0xf bank_mask:0xf
    v_dot2c_f32_bf16_dpp v12, v26, v102 row_newbcast:13 row_mask:0xf bank_mask:0xf
    v_dot2c_f32_bf16_dpp v13, v27, v102 row_newbcast:13 row_mask:0xf bank_mask:0xf
    v_dot2c_f32_bf16_dpp v14, v26, v103 row_newbcast:13 row_mask:0xf bank_mask:0xf
    v_dot2c_f32_bf16_dpp v15, v27, v103 row_newbcast:13 row_mask:0xf bank_mask:0xf
    v_perm_b32 v29, v220, v216, s72
    v_perm_b32 v220, v220, v216, s73
    v_mov_b32 v216, v29
    v_perm_b32 v29, v221, v217, s72
    v_perm_b32 v221, v221, v217, s73
    v_mov_b32 v217, v29
    v_perm_b32 v29, v222, v218, s72
    v_perm_b32 v222, v222, v218, s73
    v_mov_b32 v218, v29
    v_perm_b32 v29, v223, v219, s72
    v_perm_b32 v223, v223, v219, s73
    v_mov_b32 v219, v29
    s_waitcnt vmcnt(5)
    v_dot2_f32_bf16 v16, v40, v4, 0
    v_dot2_f32_bf16 v16, v41, v5, v16
    v_dot2_f32_bf16 v16, v42, v6, v16
    v_dot2_f32_bf16 v16, v43, v7, v16
    s_waitcnt vmcnt(4)
    buffer_load_dwordx4 v[64:67], v3, s[24:27], 0 offen offset:2048 nt
    v_dot2_f32_bf16 v17, v44, v4, 0
    v_dot2_f32_bf16 v17, v45, v5, v17
    v_dot2_f32_bf16 v17, v46, v6, v17
    v_dot2_f32_bf16 v17, v47, v7, v17
    s_waitcnt vmcnt(4)
    buffer_load_dwordx4 v[68:71], v3, s[24:27], 0 offen offset:3072 nt
    v_dot2_f32_bf16 v18, v48, v4, 0
    v_dot2_f32_bf16 v18, v49, v5, v18
    v_dot2_f32_bf16 v18, v50, v6, v18
    v_dot2_f32_bf16 v18, v51, v7, v18
    s_waitcnt vmcnt(4)
    buffer_load_dwordx4 v[72:75], v2, s[28:31], 0 offen offset:0 nt
    v_dot2_f32_bf16 v19, v52, v4, 0
    v_dot2_f32_bf16 v19, v53, v5, v19
    v_dot2_f32_bf16 v19, v54, v6, v19
    v_dot2_f32_bf16 v19, v55, v7, v19
    s_waitcnt vmcnt(4)
    buffer_load_dwordx4 v[76:79], v2, s[28:31], 0 offen offset:1024 nt
    v_dot2_f32_bf16 v20, v56, v4, 0
    v_dot2_f32_bf16 v20, v57, v5, v20
    v_dot2_f32_bf16 v20, v58, v6, v20
    v_dot2_f32_bf16 v20, v59, v7, v20
    s_waitcnt vmcnt(4)
    buffer_load_dwordx4 v[80:83], v2, s[28:31], 0 offen offset:2048 nt
    v_dot2_f32_bf16 v21, v60, v4, 0
    v_dot2_f32_bf16 v21, v61, v5, v21
    v_dot2_f32_bf16 v21, v62, v6, v21
    v_dot2_f32_bf16 v21, v63, v7, v21
    s_waitcnt vmcnt(4)
    buffer_load_dwordx4 v[84:87], v2, s[28:31], 0 offen offset:3072 nt
    v_dot2_f32_bf16 v22, v64, v4, 0
    v_dot2_f32_bf16 v22, v65, v5, v22
    v_dot2_f32_bf16 v22, v66, v6, v22
    v_dot2_f32_bf16 v22, v67, v7, v22
    s_waitcnt vmcnt(4)
    buffer_load_dwordx4 v[88:91], v3, s[28:31], 0 offen offset:0 nt
    buffer_load_dwordx4 v[92:95], v3, s[28:31], 0 offen offset:1024 nt
    v_dot2_f32_bf16 v23, v68, v4, 0
    v_dot2_f32_bf16 v23, v69, v5, v23
    v_dot2_f32_bf16 v23, v70, v6, v23
    v_dot2_f32_bf16 v23, v71, v7, v23
    s_nop 2
    v_add_f32_dpp v16, v16, v16 row_ror:8 row_mask:0xf bank_mask:0x3
    v_add_f32_dpp v17, v17, v17 row_ror:8 row_mask:0xf bank_mask:0x3
    v_add_f32_dpp v18, v18, v18 row_ror:8 row_mask:0xf bank_mask:0x3
    v_add_f32_dpp v19, v19, v19 row_ror:8 row_mask:0xf bank_mask:0x3
    v_add_f32_dpp v16, v20, v20 row_ror:8 row_mask:0xf bank_mask:0xc
    v_add_f32_dpp v17, v21, v21 row_ror:8 row_mask:0xf bank_mask:0xc
    v_add_f32_dpp v18, v22, v22 row_ror:8 row_mask:0xf bank_mask:0xc
    v_add_f32_dpp v19, v23, v23 row_ror:8 row_mask:0xf bank_mask:0xc
    v_add_f32_dpp v16, v16, v16 row_half_mirror row_mask:0xf bank_mask:0x5
    v_add_f32_dpp v17, v17, v17 row_half_mirror row_mask:0xf bank_mask:0x5
    v_add_f32_dpp v16, v18, v18 row_half_mirror row_mask:0xf bank_mask:0xa
    v_add_f32_dpp v17, v19, v19 row_half_mirror row_mask:0xf bank_mask:0xa
    s_nop 0
    v_add_f32_dpp v16, v16, v16 quad_perm:[1,0,3,2] row_mask:0xf bank_mask:0xf
    v_add_f32_dpp v17, v17, v17 quad_perm:[1,0,3,2] row_mask:0xf bank_mask:0xf
    s_nop 0
    v_cndmask_b32 v29, v16, v17, s[76:77]
    s_nop 1
    v_add_f32_dpp v29, v29, v29 quad_perm:[2,3,0,1] row_mask:0xf bank_mask:0xf
    v_mul_f32 v29, s74, v29
    s_nop 1
    v_max_f32_dpp v30, v29, v29 quad_perm:[1,0,3,2] row_mask:0xf bank_mask:0xf
    s_nop 1
    v_max_f32_dpp v30, v30, v30 row_ror:4 row_mask:0xf bank_mask:0xf
    s_nop 1
    v_max_f32_dpp v30, v30, v30 row_ror:8 row_mask:0xf bank_mask:0xf
    v_max_f32 v30, v30, v24
    v_sub_f32 v28, v24, v30
    v_sub_f32 v29, v29, v30
    v_exp_f32 v28, v28
    v_exp_f32 v29, v29
    v_mov_b32 v24, v30
    v_cvt_pk_bf16_f32 v26, v29, 0
    v_cvt_pk_bf16_f32 v27, 0, v29
    v_fma_f32 v25, v25, v28, v29
    v_mul_f32 v8, v28, v8
    v_mul_f32 v9, v28, v9
    v_mul_f32 v10, v28, v10
    v_mul_f32 v11, v28, v11
    v_mul_f32 v12, v28, v12
    v_mul_f32 v13, v28, v13
    v_mul_f32 v14, v28, v14
    v_mul_f32 v15, v28, v15
    s_waitcnt vmcnt(5)
    v_dot2c_f32_bf16_dpp v8, v26, v72 row_newbcast:0 row_mask:0xf bank_mask:0xf
    v_dot2c_f32_bf16_dpp v9, v27, v72 row_newbcast:0 row_mask:0xf bank_mask:0xf
    v_dot2c_f32_bf16_dpp v10, v26, v73 row_newbcast:0 row_mask:0xf bank_mask:0xf
    v_dot2c_f32_bf16_dpp v11, v27, v73 row_newbcast:0 row_mask:0xf bank_mask:0xf
    v_dot2c_f32_bf16_dpp v12, v26, v74 row_newbcast:0 row_mask:0xf bank_mask:0xf
    v_dot2c_f32_bf16_dpp v13, v27, v74 row_newbcast:0 row_mask:0xf bank_mask:0xf
    v_dot2c_f32_bf16_dpp v14, v26, v75 row_newbcast:0 row_mask:0xf bank_mask:0xf
    v_dot2c_f32_bf16_dpp v15, v27, v75 row_newbcast:0 row_mask:0xf bank_mask:0xf
    s_waitcnt vmcnt(4)
    buffer_load_dwordx4 v[96:99], v3, s[28:31], 0 offen offset:2048 nt
    v_dot2c_f32_bf16_dpp v8, v26, v76 row_newbcast:1 row_mask:0xf bank_mask:0xf
    v_dot2c_f32_bf16_dpp v9, v27, v76 row_newbcast:1 row_mask:0xf bank_mask:0xf
    v_dot2c_f32_bf16_dpp v10, v26, v77 row_newbcast:1 row_mask:0xf bank_mask:0xf
    v_dot2c_f32_bf16_dpp v11, v27, v77 row_newbcast:1 row_mask:0xf bank_mask:0xf
    v_dot2c_f32_bf16_dpp v12, v26, v78 row_newbcast:1 row_mask:0xf bank_mask:0xf
    v_dot2c_f32_bf16_dpp v13, v27, v78 row_newbcast:1 row_mask:0xf bank_mask:0xf
    v_dot2c_f32_bf16_dpp v14, v26, v79 row_newbcast:1 row_mask:0xf bank_mask:0xf
    v_dot2c_f32_bf16_dpp v15, v27, v79 row_newbcast:1 row_mask:0xf bank_mask:0xf
    s_waitcnt vmcnt(4)
    buffer_load_dwordx4 v[100:103], v3, s[28:31], 0 offen offset:3072 nt
    v_dot2c_f32_bf16_dpp v8, v26, v80 row_newbcast:4 row_mask:0xf bank_mask:0xf
    v_dot2c_f32_bf16_dpp v9, v27, v80 row_newbcast:4 row_mask:0xf bank_mask:0xf
    v_dot2c_f32_bf16_dpp v10, v26, v81 row_newbcast:4 row_mask:0xf bank_mask:0xf
    v_dot2c_f32_bf16_dpp v11, v27, v81 row_newbcast:4 row_mask:0xf bank_mask:0xf
    v_dot2c_f32_bf16_dpp v12, v26, v82 row_newbcast:4 row_mask:0xf bank_mask:0xf
    v_dot2c_f32_bf16_dpp v13, v27, v82 row_newbcast:4 row_mask:0xf bank_mask:0xf
    v_dot2c_f32_bf16_dpp v14, v26, v83 row_newbcast:4 row_mask:0xf bank_mask:0xf
    v_dot2c_f32_bf16_dpp v15, v27, v83 row_newbcast:4 row_mask:0xf bank_mask:0xf
    s_waitcnt vmcnt(4)
    v_add_u32 v2, 0x8000, v2
    v_add_u32 v3, 0x8000, v3
    buffer_load_dwordx4 v[40:43], v2, s[24:27], 0 offen offset:0 nt
    v_dot2c_f32_bf16_dpp v8, v26, v84 row_newbcast:5 row_mask:0xf bank_mask:0xf
    v_dot2c_f32_bf16_dpp v9, v27, v84 row_newbcast:5 row_mask:0xf bank_mask:0xf
    v_dot2c_f32_bf16_dpp v10, v26, v85 row_newbcast:5 row_mask:0xf bank_mask:0xf
    v_dot2c_f32_bf16_dpp v11, v27, v85 row_newbcast:5 row_mask:0xf bank_mask:0xf
    v_dot2c_f32_bf16_dpp v12, v26, v86 row_newbcast:5 row_mask:0xf bank_mask:0xf
    v_dot2c_f32_bf16_dpp v13, v27, v86 row_newbcast:5 row_mask:0xf bank_mask:0xf
    v_dot2c_f32_bf16_dpp v14, v26, v87 row_newbcast:5 row_mask:0xf bank_mask:0xf
    v_dot2c_f32_bf16_dpp v15, v27, v87 row_newbcast:5 row_mask:0xf bank_mask:0xf
    s_waitcnt vmcnt(4)
    buffer_load_dwordx4 v[44:47], v2, s[24:27], 0 offen offset:1024 nt
    v_dot2c_f32_bf16_dpp v8, v26, v88 row_newbcast:8 row_mask:0xf bank_mask:0xf
    v_dot2c_f32_bf16_dpp v9, v27, v88 row_newbcast:8 row_mask:0xf bank_mask:0xf
    v_dot2c_f32_bf16_dpp v10, v26, v89 row_newbcast:8 row_mask:0xf bank_mask:0xf
    v_dot2c_f32_bf16_dpp v11, v27, v89 row_newbcast:8 row_mask:0xf bank_mask:0xf
    v_dot2c_f32_bf16_dpp v12, v26, v90 row_newbcast:8 row_mask:0xf bank_mask:0xf
    v_dot2c_f32_bf16_dpp v13, v27, v90 row_newbcast:8 row_mask:0xf bank_mask:0xf
    v_dot2c_f32_bf16_dpp v14, v26, v91 row_newbcast:8 row_mask:0xf bank_mask:0xf
    v_dot2c_f32_bf16_dpp v15, v27, v91 row_newbcast:8 row_mask:0xf bank_mask:0xf
    s_waitcnt vmcnt(4)
    buffer_load_dwordx4 v[48:51], v2, s[24:27], 0 offen offset:2048 nt
    v_dot2c_f32_bf16_dpp v8, v26, v92 row_newbcast:9 row_mask:0xf bank_mask:0xf
    v_dot2c_f32_bf16_dpp v9, v27, v92 row_newbcast:9 row_mask:0xf bank_mask:0xf
    v_dot2c_f32_bf16_dpp v10, v26, v93 row_newbcast:9 row_mask:0xf bank_mask:0xf
    v_dot2c_f32_bf16_dpp v11, v27, v93 row_newbcast:9 row_mask:0xf bank_mask:0xf
    v_dot2c_f32_bf16_dpp v12, v26, v94 row_newbcast:9 row_mask:0xf bank_mask:0xf
    v_dot2c_f32_bf16_dpp v13, v27, v94 row_newbcast:9 row_mask:0xf bank_mask:0xf
    v_dot2c_f32_bf16_dpp v14, v26, v95 row_newbcast:9 row_mask:0xf bank_mask:0xf
    v_dot2c_f32_bf16_dpp v15, v27, v95 row_newbcast:9 row_mask:0xf bank_mask:0xf
    s_waitcnt vmcnt(4)
    buffer_load_dwordx4 v[52:55], v2, s[24:27], 0 offen offset:3072 nt
    v_dot2c_f32_bf16_dpp v8, v26, v96 row_newbcast:12 row_mask:0xf bank_mask:0xf
    v_dot2c_f32_bf16_dpp v9, v27, v96 row_newbcast:12 row_mask:0xf bank_mask:0xf
    v_dot2c_f32_bf16_dpp v10, v26, v97 row_newbcast:12 row_mask:0xf bank_mask:0xf
    v_dot2c_f32_bf16_dpp v11, v27, v97 row_newbcast:12 row_mask:0xf bank_mask:0xf
    v_dot2c_f32_bf16_dpp v12, v26, v98 row_newbcast:12 row_mask:0xf bank_mask:0xf
    v_dot2c_f32_bf16_dpp v13, v27, v98 row_newbcast:12 row_mask:0xf bank_mask:0xf
    v_dot2c_f32_bf16_dpp v14, v26, v99 row_newbcast:12 row_mask:0xf bank_mask:0xf
    v_dot2c_f32_bf16_dpp v15, v27, v99 row_newbcast:12 row_mask:0xf bank_mask:0xf
    s_waitcnt vmcnt(4)
    buffer_load_dwordx4 v[56:59], v3, s[24:27], 0 offen offset:0 nt
    buffer_load_dwordx4 v[60:63], v3, s[24:27], 0 offen offset:1024 nt
    v_dot2c_f32_bf16_dpp v8, v26, v100 row_newbcast:13 row_mask:0xf bank_mask:0xf
    v_dot2c_f32_bf16_dpp v9, v27, v100 row_newbcast:13 row_mask:0xf bank_mask:0xf
    v_dot2c_f32_bf16_dpp v10, v26, v101 row_newbcast:13 row_mask:0xf bank_mask:0xf
    v_dot2c_f32_bf16_dpp v11, v27, v101 row_newbcast:13 row_mask:0xf bank_mask:0xf
    v_dot2c_f32_bf16_dpp v12, v26, v102 row_newbcast:13 row_mask:0xf bank_mask:0xf
    v_dot2c_f32_bf16_dpp v13, v27, v102 row_newbcast:13 row_mask:0xf bank_mask:0xf
    v_dot2c_f32_bf16_dpp v14, v26, v103 row_newbcast:13 row_mask:0xf bank_mask:0xf
    v_dot2c_f32_bf16_dpp v15, v27, v103 row_newbcast:13 row_mask:0xf bank_mask:0xf
    v_perm_b32 v29, v228, v224, s72
    v_perm_b32 v228, v228, v224, s73
    v_mov_b32 v224, v29
    v_perm_b32 v29, v229, v225, s72
    v_perm_b32 v229, v229, v225, s73
    v_mov_b32 v225, v29
    v_perm_b32 v29, v230, v226, s72
    v_perm_b32 v230, v230, v226, s73
    v_mov_b32 v226, v29
    v_perm_b32 v29, v231, v227, s72
    v_perm_b32 v231, v231, v227, s73
    v_mov_b32 v227, v29
    s_waitcnt vmcnt(5)
    v_dot2_f32_bf16 v16, v40, v4, 0
    v_dot2_f32_bf16 v16, v41, v5, v16
    v_dot2_f32_bf16 v16, v42, v6, v16
    v_dot2_f32_bf16 v16, v43, v7, v16
    s_waitcnt vmcnt(4)
    buffer_load_dwordx4 v[64:67], v3, s[24:27], 0 offen offset:2048 nt
    v_dot2_f32_bf16 v17, v44, v4, 0
    v_dot2_f32_bf16 v17, v45, v5, v17
    v_dot2_f32_bf16 v17, v46, v6, v17
    v_dot2_f32_bf16 v17, v47, v7, v17
    s_waitcnt vmcnt(4)
    buffer_load_dwordx4 v[68:71], v3, s[24:27], 0 offen offset:3072 nt
    v_dot2_f32_bf16 v18, v48, v4, 0
    v_dot2_f32_bf16 v18, v49, v5, v18
    v_dot2_f32_bf16 v18, v50, v6, v18
    v_dot2_f32_bf16 v18, v51, v7, v18
    s_waitcnt vmcnt(4)
    buffer_load_dwordx4 v[72:75], v2, s[28:31], 0 offen offset:0 nt
    v_dot2_f32_bf16 v19, v52, v4, 0
    v_dot2_f32_bf16 v19, v53, v5, v19
    v_dot2_f32_bf16 v19, v54, v6, v19
    v_dot2_f32_bf16 v19, v55, v7, v19
    s_waitcnt vmcnt(4)
    buffer_load_dwordx4 v[76:79], v2, s[28:31], 0 offen offset:1024 nt
    v_dot2_f32_bf16 v20, v56, v4, 0
    v_dot2_f32_bf16 v20, v57, v5, v20
    v_dot2_f32_bf16 v20, v58, v6, v20
    v_dot2_f32_bf16 v20, v59, v7, v20
    s_waitcnt vmcnt(4)
    buffer_load_dwordx4 v[80:83], v2, s[28:31], 0 offen offset:2048 nt
    v_dot2_f32_bf16 v21, v60, v4, 0
    v_dot2_f32_bf16 v21, v61, v5, v21
    v_dot2_f32_bf16 v21, v62, v6, v21
    v_dot2_f32_bf16 v21, v63, v7, v21
    s_waitcnt vmcnt(4)
    buffer_load_dwordx4 v[84:87], v2, s[28:31], 0 offen offset:3072 nt
    v_dot2_f32_bf16 v22, v64, v4, 0
    v_dot2_f32_bf16 v22, v65, v5, v22
    v_dot2_f32_bf16 v22, v66, v6, v22
    v_dot2_f32_bf16 v22, v67, v7, v22
    s_waitcnt vmcnt(4)
    buffer_load_dwordx4 v[88:91], v3, s[28:31], 0 offen offset:0 nt
    buffer_load_dwordx4 v[92:95], v3, s[28:31], 0 offen offset:1024 nt
    v_dot2_f32_bf16 v23, v68, v4, 0
    v_dot2_f32_bf16 v23, v69, v5, v23
    v_dot2_f32_bf16 v23, v70, v6, v23
    v_dot2_f32_bf16 v23, v71, v7, v23
    s_nop 2
    v_add_f32_dpp v16, v16, v16 row_ror:8 row_mask:0xf bank_mask:0x3
    v_add_f32_dpp v17, v17, v17 row_ror:8 row_mask:0xf bank_mask:0x3
    v_add_f32_dpp v18, v18, v18 row_ror:8 row_mask:0xf bank_mask:0x3
    v_add_f32_dpp v19, v19, v19 row_ror:8 row_mask:0xf bank_mask:0x3
    v_add_f32_dpp v16, v20, v20 row_ror:8 row_mask:0xf bank_mask:0xc
    v_add_f32_dpp v17, v21, v21 row_ror:8 row_mask:0xf bank_mask:0xc
    v_add_f32_dpp v18, v22, v22 row_ror:8 row_mask:0xf bank_mask:0xc
    v_add_f32_dpp v19, v23, v23 row_ror:8 row_mask:0xf bank_mask:0xc
    v_add_f32_dpp v16, v16, v16 row_half_mirror row_mask:0xf bank_mask:0x5
    v_add_f32_dpp v17, v17, v17 row_half_mirror row_mask:0xf bank_mask:0x5
    v_add_f32_dpp v16, v18, v18 row_half_mirror row_mask:0xf bank_mask:0xa
    v_add_f32_dpp v17, v19, v19 row_half_mirror row_mask:0xf bank_mask:0xa
    s_nop 0
    v_add_f32_dpp v16, v16, v16 quad_perm:[1,0,3,2] row_mask:0xf bank_mask:0xf
    v_add_f32_dpp v17, v17, v17 quad_perm:[1,0,3,2] row_mask:0xf bank_mask:0xf
    s_nop 0
    v_cndmask_b32 v29, v16, v17, s[76:77]
    s_nop 1
    v_add_f32_dpp v29, v29, v29 quad_perm:[2,3,0,1] row_mask:0xf bank_mask:0xf
    v_mul_f32 v29, s74, v29
    s_nop 1
    v_max_f32_dpp v30, v29, v29 quad_perm:[1,0,3,2] row_mask:0xf bank_mask:0xf
    s_nop 1
    v_max_f32_dpp v30, v30, v30 row_ror:4 row_mask:0xf bank_mask:0xf
    s_nop 1
    v_max_f32_dpp v30, v30, v30 row_ror:8 row_mask:0xf bank_mask:0xf
    v_max_f32 v30, v30, v24
    v_sub_f32 v28, v24, v30
    v_sub_f32 v29, v29, v30
    v_exp_f32 v28, v28
    v_exp_f32 v29, v29
    v_mov_b32 v24, v30
    v_cvt_pk_bf16_f32 v26, v29, 0
    v_cvt_pk_bf16_f32 v27, 0, v29
    v_fma_f32 v25, v25, v28, v29
    v_mul_f32 v8, v28, v8
    v_mul_f32 v9, v28, v9
    v_mul_f32 v10, v28, v10
    v_mul_f32 v11, v28, v11
    v_mul_f32 v12, v28, v12
    v_mul_f32 v13, v28, v13
    v_mul_f32 v14, v28, v14
    v_mul_f32 v15, v28, v15
    s_waitcnt vmcnt(5)
    v_dot2c_f32_bf16_dpp v8, v26, v72 row_newbcast:0 row_mask:0xf bank_mask:0xf
    v_dot2c_f32_bf16_dpp v9, v27, v72 row_newbcast:0 row_mask:0xf bank_mask:0xf
    v_dot2c_f32_bf16_dpp v10, v26, v73 row_newbcast:0 row_mask:0xf bank_mask:0xf
    v_dot2c_f32_bf16_dpp v11, v27, v73 row_newbcast:0 row_mask:0xf bank_mask:0xf
    v_dot2c_f32_bf16_dpp v12, v26, v74 row_newbcast:0 row_mask:0xf bank_mask:0xf
    v_dot2c_f32_bf16_dpp v13, v27, v74 row_newbcast:0 row_mask:0xf bank_mask:0xf
    v_dot2c_f32_bf16_dpp v14, v26, v75 row_newbcast:0 row_mask:0xf bank_mask:0xf
    v_dot2c_f32_bf16_dpp v15, v27, v75 row_newbcast:0 row_mask:0xf bank_mask:0xf
    s_waitcnt vmcnt(4)
    buffer_load_dwordx4 v[96:99], v3, s[28:31], 0 offen offset:2048 nt
    v_dot2c_f32_bf16_dpp v8, v26, v76 row_newbcast:1 row_mask:0xf bank_mask:0xf
    v_dot2c_f32_bf16_dpp v9, v27, v76 row_newbcast:1 row_mask:0xf bank_mask:0xf
    v_dot2c_f32_bf16_dpp v10, v26, v77 row_newbcast:1 row_mask:0xf bank_mask:0xf
    v_dot2c_f32_bf16_dpp v11, v27, v77 row_newbcast:1 row_mask:0xf bank_mask:0xf
    v_dot2c_f32_bf16_dpp v12, v26, v78 row_newbcast:1 row_mask:0xf bank_mask:0xf
    v_dot2c_f32_bf16_dpp v13, v27, v78 row_newbcast:1 row_mask:0xf bank_mask:0xf
    v_dot2c_f32_bf16_dpp v14, v26, v79 row_newbcast:1 row_mask:0xf bank_mask:0xf
    v_dot2c_f32_bf16_dpp v15, v27, v79 row_newbcast:1 row_mask:0xf bank_mask:0xf
    s_waitcnt vmcnt(4)
    buffer_load_dwordx4 v[100:103], v3, s[28:31], 0 offen offset:3072 nt
    v_dot2c_f32_bf16_dpp v8, v26, v80 row_newbcast:4 row_mask:0xf bank_mask:0xf
    v_dot2c_f32_bf16_dpp v9, v27, v80 row_newbcast:4 row_mask:0xf bank_mask:0xf
    v_dot2c_f32_bf16_dpp v10, v26, v81 row_newbcast:4 row_mask:0xf bank_mask:0xf
    v_dot2c_f32_bf16_dpp v11, v27, v81 row_newbcast:4 row_mask:0xf bank_mask:0xf
    v_dot2c_f32_bf16_dpp v12, v26, v82 row_newbcast:4 row_mask:0xf bank_mask:0xf
    v_dot2c_f32_bf16_dpp v13, v27, v82 row_newbcast:4 row_mask:0xf bank_mask:0xf
    v_dot2c_f32_bf16_dpp v14, v26, v83 row_newbcast:4 row_mask:0xf bank_mask:0xf
    v_dot2c_f32_bf16_dpp v15, v27, v83 row_newbcast:4 row_mask:0xf bank_mask:0xf
    s_waitcnt vmcnt(4)
    v_add_u32 v2, 0x8000, v2
    v_add_u32 v3, 0x8000, v3
    buffer_load_dwordx4 v[40:43], v2, s[24:27], 0 offen offset:0 nt
    v_dot2c_f32_bf16_dpp v8, v26, v84 row_newbcast:5 row_mask:0xf bank_mask:0xf
    v_dot2c_f32_bf16_dpp v9, v27, v84 row_newbcast:5 row_mask:0xf bank_mask:0xf
    v_dot2c_f32_bf16_dpp v10, v26, v85 row_newbcast:5 row_mask:0xf bank_mask:0xf
    v_dot2c_f32_bf16_dpp v11, v27, v85 row_newbcast:5 row_mask:0xf bank_mask:0xf
    v_dot2c_f32_bf16_dpp v12, v26, v86 row_newbcast:5 row_mask:0xf bank_mask:0xf
    v_dot2c_f32_bf16_dpp v13, v27, v86 row_newbcast:5 row_mask:0xf bank_mask:0xf
    v_dot2c_f32_bf16_dpp v14, v26, v87 row_newbcast:5 row_mask:0xf bank_mask:0xf
    v_dot2c_f32_bf16_dpp v15, v27, v87 row_newbcast:5 row_mask:0xf bank_mask:0xf
    s_waitcnt vmcnt(4)
    buffer_load_dwordx4 v[44:47], v2, s[24:27], 0 offen offset:1024 nt
    v_dot2c_f32_bf16_dpp v8, v26, v88 row_newbcast:8 row_mask:0xf bank_mask:0xf
    v_dot2c_f32_bf16_dpp v9, v27, v88 row_newbcast:8 row_mask:0xf bank_mask:0xf
    v_dot2c_f32_bf16_dpp v10, v26, v89 row_newbcast:8 row_mask:0xf bank_mask:0xf
    v_dot2c_f32_bf16_dpp v11, v27, v89 row_newbcast:8 row_mask:0xf bank_mask:0xf
    v_dot2c_f32_bf16_dpp v12, v26, v90 row_newbcast:8 row_mask:0xf bank_mask:0xf
    v_dot2c_f32_bf16_dpp v13, v27, v90 row_newbcast:8 row_mask:0xf bank_mask:0xf
    v_dot2c_f32_bf16_dpp v14, v26, v91 row_newbcast:8 row_mask:0xf bank_mask:0xf
    v_dot2c_f32_bf16_dpp v15, v27, v91 row_newbcast:8 row_mask:0xf bank_mask:0xf
    s_waitcnt vmcnt(4)
    buffer_load_dwordx4 v[48:51], v2, s[24:27], 0 offen offset:2048 nt
    v_dot2c_f32_bf16_dpp v8, v26, v92 row_newbcast:9 row_mask:0xf bank_mask:0xf
    v_dot2c_f32_bf16_dpp v9, v27, v92 row_newbcast:9 row_mask:0xf bank_mask:0xf
    v_dot2c_f32_bf16_dpp v10, v26, v93 row_newbcast:9 row_mask:0xf bank_mask:0xf
    v_dot2c_f32_bf16_dpp v11, v27, v93 row_newbcast:9 row_mask:0xf bank_mask:0xf
    v_dot2c_f32_bf16_dpp v12, v26, v94 row_newbcast:9 row_mask:0xf bank_mask:0xf
    v_dot2c_f32_bf16_dpp v13, v27, v94 row_newbcast:9 row_mask:0xf bank_mask:0xf
    v_dot2c_f32_bf16_dpp v14, v26, v95 row_newbcast:9 row_mask:0xf bank_mask:0xf
    v_dot2c_f32_bf16_dpp v15, v27, v95 row_newbcast:9 row_mask:0xf bank_mask:0xf
    s_waitcnt vmcnt(4)
    buffer_load_dwordx4 v[52:55], v2, s[24:27], 0 offen offset:3072 nt
    v_dot2c_f32_bf16_dpp v8, v26, v96 row_newbcast:12 row_mask:0xf bank_mask:0xf
    v_dot2c_f32_bf16_dpp v9, v27, v96 row_newbcast:12 row_mask:0xf bank_mask:0xf
    v_dot2c_f32_bf16_dpp v10, v26, v97 row_newbcast:12 row_mask:0xf bank_mask:0xf
    v_dot2c_f32_bf16_dpp v11, v27, v97 row_newbcast:12 row_mask:0xf bank_mask:0xf
    v_dot2c_f32_bf16_dpp v12, v26, v98 row_newbcast:12 row_mask:0xf bank_mask:0xf
    v_dot2c_f32_bf16_dpp v13, v27, v98 row_newbcast:12 row_mask:0xf bank_mask:0xf
    v_dot2c_f32_bf16_dpp v14, v26, v99 row_newbcast:12 row_mask:0xf bank_mask:0xf
    v_dot2c_f32_bf16_dpp v15, v27, v99 row_newbcast:12 row_mask:0xf bank_mask:0xf
    s_waitcnt vmcnt(4)
    buffer_load_dwordx4 v[56:59], v3, s[24:27], 0 offen offset:0 nt
    buffer_load_dwordx4 v[60:63], v3, s[24:27], 0 offen offset:1024 nt
    v_dot2c_f32_bf16_dpp v8, v26, v100 row_newbcast:13 row_mask:0xf bank_mask:0xf
    v_dot2c_f32_bf16_dpp v9, v27, v100 row_newbcast:13 row_mask:0xf bank_mask:0xf
    v_dot2c_f32_bf16_dpp v10, v26, v101 row_newbcast:13 row_mask:0xf bank_mask:0xf
    v_dot2c_f32_bf16_dpp v11, v27, v101 row_newbcast:13 row_mask:0xf bank_mask:0xf
    v_dot2c_f32_bf16_dpp v12, v26, v102 row_newbcast:13 row_mask:0xf bank_mask:0xf
    v_dot2c_f32_bf16_dpp v13, v27, v102 row_newbcast:13 row_mask:0xf bank_mask:0xf
    v_dot2c_f32_bf16_dpp v14, v26, v103 row_newbcast:13 row_mask:0xf bank_mask:0xf
    v_dot2c_f32_bf16_dpp v15, v27, v103 row_newbcast:13 row_mask:0xf bank_mask:0xf
    s_waitcnt vmcnt(5)
    v_dot2_f32_bf16 v16, v40, v4, 0
    v_dot2_f32_bf16 v16, v41, v5, v16
    v_dot2_f32_bf16 v16, v42, v6, v16
    v_dot2_f32_bf16 v16, v43, v7, v16
    s_waitcnt vmcnt(4)
    buffer_load_dwordx4 v[64:67], v3, s[24:27], 0 offen offset:2048 nt
    v_dot2_f32_bf16 v17, v44, v4, 0
    v_dot2_f32_bf16 v17, v45, v5, v17
    v_dot2_f32_bf16 v17, v46, v6, v17
    v_dot2_f32_bf16 v17, v47, v7, v17
    s_waitcnt vmcnt(4)
    buffer_load_dwordx4 v[68:71], v3, s[24:27], 0 offen offset:3072 nt
    v_dot2_f32_bf16 v18, v48, v4, 0
    v_dot2_f32_bf16 v18, v49, v5, v18
    v_dot2_f32_bf16 v18, v50, v6, v18
    v_dot2_f32_bf16 v18, v51, v7, v18
    s_waitcnt vmcnt(4)
    buffer_load_dwordx4 v[72:75], v2, s[28:31], 0 offen offset:0 nt
    v_dot2_f32_bf16 v19, v52, v4, 0
    v_dot2_f32_bf16 v19, v53, v5, v19
    v_dot2_f32_bf16 v19, v54, v6, v19
    v_dot2_f32_bf16 v19, v55, v7, v19
    s_waitcnt vmcnt(4)
    buffer_load_dwordx4 v[76:79], v2, s[28:31], 0 offen offset:1024 nt
    v_dot2_f32_bf16 v20, v56, v4, 0
    v_dot2_f32_bf16 v20, v57, v5, v20
    v_dot2_f32_bf16 v20, v58, v6, v20
    v_dot2_f32_bf16 v20, v59, v7, v20
    s_waitcnt vmcnt(4)
    buffer_load_dwordx4 v[80:83], v2, s[28:31], 0 offen offset:2048 nt
    v_dot2_f32_bf16 v21, v60, v4, 0
    v_dot2_f32_bf16 v21, v61, v5, v21
    v_dot2_f32_bf16 v21, v62, v6, v21
    v_dot2_f32_bf16 v21, v63, v7, v21
    s_waitcnt vmcnt(4)
    buffer_load_dwordx4 v[84:87], v2, s[28:31], 0 offen offset:3072 nt
    v_dot2_f32_bf16 v22, v64, v4, 0
    v_dot2_f32_bf16 v22, v65, v5, v22
    v_dot2_f32_bf16 v22, v66, v6, v22
    v_dot2_f32_bf16 v22, v67, v7, v22
    s_waitcnt vmcnt(4)
    buffer_load_dwordx4 v[88:91], v3, s[28:31], 0 offen offset:0 nt
    buffer_load_dwordx4 v[92:95], v3, s[28:31], 0 offen offset:1024 nt
    v_dot2_f32_bf16 v23, v68, v4, 0
    v_dot2_f32_bf16 v23, v69, v5, v23
    v_dot2_f32_bf16 v23, v70, v6, v23
    v_dot2_f32_bf16 v23, v71, v7, v23
    s_nop 2
    v_add_f32_dpp v16, v16, v16 row_ror:8 row_mask:0xf bank_mask:0x3
    v_add_f32_dpp v17, v17, v17 row_ror:8 row_mask:0xf bank_mask:0x3
    v_add_f32_dpp v18, v18, v18 row_ror:8 row_mask:0xf bank_mask:0x3
    v_add_f32_dpp v19, v19, v19 row_ror:8 row_mask:0xf bank_mask:0x3
    v_add_f32_dpp v16, v20, v20 row_ror:8 row_mask:0xf bank_mask:0xc
    v_add_f32_dpp v17, v21, v21 row_ror:8 row_mask:0xf bank_mask:0xc
    v_add_f32_dpp v18, v22, v22 row_ror:8 row_mask:0xf bank_mask:0xc
    v_add_f32_dpp v19, v23, v23 row_ror:8 row_mask:0xf bank_mask:0xc
    v_add_f32_dpp v16, v16, v16 row_half_mirror row_mask:0xf bank_mask:0x5
    v_add_f32_dpp v17, v17, v17 row_half_mirror row_mask:0xf bank_mask:0x5
    v_add_f32_dpp v16, v18, v18 row_half_mirror row_mask:0xf bank_mask:0xa
    v_add_f32_dpp v17, v19, v19 row_half_mirror row_mask:0xf bank_mask:0xa
    s_nop 0
    v_add_f32_dpp v16, v16, v16 quad_perm:[1,0,3,2] row_mask:0xf bank_mask:0xf
    v_add_f32_dpp v17, v17, v17 quad_perm:[1,0,3,2] row_mask:0xf bank_mask:0xf
    s_nop 0
    v_cndmask_b32 v29, v16, v17, s[76:77]
    s_nop 1
    v_add_f32_dpp v29, v29, v29 quad_perm:[2,3,0,1] row_mask:0xf bank_mask:0xf
    v_mul_f32 v29, s74, v29
    s_nop 1
    v_max_f32_dpp v30, v29, v29 quad_perm:[1,0,3,2] row_mask:0xf bank_mask:0xf
    s_nop 1
    v_max_f32_dpp v30, v30, v30 row_ror:4 row_mask:0xf bank_mask:0xf
    s_nop 1
    v_max_f32_dpp v30, v30, v30 row_ror:8 row_mask:0xf bank_mask:0xf
    v_max_f32 v30, v30, v24
    v_sub_f32 v28, v24, v30
    v_sub_f32 v29, v29, v30
    v_exp_f32 v28, v28
    v_exp_f32 v29, v29
    v_mov_b32 v24, v30
    v_cvt_pk_bf16_f32 v26, v29, 0
    v_cvt_pk_bf16_f32 v27, 0, v29
    v_fma_f32 v25, v25, v28, v29
    v_mul_f32 v8, v28, v8
    v_mul_f32 v9, v28, v9
    v_mul_f32 v10, v28, v10
    v_mul_f32 v11, v28, v11
    v_mul_f32 v12, v28, v12
    v_mul_f32 v13, v28, v13
    v_mul_f32 v14, v28, v14
    v_mul_f32 v15, v28, v15
    s_waitcnt vmcnt(5)
    v_dot2c_f32_bf16_dpp v8, v26, v72 row_newbcast:0 row_mask:0xf bank_mask:0xf
    v_dot2c_f32_bf16_dpp v9, v27, v72 row_newbcast:0 row_mask:0xf bank_mask:0xf
    v_dot2c_f32_bf16_dpp v10, v26, v73 row_newbcast:0 row_mask:0xf bank_mask:0xf
    v_dot2c_f32_bf16_dpp v11, v27, v73 row_newbcast:0 row_mask:0xf bank_mask:0xf
    v_dot2c_f32_bf16_dpp v12, v26, v74 row_newbcast:0 row_mask:0xf bank_mask:0xf
    v_dot2c_f32_bf16_dpp v13, v27, v74 row_newbcast:0 row_mask:0xf bank_mask:0xf
    v_dot2c_f32_bf16_dpp v14, v26, v75 row_newbcast:0 row_mask:0xf bank_mask:0xf
    v_dot2c_f32_bf16_dpp v15, v27, v75 row_newbcast:0 row_mask:0xf bank_mask:0xf
    s_waitcnt vmcnt(4)
    buffer_load_dwordx4 v[96:99], v3, s[28:31], 0 offen offset:2048 nt
    v_dot2c_f32_bf16_dpp v8, v26, v76 row_newbcast:1 row_mask:0xf bank_mask:0xf
    v_dot2c_f32_bf16_dpp v9, v27, v76 row_newbcast:1 row_mask:0xf bank_mask:0xf
    v_dot2c_f32_bf16_dpp v10, v26, v77 row_newbcast:1 row_mask:0xf bank_mask:0xf
    v_dot2c_f32_bf16_dpp v11, v27, v77 row_newbcast:1 row_mask:0xf bank_mask:0xf
    v_dot2c_f32_bf16_dpp v12, v26, v78 row_newbcast:1 row_mask:0xf bank_mask:0xf
    v_dot2c_f32_bf16_dpp v13, v27, v78 row_newbcast:1 row_mask:0xf bank_mask:0xf
    v_dot2c_f32_bf16_dpp v14, v26, v79 row_newbcast:1 row_mask:0xf bank_mask:0xf
    v_dot2c_f32_bf16_dpp v15, v27, v79 row_newbcast:1 row_mask:0xf bank_mask:0xf
    s_waitcnt vmcnt(4)
    buffer_load_dwordx4 v[100:103], v3, s[28:31], 0 offen offset:3072 nt
    v_dot2c_f32_bf16_dpp v8, v26, v80 row_newbcast:4 row_mask:0xf bank_mask:0xf
    v_dot2c_f32_bf16_dpp v9, v27, v80 row_newbcast:4 row_mask:0xf bank_mask:0xf
    v_dot2c_f32_bf16_dpp v10, v26, v81 row_newbcast:4 row_mask:0xf bank_mask:0xf
    v_dot2c_f32_bf16_dpp v11, v27, v81 row_newbcast:4 row_mask:0xf bank_mask:0xf
    v_dot2c_f32_bf16_dpp v12, v26, v82 row_newbcast:4 row_mask:0xf bank_mask:0xf
    v_dot2c_f32_bf16_dpp v13, v27, v82 row_newbcast:4 row_mask:0xf bank_mask:0xf
    v_dot2c_f32_bf16_dpp v14, v26, v83 row_newbcast:4 row_mask:0xf bank_mask:0xf
    v_dot2c_f32_bf16_dpp v15, v27, v83 row_newbcast:4 row_mask:0xf bank_mask:0xf
    s_waitcnt vmcnt(4)
    v_add_u32 v2, 0x8000, v2
    v_add_u32 v3, 0x8000, v3
    buffer_load_dwordx4 v[40:43], v2, s[24:27], 0 offen offset:0 nt
    v_dot2c_f32_bf16_dpp v8, v26, v84 row_newbcast:5 row_mask:0xf bank_mask:0xf
    v_dot2c_f32_bf16_dpp v9, v27, v84 row_newbcast:5 row_mask:0xf bank_mask:0xf
    v_dot2c_f32_bf16_dpp v10, v26, v85 row_newbcast:5 row_mask:0xf bank_mask:0xf
    v_dot2c_f32_bf16_dpp v11, v27, v85 row_newbcast:5 row_mask:0xf bank_mask:0xf
    v_dot2c_f32_bf16_dpp v12, v26, v86 row_newbcast:5 row_mask:0xf bank_mask:0xf
    v_dot2c_f32_bf16_dpp v13, v27, v86 row_newbcast:5 row_mask:0xf bank_mask:0xf
    v_dot2c_f32_bf16_dpp v14, v26, v87 row_newbcast:5 row_mask:0xf bank_mask:0xf
    v_dot2c_f32_bf16_dpp v15, v27, v87 row_newbcast:5 row_mask:0xf bank_mask:0xf
    s_waitcnt vmcnt(4)
    buffer_load_dwordx4 v[44:47], v2, s[24:27], 0 offen offset:1024 nt
    v_dot2c_f32_bf16_dpp v8, v26, v88 row_newbcast:8 row_mask:0xf bank_mask:0xf
    v_dot2c_f32_bf16_dpp v9, v27, v88 row_newbcast:8 row_mask:0xf bank_mask:0xf
    v_dot2c_f32_bf16_dpp v10, v26, v89 row_newbcast:8 row_mask:0xf bank_mask:0xf
    v_dot2c_f32_bf16_dpp v11, v27, v89 row_newbcast:8 row_mask:0xf bank_mask:0xf
    v_dot2c_f32_bf16_dpp v12, v26, v90 row_newbcast:8 row_mask:0xf bank_mask:0xf
    v_dot2c_f32_bf16_dpp v13, v27, v90 row_newbcast:8 row_mask:0xf bank_mask:0xf
    v_dot2c_f32_bf16_dpp v14, v26, v91 row_newbcast:8 row_mask:0xf bank_mask:0xf
    v_dot2c_f32_bf16_dpp v15, v27, v91 row_newbcast:8 row_mask:0xf bank_mask:0xf
    s_waitcnt vmcnt(4)
    buffer_load_dwordx4 v[48:51], v2, s[24:27], 0 offen offset:2048 nt
    v_dot2c_f32_bf16_dpp v8, v26, v92 row_newbcast:9 row_mask:0xf bank_mask:0xf
    v_dot2c_f32_bf16_dpp v9, v27, v92 row_newbcast:9 row_mask:0xf bank_mask:0xf
    v_dot2c_f32_bf16_dpp v10, v26, v93 row_newbcast:9 row_mask:0xf bank_mask:0xf
    v_dot2c_f32_bf16_dpp v11, v27, v93 row_newbcast:9 row_mask:0xf bank_mask:0xf
    v_dot2c_f32_bf16_dpp v12, v26, v94 row_newbcast:9 row_mask:0xf bank_mask:0xf
    v_dot2c_f32_bf16_dpp v13, v27, v94 row_newbcast:9 row_mask:0xf bank_mask:0xf
    v_dot2c_f32_bf16_dpp v14, v26, v95 row_newbcast:9 row_mask:0xf bank_mask:0xf
    v_dot2c_f32_bf16_dpp v15, v27, v95 row_newbcast:9 row_mask:0xf bank_mask:0xf
    s_waitcnt vmcnt(4)
    buffer_load_dwordx4 v[52:55], v2, s[24:27], 0 offen offset:3072 nt
    v_dot2c_f32_bf16_dpp v8, v26, v96 row_newbcast:12 row_mask:0xf bank_mask:0xf
    v_dot2c_f32_bf16_dpp v9, v27, v96 row_newbcast:12 row_mask:0xf bank_mask:0xf
    v_dot2c_f32_bf16_dpp v10, v26, v97 row_newbcast:12 row_mask:0xf bank_mask:0xf
    v_dot2c_f32_bf16_dpp v11, v27, v97 row_newbcast:12 row_mask:0xf bank_mask:0xf
    v_dot2c_f32_bf16_dpp v12, v26, v98 row_newbcast:12 row_mask:0xf bank_mask:0xf
    v_dot2c_f32_bf16_dpp v13, v27, v98 row_newbcast:12 row_mask:0xf bank_mask:0xf
    v_dot2c_f32_bf16_dpp v14, v26, v99 row_newbcast:12 row_mask:0xf bank_mask:0xf
    v_dot2c_f32_bf16_dpp v15, v27, v99 row_newbcast:12 row_mask:0xf bank_mask:0xf
    s_waitcnt vmcnt(4)
    buffer_load_dwordx4 v[56:59], v3, s[24:27], 0 offen offset:0 nt
    buffer_load_dwordx4 v[60:63], v3, s[24:27], 0 offen offset:1024 nt
    v_dot2c_f32_bf16_dpp v8, v26, v100 row_newbcast:13 row_mask:0xf bank_mask:0xf
    v_dot2c_f32_bf16_dpp v9, v27, v100 row_newbcast:13 row_mask:0xf bank_mask:0xf
    v_dot2c_f32_bf16_dpp v10, v26, v101 row_newbcast:13 row_mask:0xf bank_mask:0xf
    v_dot2c_f32_bf16_dpp v11, v27, v101 row_newbcast:13 row_mask:0xf bank_mask:0xf
    v_dot2c_f32_bf16_dpp v12, v26, v102 row_newbcast:13 row_mask:0xf bank_mask:0xf
    v_dot2c_f32_bf16_dpp v13, v27, v102 row_newbcast:13 row_mask:0xf bank_mask:0xf
    v_dot2c_f32_bf16_dpp v14, v26, v103 row_newbcast:13 row_mask:0xf bank_mask:0xf
    v_dot2c_f32_bf16_dpp v15, v27, v103 row_newbcast:13 row_mask:0xf bank_mask:0xf
    s_waitcnt vmcnt(5)
    v_dot2_f32_bf16 v16, v40, v4, 0
    v_dot2_f32_bf16 v16, v41, v5, v16
    v_dot2_f32_bf16 v16, v42, v6, v16
    v_dot2_f32_bf16 v16, v43, v7, v16
    s_waitcnt vmcnt(4)
    buffer_load_dwordx4 v[64:67], v3, s[24:27], 0 offen offset:2048 nt
    v_dot2_f32_bf16 v17, v44, v4, 0
    v_dot2_f32_bf16 v17, v45, v5, v17
    v_dot2_f32_bf16 v17, v46, v6, v17
    v_dot2_f32_bf16 v17, v47, v7, v17
    s_waitcnt vmcnt(4)
    buffer_load_dwordx4 v[68:71], v3, s[24:27], 0 offen offset:3072 nt
    v_dot2_f32_bf16 v18, v48, v4, 0
    v_dot2_f32_bf16 v18, v49, v5, v18
    v_dot2_f32_bf16 v18, v50, v6, v18
    v_dot2_f32_bf16 v18, v51, v7, v18
    s_waitcnt vmcnt(4)
    buffer_load_dwordx4 v[72:75], v2, s[28:31], 0 offen offset:0 nt
    v_dot2_f32_bf16 v19, v52, v4, 0
    v_dot2_f32_bf16 v19, v53, v5, v19
    v_dot2_f32_bf16 v19, v54, v6, v19
    v_dot2_f32_bf16 v19, v55, v7, v19
    s_waitcnt vmcnt(4)
    buffer_load_dwordx4 v[76:79], v2, s[28:31], 0 offen offset:1024 nt
    v_dot2_f32_bf16 v20, v56, v4, 0
    v_dot2_f32_bf16 v20, v57, v5, v20
    v_dot2_f32_bf16 v20, v58, v6, v20
    v_dot2_f32_bf16 v20, v59, v7, v20
    s_waitcnt vmcnt(4)
    buffer_load_dwordx4 v[80:83], v2, s[28:31], 0 offen offset:2048 nt
    v_dot2_f32_bf16 v21, v60, v4, 0
    v_dot2_f32_bf16 v21, v61, v5, v21
    v_dot2_f32_bf16 v21, v62, v6, v21
    v_dot2_f32_bf16 v21, v63, v7, v21
    s_waitcnt vmcnt(4)
    buffer_load_dwordx4 v[84:87], v2, s[28:31], 0 offen offset:3072 nt
    v_dot2_f32_bf16 v22, v64, v4, 0
    v_dot2_f32_bf16 v22, v65, v5, v22
    v_dot2_f32_bf16 v22, v66, v6, v22
    v_dot2_f32_bf16 v22, v67, v7, v22
    s_waitcnt vmcnt(4)
    buffer_load_dwordx4 v[88:91], v3, s[28:31], 0 offen offset:0 nt
    buffer_load_dwordx4 v[92:95], v3, s[28:31], 0 offen offset:1024 nt
    v_dot2_f32_bf16 v23, v68, v4, 0
    v_dot2_f32_bf16 v23, v69, v5, v23
    v_dot2_f32_bf16 v23, v70, v6, v23
    v_dot2_f32_bf16 v23, v71, v7, v23
    s_nop 2
    v_add_f32_dpp v16, v16, v16 row_ror:8 row_mask:0xf bank_mask:0x3
    v_add_f32_dpp v17, v17, v17 row_ror:8 row_mask:0xf bank_mask:0x3
    v_add_f32_dpp v18, v18, v18 row_ror:8 row_mask:0xf bank_mask:0x3
    v_add_f32_dpp v19, v19, v19 row_ror:8 row_mask:0xf bank_mask:0x3
    v_add_f32_dpp v16, v20, v20 row_ror:8 row_mask:0xf bank_mask:0xc
    v_add_f32_dpp v17, v21, v21 row_ror:8 row_mask:0xf bank_mask:0xc
    v_add_f32_dpp v18, v22, v22 row_ror:8 row_mask:0xf bank_mask:0xc
    v_add_f32_dpp v19, v23, v23 row_ror:8 row_mask:0xf bank_mask:0xc
    v_add_f32_dpp v16, v16, v16 row_half_mirror row_mask:0xf bank_mask:0x5
    v_add_f32_dpp v17, v17, v17 row_half_mirror row_mask:0xf bank_mask:0x5
    v_add_f32_dpp v16, v18, v18 row_half_mirror row_mask:0xf bank_mask:0xa
    v_add_f32_dpp v17, v19, v19 row_half_mirror row_mask:0xf bank_mask:0xa
    s_nop 0
    v_add_f32_dpp v16, v16, v16 quad_perm:[1,0,3,2] row_mask:0xf bank_mask:0xf
    v_add_f32_dpp v17, v17, v17 quad_perm:[1,0,3,2] row_mask:0xf bank_mask:0xf
    s_nop 0
    v_cndmask_b32 v29, v16, v17, s[76:77]
    s_nop 1
    v_add_f32_dpp v29, v29, v29 quad_perm:[2,3,0,1] row_mask:0xf bank_mask:0xf
    v_mul_f32 v29, s74, v29
    s_nop 1
    v_max_f32_dpp v30, v29, v29 quad_perm:[1,0,3,2] row_mask:0xf bank_mask:0xf
    s_nop 1
    v_max_f32_dpp v30, v30, v30 row_ror:4 row_mask:0xf bank_mask:0xf
    s_nop 1
    v_max_f32_dpp v30, v30, v30 row_ror:8 row_mask:0xf bank_mask:0xf
    v_max_f32 v30, v30, v24
    v_sub_f32 v28, v24, v30
    v_sub_f32 v29, v29, v30
    v_exp_f32 v28, v28
    v_exp_f32 v29, v29
    v_mov_b32 v24, v30
    v_cvt_pk_bf16_f32 v26, v29, 0
    v_cvt_pk_bf16_f32 v27, 0, v29
    v_fma_f32 v25, v25, v28, v29
    v_mul_f32 v8, v28, v8
    v_mul_f32 v9, v28, v9
    v_mul_f32 v10, v28, v10
    v_mul_f32 v11, v28, v11
    v_mul_f32 v12, v28, v12
    v_mul_f32 v13, v28, v13
    v_mul_f32 v14, v28, v14
    v_mul_f32 v15, v28, v15
    s_waitcnt vmcnt(5)
    v_dot2c_f32_bf16_dpp v8, v26, v72 row_newbcast:0 row_mask:0xf bank_mask:0xf
    v_dot2c_f32_bf16_dpp v9, v27, v72 row_newbcast:0 row_mask:0xf bank_mask:0xf
    v_dot2c_f32_bf16_dpp v10, v26, v73 row_newbcast:0 row_mask:0xf bank_mask:0xf
    v_dot2c_f32_bf16_dpp v11, v27, v73 row_newbcast:0 row_mask:0xf bank_mask:0xf
    v_dot2c_f32_bf16_dpp v12, v26, v74 row_newbcast:0 row_mask:0xf bank_mask:0xf
    v_dot2c_f32_bf16_dpp v13, v27, v74 row_newbcast:0 row_mask:0xf bank_mask:0xf
    v_dot2c_f32_bf16_dpp v14, v26, v75 row_newbcast:0 row_mask:0xf bank_mask:0xf
    v_dot2c_f32_bf16_dpp v15, v27, v75 row_newbcast:0 row_mask:0xf bank_mask:0xf
    s_waitcnt vmcnt(4)
    buffer_load_dwordx4 v[96:99], v3, s[28:31], 0 offen offset:2048 nt
    v_dot2c_f32_bf16_dpp v8, v26, v76 row_newbcast:1 row_mask:0xf bank_mask:0xf
    v_dot2c_f32_bf16_dpp v9, v27, v76 row_newbcast:1 row_mask:0xf bank_mask:0xf
    v_dot2c_f32_bf16_dpp v10, v26, v77 row_newbcast:1 row_mask:0xf bank_mask:0xf
    v_dot2c_f32_bf16_dpp v11, v27, v77 row_newbcast:1 row_mask:0xf bank_mask:0xf
    v_dot2c_f32_bf16_dpp v12, v26, v78 row_newbcast:1 row_mask:0xf bank_mask:0xf
    v_dot2c_f32_bf16_dpp v13, v27, v78 row_newbcast:1 row_mask:0xf bank_mask:0xf
    v_dot2c_f32_bf16_dpp v14, v26, v79 row_newbcast:1 row_mask:0xf bank_mask:0xf
    v_dot2c_f32_bf16_dpp v15, v27, v79 row_newbcast:1 row_mask:0xf bank_mask:0xf
    s_waitcnt vmcnt(4)
    buffer_load_dwordx4 v[100:103], v3, s[28:31], 0 offen offset:3072 nt
    v_dot2c_f32_bf16_dpp v8, v26, v80 row_newbcast:4 row_mask:0xf bank_mask:0xf
    v_dot2c_f32_bf16_dpp v9, v27, v80 row_newbcast:4 row_mask:0xf bank_mask:0xf
    v_dot2c_f32_bf16_dpp v10, v26, v81 row_newbcast:4 row_mask:0xf bank_mask:0xf
    v_dot2c_f32_bf16_dpp v11, v27, v81 row_newbcast:4 row_mask:0xf bank_mask:0xf
    v_dot2c_f32_bf16_dpp v12, v26, v82 row_newbcast:4 row_mask:0xf bank_mask:0xf
    v_dot2c_f32_bf16_dpp v13, v27, v82 row_newbcast:4 row_mask:0xf bank_mask:0xf
    v_dot2c_f32_bf16_dpp v14, v26, v83 row_newbcast:4 row_mask:0xf bank_mask:0xf
    v_dot2c_f32_bf16_dpp v15, v27, v83 row_newbcast:4 row_mask:0xf bank_mask:0xf
    s_waitcnt vmcnt(4)
    v_add_u32 v2, 0x8000, v2
    v_add_u32 v3, 0x8000, v3
    buffer_load_dwordx4 v[40:43], v2, s[24:27], 0 offen offset:0 nt
    v_dot2c_f32_bf16_dpp v8, v26, v84 row_newbcast:5 row_mask:0xf bank_mask:0xf
    v_dot2c_f32_bf16_dpp v9, v27, v84 row_newbcast:5 row_mask:0xf bank_mask:0xf
    v_dot2c_f32_bf16_dpp v10, v26, v85 row_newbcast:5 row_mask:0xf bank_mask:0xf
    v_dot2c_f32_bf16_dpp v11, v27, v85 row_newbcast:5 row_mask:0xf bank_mask:0xf
    v_dot2c_f32_bf16_dpp v12, v26, v86 row_newbcast:5 row_mask:0xf bank_mask:0xf
    v_dot2c_f32_bf16_dpp v13, v27, v86 row_newbcast:5 row_mask:0xf bank_mask:0xf
    v_dot2c_f32_bf16_dpp v14, v26, v87 row_newbcast:5 row_mask:0xf bank_mask:0xf
    v_dot2c_f32_bf16_dpp v15, v27, v87 row_newbcast:5 row_mask:0xf bank_mask:0xf
    s_waitcnt vmcnt(4)
    buffer_load_dwordx4 v[44:47], v2, s[24:27], 0 offen offset:1024 nt
    v_dot2c_f32_bf16_dpp v8, v26, v88 row_newbcast:8 row_mask:0xf bank_mask:0xf
    v_dot2c_f32_bf16_dpp v9, v27, v88 row_newbcast:8 row_mask:0xf bank_mask:0xf
    v_dot2c_f32_bf16_dpp v10, v26, v89 row_newbcast:8 row_mask:0xf bank_mask:0xf
    v_dot2c_f32_bf16_dpp v11, v27, v89 row_newbcast:8 row_mask:0xf bank_mask:0xf
    v_dot2c_f32_bf16_dpp v12, v26, v90 row_newbcast:8 row_mask:0xf bank_mask:0xf
    v_dot2c_f32_bf16_dpp v13, v27, v90 row_newbcast:8 row_mask:0xf bank_mask:0xf
    v_dot2c_f32_bf16_dpp v14, v26, v91 row_newbcast:8 row_mask:0xf bank_mask:0xf
    v_dot2c_f32_bf16_dpp v15, v27, v91 row_newbcast:8 row_mask:0xf bank_mask:0xf
    s_waitcnt vmcnt(4)
    buffer_load_dwordx4 v[48:51], v2, s[24:27], 0 offen offset:2048 nt
    v_dot2c_f32_bf16_dpp v8, v26, v92 row_newbcast:9 row_mask:0xf bank_mask:0xf
    v_dot2c_f32_bf16_dpp v9, v27, v92 row_newbcast:9 row_mask:0xf bank_mask:0xf
    v_dot2c_f32_bf16_dpp v10, v26, v93 row_newbcast:9 row_mask:0xf bank_mask:0xf
    v_dot2c_f32_bf16_dpp v11, v27, v93 row_newbcast:9 row_mask:0xf bank_mask:0xf
    v_dot2c_f32_bf16_dpp v12, v26, v94 row_newbcast:9 row_mask:0xf bank_mask:0xf
    v_dot2c_f32_bf16_dpp v13, v27, v94 row_newbcast:9 row_mask:0xf bank_mask:0xf
    v_dot2c_f32_bf16_dpp v14, v26, v95 row_newbcast:9 row_mask:0xf bank_mask:0xf
    v_dot2c_f32_bf16_dpp v15, v27, v95 row_newbcast:9 row_mask:0xf bank_mask:0xf
    s_waitcnt vmcnt(4)
    buffer_load_dwordx4 v[52:55], v2, s[24:27], 0 offen offset:3072 nt
    v_dot2c_f32_bf16_dpp v8, v26, v96 row_newbcast:12 row_mask:0xf bank_mask:0xf
    v_dot2c_f32_bf16_dpp v9, v27, v96 row_newbcast:12 row_mask:0xf bank_mask:0xf
    v_dot2c_f32_bf16_dpp v10, v26, v97 row_newbcast:12 row_mask:0xf bank_mask:0xf
    v_dot2c_f32_bf16_dpp v11, v27, v97 row_newbcast:12 row_mask:0xf bank_mask:0xf
    v_dot2c_f32_bf16_dpp v12, v26, v98 row_newbcast:12 row_mask:0xf bank_mask:0xf
    v_dot2c_f32_bf16_dpp v13, v27, v98 row_newbcast:12 row_mask:0xf bank_mask:0xf
    v_dot2c_f32_bf16_dpp v14, v26, v99 row_newbcast:12 row_mask:0xf bank_mask:0xf
    v_dot2c_f32_bf16_dpp v15, v27, v99 row_newbcast:12 row_mask:0xf bank_mask:0xf
    s_waitcnt vmcnt(4)
    buffer_load_dwordx4 v[56:59], v3, s[24:27], 0 offen offset:0 nt
    buffer_load_dwordx4 v[60:63], v3, s[24:27], 0 offen offset:1024 nt
    v_dot2c_f32_bf16_dpp v8, v26, v100 row_newbcast:13 row_mask:0xf bank_mask:0xf
    v_dot2c_f32_bf16_dpp v9, v27, v100 row_newbcast:13 row_mask:0xf bank_mask:0xf
    v_dot2c_f32_bf16_dpp v10, v26, v101 row_newbcast:13 row_mask:0xf bank_mask:0xf
    v_dot2c_f32_bf16_dpp v11, v27, v101 row_newbcast:13 row_mask:0xf bank_mask:0xf
    v_dot2c_f32_bf16_dpp v12, v26, v102 row_newbcast:13 row_mask:0xf bank_mask:0xf
    v_dot2c_f32_bf16_dpp v13, v27, v102 row_newbcast:13 row_mask:0xf bank_mask:0xf
    v_dot2c_f32_bf16_dpp v14, v26, v103 row_newbcast:13 row_mask:0xf bank_mask:0xf
    v_dot2c_f32_bf16_dpp v15, v27, v103 row_newbcast:13 row_mask:0xf bank_mask:0xf
    s_waitcnt vmcnt(5)
    v_dot2_f32_bf16 v16, v40, v4, 0
    v_dot2_f32_bf16 v16, v41, v5, v16
    v_dot2_f32_bf16 v16, v42, v6, v16
    v_dot2_f32_bf16 v16, v43, v7, v16
    s_waitcnt vmcnt(4)
    buffer_load_dwordx4 v[64:67], v3, s[24:27], 0 offen offset:2048 nt
    v_dot2_f32_bf16 v17, v44, v4, 0
    v_dot2_f32_bf16 v17, v45, v5, v17
    v_dot2_f32_bf16 v17, v46, v6, v17
    v_dot2_f32_bf16 v17, v47, v7, v17
    s_waitcnt vmcnt(4)
    buffer_load_dwordx4 v[68:71], v3, s[24:27], 0 offen offset:3072 nt
    v_dot2_f32_bf16 v18, v48, v4, 0
    v_dot2_f32_bf16 v18, v49, v5, v18
    v_dot2_f32_bf16 v18, v50, v6, v18
    v_dot2_f32_bf16 v18, v51, v7, v18
    s_waitcnt vmcnt(4)
    buffer_load_dwordx4 v[72:75], v2, s[28:31], 0 offen offset:0 nt
    v_dot2_f32_bf16 v19, v52, v4, 0
    v_dot2_f32_bf16 v19, v53, v5, v19
    v_dot2_f32_bf16 v19, v54, v6, v19
    v_dot2_f32_bf16 v19, v55, v7, v19
    s_waitcnt vmcnt(4)
    buffer_load_dwordx4 v[76:79], v2, s[28:31], 0 offen offset:1024 nt
    v_dot2_f32_bf16 v20, v56, v4, 0
    v_dot2_f32_bf16 v20, v57, v5, v20
    v_dot2_f32_bf16 v20, v58, v6, v20
    v_dot2_f32_bf16 v20, v59, v7, v20
    s_waitcnt vmcnt(4)
    buffer_load_dwordx4 v[80:83], v2, s[28:31], 0 offen offset:2048 nt
    v_dot2_f32_bf16 v21, v60, v4, 0
    v_dot2_f32_bf16 v21, v61, v5, v21
    v_dot2_f32_bf16 v21, v62, v6, v21
    v_dot2_f32_bf16 v21, v63, v7, v21
    s_waitcnt vmcnt(4)
    buffer_load_dwordx4 v[84:87], v2, s[28:31], 0 offen offset:3072 nt
    v_dot2_f32_bf16 v22, v64, v4, 0
    v_dot2_f32_bf16 v22, v65, v5, v22
    v_dot2_f32_bf16 v22, v66, v6, v22
    v_dot2_f32_bf16 v22, v67, v7, v22
    s_waitcnt vmcnt(4)
    buffer_load_dwordx4 v[88:91], v3, s[28:31], 0 offen offset:0 nt
    buffer_load_dwordx4 v[92:95], v3, s[28:31], 0 offen offset:1024 nt
    v_dot2_f32_bf16 v23, v68, v4, 0
    v_dot2_f32_bf16 v23, v69, v5, v23
    v_dot2_f32_bf16 v23, v70, v6, v23
    v_dot2_f32_bf16 v23, v71, v7, v23
    s_nop 2
    v_add_f32_dpp v16, v16, v16 row_ror:8 row_mask:0xf bank_mask:0x3
    v_add_f32_dpp v17, v17, v17 row_ror:8 row_mask:0xf bank_mask:0x3
    v_add_f32_dpp v18, v18, v18 row_ror:8 row_mask:0xf bank_mask:0x3
    v_add_f32_dpp v19, v19, v19 row_ror:8 row_mask:0xf bank_mask:0x3
    v_add_f32_dpp v16, v20, v20 row_ror:8 row_mask:0xf bank_mask:0xc
    v_add_f32_dpp v17, v21, v21 row_ror:8 row_mask:0xf bank_mask:0xc
    v_add_f32_dpp v18, v22, v22 row_ror:8 row_mask:0xf bank_mask:0xc
    v_add_f32_dpp v19, v23, v23 row_ror:8 row_mask:0xf bank_mask:0xc
    v_add_f32_dpp v16, v16, v16 row_half_mirror row_mask:0xf bank_mask:0x5
    v_add_f32_dpp v17, v17, v17 row_half_mirror row_mask:0xf bank_mask:0x5
    v_add_f32_dpp v16, v18, v18 row_half_mirror row_mask:0xf bank_mask:0xa
    v_add_f32_dpp v17, v19, v19 row_half_mirror row_mask:0xf bank_mask:0xa
    s_nop 0
    v_add_f32_dpp v16, v16, v16 quad_perm:[1,0,3,2] row_mask:0xf bank_mask:0xf
    v_add_f32_dpp v17, v17, v17 quad_perm:[1,0,3,2] row_mask:0xf bank_mask:0xf
    s_nop 0
    v_cndmask_b32 v29, v16, v17, s[76:77]
    s_nop 1
    v_add_f32_dpp v29, v29, v29 quad_perm:[2,3,0,1] row_mask:0xf bank_mask:0xf
    v_mul_f32 v29, s74, v29
    s_nop 1
    v_max_f32_dpp v30, v29, v29 quad_perm:[1,0,3,2] row_mask:0xf bank_mask:0xf
    s_nop 1
    v_max_f32_dpp v30, v30, v30 row_ror:4 row_mask:0xf bank_mask:0xf
    s_nop 1
    v_max_f32_dpp v30, v30, v30 row_ror:8 row_mask:0xf bank_mask:0xf
    v_max_f32 v30, v30, v24
    v_sub_f32 v28, v24, v30
    v_sub_f32 v29, v29, v30
    v_exp_f32 v28, v28
    v_exp_f32 v29, v29
    v_mov_b32 v24, v30
    v_cvt_pk_bf16_f32 v26, v29, 0
    v_cvt_pk_bf16_f32 v27, 0, v29
    v_fma_f32 v25, v25, v28, v29
    v_mul_f32 v8, v28, v8
    v_mul_f32 v9, v28, v9
    v_mul_f32 v10, v28, v10
    v_mul_f32 v11, v28, v11
    v_mul_f32 v12, v28, v12
    v_mul_f32 v13, v28, v13
    v_mul_f32 v14, v28, v14
    v_mul_f32 v15, v28, v15
    s_waitcnt vmcnt(5)
    v_dot2c_f32_bf16_dpp v8, v26, v72 row_newbcast:0 row_mask:0xf bank_mask:0xf
    v_dot2c_f32_bf16_dpp v9, v27, v72 row_newbcast:0 row_mask:0xf bank_mask:0xf
    v_dot2c_f32_bf16_dpp v10, v26, v73 row_newbcast:0 row_mask:0xf bank_mask:0xf
    v_dot2c_f32_bf16_dpp v11, v27, v73 row_newbcast:0 row_mask:0xf bank_mask:0xf
    v_dot2c_f32_bf16_dpp v12, v26, v74 row_newbcast:0 row_mask:0xf bank_mask:0xf
    v_dot2c_f32_bf16_dpp v13, v27, v74 row_newbcast:0 row_mask:0xf bank_mask:0xf
    v_dot2c_f32_bf16_dpp v14, v26, v75 row_newbcast:0 row_mask:0xf bank_mask:0xf
    v_dot2c_f32_bf16_dpp v15, v27, v75 row_newbcast:0 row_mask:0xf bank_mask:0xf
    s_waitcnt vmcnt(4)
    buffer_load_dwordx4 v[96:99], v3, s[28:31], 0 offen offset:2048 nt
    v_dot2c_f32_bf16_dpp v8, v26, v76 row_newbcast:1 row_mask:0xf bank_mask:0xf
    v_dot2c_f32_bf16_dpp v9, v27, v76 row_newbcast:1 row_mask:0xf bank_mask:0xf
    v_dot2c_f32_bf16_dpp v10, v26, v77 row_newbcast:1 row_mask:0xf bank_mask:0xf
    v_dot2c_f32_bf16_dpp v11, v27, v77 row_newbcast:1 row_mask:0xf bank_mask:0xf
    v_dot2c_f32_bf16_dpp v12, v26, v78 row_newbcast:1 row_mask:0xf bank_mask:0xf
    v_dot2c_f32_bf16_dpp v13, v27, v78 row_newbcast:1 row_mask:0xf bank_mask:0xf
    v_dot2c_f32_bf16_dpp v14, v26, v79 row_newbcast:1 row_mask:0xf bank_mask:0xf
    v_dot2c_f32_bf16_dpp v15, v27, v79 row_newbcast:1 row_mask:0xf bank_mask:0xf
    s_waitcnt vmcnt(4)
    buffer_load_dwordx4 v[100:103], v3, s[28:31], 0 offen offset:3072 nt
    v_dot2c_f32_bf16_dpp v8, v26, v80 row_newbcast:4 row_mask:0xf bank_mask:0xf
    v_dot2c_f32_bf16_dpp v9, v27, v80 row_newbcast:4 row_mask:0xf bank_mask:0xf
    v_dot2c_f32_bf16_dpp v10, v26, v81 row_newbcast:4 row_mask:0xf bank_mask:0xf
    v_dot2c_f32_bf16_dpp v11, v27, v81 row_newbcast:4 row_mask:0xf bank_mask:0xf
    v_dot2c_f32_bf16_dpp v12, v26, v82 row_newbcast:4 row_mask:0xf bank_mask:0xf
    v_dot2c_f32_bf16_dpp v13, v27, v82 row_newbcast:4 row_mask:0xf bank_mask:0xf
    v_dot2c_f32_bf16_dpp v14, v26, v83 row_newbcast:4 row_mask:0xf bank_mask:0xf
    v_dot2c_f32_bf16_dpp v15, v27, v83 row_newbcast:4 row_mask:0xf bank_mask:0xf
    s_waitcnt vmcnt(4)
    v_add_u32 v2, 0x8000, v2
    v_add_u32 v3, 0x8000, v3
    buffer_load_dwordx4 v[40:43], v2, s[24:27], 0 offen offset:0 nt
    v_dot2c_f32_bf16_dpp v8, v26, v84 row_newbcast:5 row_mask:0xf bank_mask:0xf
    v_dot2c_f32_bf16_dpp v9, v27, v84 row_newbcast:5 row_mask:0xf bank_mask:0xf
    v_dot2c_f32_bf16_dpp v10, v26, v85 row_newbcast:5 row_mask:0xf bank_mask:0xf
    v_dot2c_f32_bf16_dpp v11, v27, v85 row_newbcast:5 row_mask:0xf bank_mask:0xf
    v_dot2c_f32_bf16_dpp v12, v26, v86 row_newbcast:5 row_mask:0xf bank_mask:0xf
    v_dot2c_f32_bf16_dpp v13, v27, v86 row_newbcast:5 row_mask:0xf bank_mask:0xf
    v_dot2c_f32_bf16_dpp v14, v26, v87 row_newbcast:5 row_mask:0xf bank_mask:0xf
    v_dot2c_f32_bf16_dpp v15, v27, v87 row_newbcast:5 row_mask:0xf bank_mask:0xf
    s_waitcnt vmcnt(4)
    buffer_load_dwordx4 v[44:47], v2, s[24:27], 0 offen offset:1024 nt
    v_dot2c_f32_bf16_dpp v8, v26, v88 row_newbcast:8 row_mask:0xf bank_mask:0xf
    v_dot2c_f32_bf16_dpp v9, v27, v88 row_newbcast:8 row_mask:0xf bank_mask:0xf
    v_dot2c_f32_bf16_dpp v10, v26, v89 row_newbcast:8 row_mask:0xf bank_mask:0xf
    v_dot2c_f32_bf16_dpp v11, v27, v89 row_newbcast:8 row_mask:0xf bank_mask:0xf
    v_dot2c_f32_bf16_dpp v12, v26, v90 row_newbcast:8 row_mask:0xf bank_mask:0xf
    v_dot2c_f32_bf16_dpp v13, v27, v90 row_newbcast:8 row_mask:0xf bank_mask:0xf
    v_dot2c_f32_bf16_dpp v14, v26, v91 row_newbcast:8 row_mask:0xf bank_mask:0xf
    v_dot2c_f32_bf16_dpp v15, v27, v91 row_newbcast:8 row_mask:0xf bank_mask:0xf
    s_waitcnt vmcnt(4)
    buffer_load_dwordx4 v[48:51], v2, s[24:27], 0 offen offset:2048 nt
    v_dot2c_f32_bf16_dpp v8, v26, v92 row_newbcast:9 row_mask:0xf bank_mask:0xf
    v_dot2c_f32_bf16_dpp v9, v27, v92 row_newbcast:9 row_mask:0xf bank_mask:0xf
    v_dot2c_f32_bf16_dpp v10, v26, v93 row_newbcast:9 row_mask:0xf bank_mask:0xf
    v_dot2c_f32_bf16_dpp v11, v27, v93 row_newbcast:9 row_mask:0xf bank_mask:0xf
    v_dot2c_f32_bf16_dpp v12, v26, v94 row_newbcast:9 row_mask:0xf bank_mask:0xf
    v_dot2c_f32_bf16_dpp v13, v27, v94 row_newbcast:9 row_mask:0xf bank_mask:0xf
    v_dot2c_f32_bf16_dpp v14, v26, v95 row_newbcast:9 row_mask:0xf bank_mask:0xf
    v_dot2c_f32_bf16_dpp v15, v27, v95 row_newbcast:9 row_mask:0xf bank_mask:0xf
    s_waitcnt vmcnt(4)
    buffer_load_dwordx4 v[52:55], v2, s[24:27], 0 offen offset:3072 nt
    v_dot2c_f32_bf16_dpp v8, v26, v96 row_newbcast:12 row_mask:0xf bank_mask:0xf
    v_dot2c_f32_bf16_dpp v9, v27, v96 row_newbcast:12 row_mask:0xf bank_mask:0xf
    v_dot2c_f32_bf16_dpp v10, v26, v97 row_newbcast:12 row_mask:0xf bank_mask:0xf
    v_dot2c_f32_bf16_dpp v11, v27, v97 row_newbcast:12 row_mask:0xf bank_mask:0xf
    v_dot2c_f32_bf16_dpp v12, v26, v98 row_newbcast:12 row_mask:0xf bank_mask:0xf
    v_dot2c_f32_bf16_dpp v13, v27, v98 row_newbcast:12 row_mask:0xf bank_mask:0xf
    v_dot2c_f32_bf16_dpp v14, v26, v99 row_newbcast:12 row_mask:0xf bank_mask:0xf
    v_dot2c_f32_bf16_dpp v15, v27, v99 row_newbcast:12 row_mask:0xf bank_mask:0xf
    s_waitcnt vmcnt(4)
    buffer_load_dwordx4 v[56:59], v3, s[24:27], 0 offen offset:0 nt
    buffer_load_dwordx4 v[60:63], v3, s[24:27], 0 offen offset:1024 nt
    v_dot2c_f32_bf16_dpp v8, v26, v100 row_newbcast:13 row_mask:0xf bank_mask:0xf
    v_dot2c_f32_bf16_dpp v9, v27, v100 row_newbcast:13 row_mask:0xf bank_mask:0xf
    v_dot2c_f32_bf16_dpp v10, v26, v101 row_newbcast:13 row_mask:0xf bank_mask:0xf
    v_dot2c_f32_bf16_dpp v11, v27, v101 row_newbcast:13 row_mask:0xf bank_mask:0xf
    v_dot2c_f32_bf16_dpp v12, v26, v102 row_newbcast:13 row_mask:0xf bank_mask:0xf
    v_dot2c_f32_bf16_dpp v13, v27, v102 row_newbcast:13 row_mask:0xf bank_mask:0xf
    v_dot2c_f32_bf16_dpp v14, v26, v103 row_newbcast:13 row_mask:0xf bank_mask:0xf
    v_dot2c_f32_bf16_dpp v15, v27, v103 row_newbcast:13 row_mask:0xf bank_mask:0xf
    s_waitcnt vmcnt(5)
    v_dot2_f32_bf16 v16, v40, v4, 0
    v_dot2_f32_bf16 v16, v41, v5, v16
    v_dot2_f32_bf16 v16, v42, v6, v16
    v_dot2_f32_bf16 v16, v43, v7, v16
    s_waitcnt vmcnt(4)
    buffer_load_dwordx4 v[64:67], v3, s[24:27], 0 offen offset:2048 nt
    v_dot2_f32_bf16 v17, v44, v4, 0
    v_dot2_f32_bf16 v17, v45, v5, v17
    v_dot2_f32_bf16 v17, v46, v6, v17
    v_dot2_f32_bf16 v17, v47, v7, v17
    s_waitcnt vmcnt(4)
    buffer_load_dwordx4 v[68:71], v3, s[24:27], 0 offen offset:3072 nt
    v_dot2_f32_bf16 v18, v48, v4, 0
    v_dot2_f32_bf16 v18, v49, v5, v18
    v_dot2_f32_bf16 v18, v50, v6, v18
    v_dot2_f32_bf16 v18, v51, v7, v18
    s_waitcnt vmcnt(4)
    buffer_load_dwordx4 v[72:75], v2, s[28:31], 0 offen offset:0 nt
    v_dot2_f32_bf16 v19, v52, v4, 0
    v_dot2_f32_bf16 v19, v53, v5, v19
    v_dot2_f32_bf16 v19, v54, v6, v19
    v_dot2_f32_bf16 v19, v55, v7, v19
    s_waitcnt vmcnt(4)
    buffer_load_dwordx4 v[76:79], v2, s[28:31], 0 offen offset:1024 nt
    v_dot2_f32_bf16 v20, v56, v4, 0
    v_dot2_f32_bf16 v20, v57, v5, v20
    v_dot2_f32_bf16 v20, v58, v6, v20
    v_dot2_f32_bf16 v20, v59, v7, v20
    s_waitcnt vmcnt(4)
    buffer_load_dwordx4 v[80:83], v2, s[28:31], 0 offen offset:2048 nt
    v_dot2_f32_bf16 v21, v60, v4, 0
    v_dot2_f32_bf16 v21, v61, v5, v21
    v_dot2_f32_bf16 v21, v62, v6, v21
    v_dot2_f32_bf16 v21, v63, v7, v21
    s_waitcnt vmcnt(4)
    buffer_load_dwordx4 v[84:87], v2, s[28:31], 0 offen offset:3072 nt
    v_dot2_f32_bf16 v22, v64, v4, 0
    v_dot2_f32_bf16 v22, v65, v5, v22
    v_dot2_f32_bf16 v22, v66, v6, v22
    v_dot2_f32_bf16 v22, v67, v7, v22
    s_waitcnt vmcnt(4)
    buffer_load_dwordx4 v[88:91], v3, s[28:31], 0 offen offset:0 nt
    buffer_load_dwordx4 v[92:95], v3, s[28:31], 0 offen offset:1024 nt
    v_dot2_f32_bf16 v23, v68, v4, 0
    v_dot2_f32_bf16 v23, v69, v5, v23
    v_dot2_f32_bf16 v23, v70, v6, v23
    v_dot2_f32_bf16 v23, v71, v7, v23
    s_nop 2
    v_add_f32_dpp v16, v16, v16 row_ror:8 row_mask:0xf bank_mask:0x3
    v_add_f32_dpp v17, v17, v17 row_ror:8 row_mask:0xf bank_mask:0x3
    v_add_f32_dpp v18, v18, v18 row_ror:8 row_mask:0xf bank_mask:0x3
    v_add_f32_dpp v19, v19, v19 row_ror:8 row_mask:0xf bank_mask:0x3
    v_add_f32_dpp v16, v20, v20 row_ror:8 row_mask:0xf bank_mask:0xc
    v_add_f32_dpp v17, v21, v21 row_ror:8 row_mask:0xf bank_mask:0xc
    v_add_f32_dpp v18, v22, v22 row_ror:8 row_mask:0xf bank_mask:0xc
    v_add_f32_dpp v19, v23, v23 row_ror:8 row_mask:0xf bank_mask:0xc
    v_add_f32_dpp v16, v16, v16 row_half_mirror row_mask:0xf bank_mask:0x5
    v_add_f32_dpp v17, v17, v17 row_half_mirror row_mask:0xf bank_mask:0x5
    v_add_f32_dpp v16, v18, v18 row_half_mirror row_mask:0xf bank_mask:0xa
    v_add_f32_dpp v17, v19, v19 row_half_mirror row_mask:0xf bank_mask:0xa
    s_nop 0
    v_add_f32_dpp v16, v16, v16 quad_perm:[1,0,3,2] row_mask:0xf bank_mask:0xf
    v_add_f32_dpp v17, v17, v17 quad_perm:[1,0,3,2] row_mask:0xf bank_mask:0xf
    s_nop 0
    v_cndmask_b32 v29, v16, v17, s[76:77]
    s_nop 1
    v_add_f32_dpp v29, v29, v29 quad_perm:[2,3,0,1] row_mask:0xf bank_mask:0xf
    v_mul_f32 v29, s74, v29
    s_nop 1
    v_max_f32_dpp v30, v29, v29 quad_perm:[1,0,3,2] row_mask:0xf bank_mask:0xf
    s_nop 1
    v_max_f32_dpp v30, v30, v30 row_ror:4 row_mask:0xf bank_mask:0xf
    s_nop 1
    v_max_f32_dpp v30, v30, v30 row_ror:8 row_mask:0xf bank_mask:0xf
    v_max_f32 v30, v30, v24
    v_sub_f32 v28, v24, v30
    v_sub_f32 v29, v29, v30
    v_exp_f32 v28, v28
    v_exp_f32 v29, v29
    v_mov_b32 v24, v30
    v_cvt_pk_bf16_f32 v26, v29, 0
    v_cvt_pk_bf16_f32 v27, 0, v29
    v_fma_f32 v25, v25, v28, v29
    v_mul_f32 v8, v28, v8
    v_mul_f32 v9, v28, v9
    v_mul_f32 v10, v28, v10
    v_mul_f32 v11, v28, v11
    v_mul_f32 v12, v28, v12
    v_mul_f32 v13, v28, v13
    v_mul_f32 v14, v28, v14
    v_mul_f32 v15, v28, v15
    s_waitcnt vmcnt(5)
    v_dot2c_f32_bf16_dpp v8, v26, v72 row_newbcast:0 row_mask:0xf bank_mask:0xf
    v_dot2c_f32_bf16_dpp v9, v27, v72 row_newbcast:0 row_mask:0xf bank_mask:0xf
    v_dot2c_f32_bf16_dpp v10, v26, v73 row_newbcast:0 row_mask:0xf bank_mask:0xf
    v_dot2c_f32_bf16_dpp v11, v27, v73 row_newbcast:0 row_mask:0xf bank_mask:0xf
    v_dot2c_f32_bf16_dpp v12, v26, v74 row_newbcast:0 row_mask:0xf bank_mask:0xf
    v_dot2c_f32_bf16_dpp v13, v27, v74 row_newbcast:0 row_mask:0xf bank_mask:0xf
    v_dot2c_f32_bf16_dpp v14, v26, v75 row_newbcast:0 row_mask:0xf bank_mask:0xf
    v_dot2c_f32_bf16_dpp v15, v27, v75 row_newbcast:0 row_mask:0xf bank_mask:0xf
    s_waitcnt vmcnt(4)
    buffer_load_dwordx4 v[96:99], v3, s[28:31], 0 offen offset:2048 nt
    v_dot2c_f32_bf16_dpp v8, v26, v76 row_newbcast:1 row_mask:0xf bank_mask:0xf
    v_dot2c_f32_bf16_dpp v9, v27, v76 row_newbcast:1 row_mask:0xf bank_mask:0xf
    v_dot2c_f32_bf16_dpp v10, v26, v77 row_newbcast:1 row_mask:0xf bank_mask:0xf
    v_dot2c_f32_bf16_dpp v11, v27, v77 row_newbcast:1 row_mask:0xf bank_mask:0xf
    v_dot2c_f32_bf16_dpp v12, v26, v78 row_newbcast:1 row_mask:0xf bank_mask:0xf
    v_dot2c_f32_bf16_dpp v13, v27, v78 row_newbcast:1 row_mask:0xf bank_mask:0xf
    v_dot2c_f32_bf16_dpp v14, v26, v79 row_newbcast:1 row_mask:0xf bank_mask:0xf
    v_dot2c_f32_bf16_dpp v15, v27, v79 row_newbcast:1 row_mask:0xf bank_mask:0xf
    s_waitcnt vmcnt(4)
    buffer_load_dwordx4 v[100:103], v3, s[28:31], 0 offen offset:3072 nt
    v_dot2c_f32_bf16_dpp v8, v26, v80 row_newbcast:4 row_mask:0xf bank_mask:0xf
    v_dot2c_f32_bf16_dpp v9, v27, v80 row_newbcast:4 row_mask:0xf bank_mask:0xf
    v_dot2c_f32_bf16_dpp v10, v26, v81 row_newbcast:4 row_mask:0xf bank_mask:0xf
    v_dot2c_f32_bf16_dpp v11, v27, v81 row_newbcast:4 row_mask:0xf bank_mask:0xf
    v_dot2c_f32_bf16_dpp v12, v26, v82 row_newbcast:4 row_mask:0xf bank_mask:0xf
    v_dot2c_f32_bf16_dpp v13, v27, v82 row_newbcast:4 row_mask:0xf bank_mask:0xf
    v_dot2c_f32_bf16_dpp v14, v26, v83 row_newbcast:4 row_mask:0xf bank_mask:0xf
    v_dot2c_f32_bf16_dpp v15, v27, v83 row_newbcast:4 row_mask:0xf bank_mask:0xf
    s_waitcnt vmcnt(4)
    v_add_u32 v2, 0x8000, v2
    v_add_u32 v3, 0x8000, v3
    buffer_load_dwordx4 v[40:43], v2, s[24:27], 0 offen offset:0 nt
    v_dot2c_f32_bf16_dpp v8, v26, v84 row_newbcast:5 row_mask:0xf bank_mask:0xf
    v_dot2c_f32_bf16_dpp v9, v27, v84 row_newbcast:5 row_mask:0xf bank_mask:0xf
    v_dot2c_f32_bf16_dpp v10, v26, v85 row_newbcast:5 row_mask:0xf bank_mask:0xf
    v_dot2c_f32_bf16_dpp v11, v27, v85 row_newbcast:5 row_mask:0xf bank_mask:0xf
    v_dot2c_f32_bf16_dpp v12, v26, v86 row_newbcast:5 row_mask:0xf bank_mask:0xf
    v_dot2c_f32_bf16_dpp v13, v27, v86 row_newbcast:5 row_mask:0xf bank_mask:0xf
    v_dot2c_f32_bf16_dpp v14, v26, v87 row_newbcast:5 row_mask:0xf bank_mask:0xf
    v_dot2c_f32_bf16_dpp v15, v27, v87 row_newbcast:5 row_mask:0xf bank_mask:0xf
    s_waitcnt vmcnt(4)
    buffer_load_dwordx4 v[44:47], v2, s[24:27], 0 offen offset:1024 nt
    v_dot2c_f32_bf16_dpp v8, v26, v88 row_newbcast:8 row_mask:0xf bank_mask:0xf
    v_dot2c_f32_bf16_dpp v9, v27, v88 row_newbcast:8 row_mask:0xf bank_mask:0xf
    v_dot2c_f32_bf16_dpp v10, v26, v89 row_newbcast:8 row_mask:0xf bank_mask:0xf
    v_dot2c_f32_bf16_dpp v11, v27, v89 row_newbcast:8 row_mask:0xf bank_mask:0xf
    v_dot2c_f32_bf16_dpp v12, v26, v90 row_newbcast:8 row_mask:0xf bank_mask:0xf
    v_dot2c_f32_bf16_dpp v13, v27, v90 row_newbcast:8 row_mask:0xf bank_mask:0xf
    v_dot2c_f32_bf16_dpp v14, v26, v91 row_newbcast:8 row_mask:0xf bank_mask:0xf
    v_dot2c_f32_bf16_dpp v15, v27, v91 row_newbcast:8 row_mask:0xf bank_mask:0xf
    s_waitcnt vmcnt(4)
    buffer_load_dwordx4 v[48:51], v2, s[24:27], 0 offen offset:2048 nt
    v_dot2c_f32_bf16_dpp v8, v26, v92 row_newbcast:9 row_mask:0xf bank_mask:0xf
    v_dot2c_f32_bf16_dpp v9, v27, v92 row_newbcast:9 row_mask:0xf bank_mask:0xf
    v_dot2c_f32_bf16_dpp v10, v26, v93 row_newbcast:9 row_mask:0xf bank_mask:0xf
    v_dot2c_f32_bf16_dpp v11, v27, v93 row_newbcast:9 row_mask:0xf bank_mask:0xf
    v_dot2c_f32_bf16_dpp v12, v26, v94 row_newbcast:9 row_mask:0xf bank_mask:0xf
    v_dot2c_f32_bf16_dpp v13, v27, v94 row_newbcast:9 row_mask:0xf bank_mask:0xf
    v_dot2c_f32_bf16_dpp v14, v26, v95 row_newbcast:9 row_mask:0xf bank_mask:0xf
    v_dot2c_f32_bf16_dpp v15, v27, v95 row_newbcast:9 row_mask:0xf bank_mask:0xf
    s_waitcnt vmcnt(4)
    buffer_load_dwordx4 v[52:55], v2, s[24:27], 0 offen offset:3072 nt
    v_dot2c_f32_bf16_dpp v8, v26, v96 row_newbcast:12 row_mask:0xf bank_mask:0xf
    v_dot2c_f32_bf16_dpp v9, v27, v96 row_newbcast:12 row_mask:0xf bank_mask:0xf
    v_dot2c_f32_bf16_dpp v10, v26, v97 row_newbcast:12 row_mask:0xf bank_mask:0xf
    v_dot2c_f32_bf16_dpp v11, v27, v97 row_newbcast:12 row_mask:0xf bank_mask:0xf
    v_dot2c_f32_bf16_dpp v12, v26, v98 row_newbcast:12 row_mask:0xf bank_mask:0xf
    v_dot2c_f32_bf16_dpp v13, v27, v98 row_newbcast:12 row_mask:0xf bank_mask:0xf
    v_dot2c_f32_bf16_dpp v14, v26, v99 row_newbcast:12 row_mask:0xf bank_mask:0xf
    v_dot2c_f32_bf16_dpp v15, v27, v99 row_newbcast:12 row_mask:0xf bank_mask:0xf
    s_waitcnt vmcnt(4)
    buffer_load_dwordx4 v[56:59], v3, s[24:27], 0 offen offset:0 nt
    buffer_load_dwordx4 v[60:63], v3, s[24:27], 0 offen offset:1024 nt
    v_dot2c_f32_bf16_dpp v8, v26, v100 row_newbcast:13 row_mask:0xf bank_mask:0xf
    v_dot2c_f32_bf16_dpp v9, v27, v100 row_newbcast:13 row_mask:0xf bank_mask:0xf
    v_dot2c_f32_bf16_dpp v10, v26, v101 row_newbcast:13 row_mask:0xf bank_mask:0xf
    v_dot2c_f32_bf16_dpp v11, v27, v101 row_newbcast:13 row_mask:0xf bank_mask:0xf
    v_dot2c_f32_bf16_dpp v12, v26, v102 row_newbcast:13 row_mask:0xf bank_mask:0xf
    v_dot2c_f32_bf16_dpp v13, v27, v102 row_newbcast:13 row_mask:0xf bank_mask:0xf
    v_dot2c_f32_bf16_dpp v14, v26, v103 row_newbcast:13 row_mask:0xf bank_mask:0xf
    v_dot2c_f32_bf16_dpp v15, v27, v103 row_newbcast:13 row_mask:0xf bank_mask:0xf
    s_waitcnt vmcnt(5)
    v_dot2_f32_bf16 v16, v40, v4, 0
    v_dot2_f32_bf16 v16, v41, v5, v16
    v_dot2_f32_bf16 v16, v42, v6, v16
    v_dot2_f32_bf16 v16, v43, v7, v16
    s_waitcnt vmcnt(4)
    buffer_load_dwordx4 v[64:67], v3, s[24:27], 0 offen offset:2048 nt
    v_dot2_f32_bf16 v17, v44, v4, 0
    v_dot2_f32_bf16 v17, v45, v5, v17
    v_dot2_f32_bf16 v17, v46, v6, v17
    v_dot2_f32_bf16 v17, v47, v7, v17
    s_waitcnt vmcnt(4)
    buffer_load_dwordx4 v[68:71], v3, s[24:27], 0 offen offset:3072 nt
    v_dot2_f32_bf16 v18, v48, v4, 0
    v_dot2_f32_bf16 v18, v49, v5, v18
    v_dot2_f32_bf16 v18, v50, v6, v18
    v_dot2_f32_bf16 v18, v51, v7, v18
    s_waitcnt vmcnt(4)
    buffer_load_dwordx4 v[72:75], v2, s[28:31], 0 offen offset:0 nt
    v_dot2_f32_bf16 v19, v52, v4, 0
    v_dot2_f32_bf16 v19, v53, v5, v19
    v_dot2_f32_bf16 v19, v54, v6, v19
    v_dot2_f32_bf16 v19, v55, v7, v19
    s_waitcnt vmcnt(4)
    buffer_load_dwordx4 v[76:79], v2, s[28:31], 0 offen offset:1024 nt
    v_dot2_f32_bf16 v20, v56, v4, 0
    v_dot2_f32_bf16 v20, v57, v5, v20
    v_dot2_f32_bf16 v20, v58, v6, v20
    v_dot2_f32_bf16 v20, v59, v7, v20
    s_waitcnt vmcnt(4)
    buffer_load_dwordx4 v[80:83], v2, s[28:31], 0 offen offset:2048 nt
    v_dot2_f32_bf16 v21, v60, v4, 0
    v_dot2_f32_bf16 v21, v61, v5, v21
    v_dot2_f32_bf16 v21, v62, v6, v21
    v_dot2_f32_bf16 v21, v63, v7, v21
    s_waitcnt vmcnt(4)
    buffer_load_dwordx4 v[84:87], v2, s[28:31], 0 offen offset:3072 nt
    v_dot2_f32_bf16 v22, v64, v4, 0
    v_dot2_f32_bf16 v22, v65, v5, v22
    v_dot2_f32_bf16 v22, v66, v6, v22
    v_dot2_f32_bf16 v22, v67, v7, v22
    s_waitcnt vmcnt(4)
    buffer_load_dwordx4 v[88:91], v3, s[28:31], 0 offen offset:0 nt
    buffer_load_dwordx4 v[92:95], v3, s[28:31], 0 offen offset:1024 nt
    v_dot2_f32_bf16 v23, v68, v4, 0
    v_dot2_f32_bf16 v23, v69, v5, v23
    v_dot2_f32_bf16 v23, v70, v6, v23
    v_dot2_f32_bf16 v23, v71, v7, v23
    s_nop 2
    v_add_f32_dpp v16, v16, v16 row_ror:8 row_mask:0xf bank_mask:0x3
    v_add_f32_dpp v17, v17, v17 row_ror:8 row_mask:0xf bank_mask:0x3
    v_add_f32_dpp v18, v18, v18 row_ror:8 row_mask:0xf bank_mask:0x3
    v_add_f32_dpp v19, v19, v19 row_ror:8 row_mask:0xf bank_mask:0x3
    v_add_f32_dpp v16, v20, v20 row_ror:8 row_mask:0xf bank_mask:0xc
    v_add_f32_dpp v17, v21, v21 row_ror:8 row_mask:0xf bank_mask:0xc
    v_add_f32_dpp v18, v22, v22 row_ror:8 row_mask:0xf bank_mask:0xc
    v_add_f32_dpp v19, v23, v23 row_ror:8 row_mask:0xf bank_mask:0xc
    v_add_f32_dpp v16, v16, v16 row_half_mirror row_mask:0xf bank_mask:0x5
    v_add_f32_dpp v17, v17, v17 row_half_mirror row_mask:0xf bank_mask:0x5
    v_add_f32_dpp v16, v18, v18 row_half_mirror row_mask:0xf bank_mask:0xa
    v_add_f32_dpp v17, v19, v19 row_half_mirror row_mask:0xf bank_mask:0xa
    s_nop 0
    v_add_f32_dpp v16, v16, v16 quad_perm:[1,0,3,2] row_mask:0xf bank_mask:0xf
    v_add_f32_dpp v17, v17, v17 quad_perm:[1,0,3,2] row_mask:0xf bank_mask:0xf
    s_nop 0
    v_cndmask_b32 v29, v16, v17, s[76:77]
    s_nop 1
    v_add_f32_dpp v29, v29, v29 quad_perm:[2,3,0,1] row_mask:0xf bank_mask:0xf
    v_mul_f32 v29, s74, v29
    s_nop 1
    v_max_f32_dpp v30, v29, v29 quad_perm:[1,0,3,2] row_mask:0xf bank_mask:0xf
    s_nop 1
    v_max_f32_dpp v30, v30, v30 row_ror:4 row_mask:0xf bank_mask:0xf
    s_nop 1
    v_max_f32_dpp v30, v30, v30 row_ror:8 row_mask:0xf bank_mask:0xf
    v_max_f32 v30, v30, v24
    v_sub_f32 v28, v24, v30
    v_sub_f32 v29, v29, v30
    v_exp_f32 v28, v28
    v_exp_f32 v29, v29
    v_mov_b32 v24, v30
    v_cvt_pk_bf16_f32 v26, v29, 0
    v_cvt_pk_bf16_f32 v27, 0, v29
    v_fma_f32 v25, v25, v28, v29
    v_mul_f32 v8, v28, v8
    v_mul_f32 v9, v28, v9
    v_mul_f32 v10, v28, v10
    v_mul_f32 v11, v28, v11
    v_mul_f32 v12, v28, v12
    v_mul_f32 v13, v28, v13
    v_mul_f32 v14, v28, v14
    v_mul_f32 v15, v28, v15
    s_waitcnt vmcnt(5)
    v_dot2c_f32_bf16_dpp v8, v26, v72 row_newbcast:0 row_mask:0xf bank_mask:0xf
    v_dot2c_f32_bf16_dpp v9, v27, v72 row_newbcast:0 row_mask:0xf bank_mask:0xf
    v_dot2c_f32_bf16_dpp v10, v26, v73 row_newbcast:0 row_mask:0xf bank_mask:0xf
    v_dot2c_f32_bf16_dpp v11, v27, v73 row_newbcast:0 row_mask:0xf bank_mask:0xf
    v_dot2c_f32_bf16_dpp v12, v26, v74 row_newbcast:0 row_mask:0xf bank_mask:0xf
    v_dot2c_f32_bf16_dpp v13, v27, v74 row_newbcast:0 row_mask:0xf bank_mask:0xf
    v_dot2c_f32_bf16_dpp v14, v26, v75 row_newbcast:0 row_mask:0xf bank_mask:0xf
    v_dot2c_f32_bf16_dpp v15, v27, v75 row_newbcast:0 row_mask:0xf bank_mask:0xf
    s_waitcnt vmcnt(4)
    buffer_load_dwordx4 v[96:99], v3, s[28:31], 0 offen offset:2048 nt
    v_dot2c_f32_bf16_dpp v8, v26, v76 row_newbcast:1 row_mask:0xf bank_mask:0xf
    v_dot2c_f32_bf16_dpp v9, v27, v76 row_newbcast:1 row_mask:0xf bank_mask:0xf
    v_dot2c_f32_bf16_dpp v10, v26, v77 row_newbcast:1 row_mask:0xf bank_mask:0xf
    v_dot2c_f32_bf16_dpp v11, v27, v77 row_newbcast:1 row_mask:0xf bank_mask:0xf
    v_dot2c_f32_bf16_dpp v12, v26, v78 row_newbcast:1 row_mask:0xf bank_mask:0xf
    v_dot2c_f32_bf16_dpp v13, v27, v78 row_newbcast:1 row_mask:0xf bank_mask:0xf
    v_dot2c_f32_bf16_dpp v14, v26, v79 row_newbcast:1 row_mask:0xf bank_mask:0xf
    v_dot2c_f32_bf16_dpp v15, v27, v79 row_newbcast:1 row_mask:0xf bank_mask:0xf
    s_waitcnt vmcnt(4)
    buffer_load_dwordx4 v[100:103], v3, s[28:31], 0 offen offset:3072 nt
    v_dot2c_f32_bf16_dpp v8, v26, v80 row_newbcast:4 row_mask:0xf bank_mask:0xf
    v_dot2c_f32_bf16_dpp v9, v27, v80 row_newbcast:4 row_mask:0xf bank_mask:0xf
    v_dot2c_f32_bf16_dpp v10, v26, v81 row_newbcast:4 row_mask:0xf bank_mask:0xf
    v_dot2c_f32_bf16_dpp v11, v27, v81 row_newbcast:4 row_mask:0xf bank_mask:0xf
    v_dot2c_f32_bf16_dpp v12, v26, v82 row_newbcast:4 row_mask:0xf bank_mask:0xf
    v_dot2c_f32_bf16_dpp v13, v27, v82 row_newbcast:4 row_mask:0xf bank_mask:0xf
    v_dot2c_f32_bf16_dpp v14, v26, v83 row_newbcast:4 row_mask:0xf bank_mask:0xf
    v_dot2c_f32_bf16_dpp v15, v27, v83 row_newbcast:4 row_mask:0xf bank_mask:0xf
    s_waitcnt vmcnt(4)
    v_add_u32 v2, 0x8000, v2
    v_add_u32 v3, 0x8000, v3
    buffer_load_dwordx4 v[40:43], v2, s[24:27], 0 offen offset:0 nt
    v_dot2c_f32_bf16_dpp v8, v26, v84 row_newbcast:5 row_mask:0xf bank_mask:0xf
    v_dot2c_f32_bf16_dpp v9, v27, v84 row_newbcast:5 row_mask:0xf bank_mask:0xf
    v_dot2c_f32_bf16_dpp v10, v26, v85 row_newbcast:5 row_mask:0xf bank_mask:0xf
    v_dot2c_f32_bf16_dpp v11, v27, v85 row_newbcast:5 row_mask:0xf bank_mask:0xf
    v_dot2c_f32_bf16_dpp v12, v26, v86 row_newbcast:5 row_mask:0xf bank_mask:0xf
    v_dot2c_f32_bf16_dpp v13, v27, v86 row_newbcast:5 row_mask:0xf bank_mask:0xf
    v_dot2c_f32_bf16_dpp v14, v26, v87 row_newbcast:5 row_mask:0xf bank_mask:0xf
    v_dot2c_f32_bf16_dpp v15, v27, v87 row_newbcast:5 row_mask:0xf bank_mask:0xf
    s_waitcnt vmcnt(4)
    buffer_load_dwordx4 v[44:47], v2, s[24:27], 0 offen offset:1024 nt
    v_dot2c_f32_bf16_dpp v8, v26, v88 row_newbcast:8 row_mask:0xf bank_mask:0xf
    v_dot2c_f32_bf16_dpp v9, v27, v88 row_newbcast:8 row_mask:0xf bank_mask:0xf
    v_dot2c_f32_bf16_dpp v10, v26, v89 row_newbcast:8 row_mask:0xf bank_mask:0xf
    v_dot2c_f32_bf16_dpp v11, v27, v89 row_newbcast:8 row_mask:0xf bank_mask:0xf
    v_dot2c_f32_bf16_dpp v12, v26, v90 row_newbcast:8 row_mask:0xf bank_mask:0xf
    v_dot2c_f32_bf16_dpp v13, v27, v90 row_newbcast:8 row_mask:0xf bank_mask:0xf
    v_dot2c_f32_bf16_dpp v14, v26, v91 row_newbcast:8 row_mask:0xf bank_mask:0xf
    v_dot2c_f32_bf16_dpp v15, v27, v91 row_newbcast:8 row_mask:0xf bank_mask:0xf
    s_waitcnt vmcnt(4)
    buffer_load_dwordx4 v[48:51], v2, s[24:27], 0 offen offset:2048 nt
    v_dot2c_f32_bf16_dpp v8, v26, v92 row_newbcast:9 row_mask:0xf bank_mask:0xf
    v_dot2c_f32_bf16_dpp v9, v27, v92 row_newbcast:9 row_mask:0xf bank_mask:0xf
    v_dot2c_f32_bf16_dpp v10, v26, v93 row_newbcast:9 row_mask:0xf bank_mask:0xf
    v_dot2c_f32_bf16_dpp v11, v27, v93 row_newbcast:9 row_mask:0xf bank_mask:0xf
    v_dot2c_f32_bf16_dpp v12, v26, v94 row_newbcast:9 row_mask:0xf bank_mask:0xf
    v_dot2c_f32_bf16_dpp v13, v27, v94 row_newbcast:9 row_mask:0xf bank_mask:0xf
    v_dot2c_f32_bf16_dpp v14, v26, v95 row_newbcast:9 row_mask:0xf bank_mask:0xf
    v_dot2c_f32_bf16_dpp v15, v27, v95 row_newbcast:9 row_mask:0xf bank_mask:0xf
    s_waitcnt vmcnt(4)
    buffer_load_dwordx4 v[52:55], v2, s[24:27], 0 offen offset:3072 nt
    v_dot2c_f32_bf16_dpp v8, v26, v96 row_newbcast:12 row_mask:0xf bank_mask:0xf
    v_dot2c_f32_bf16_dpp v9, v27, v96 row_newbcast:12 row_mask:0xf bank_mask:0xf
    v_dot2c_f32_bf16_dpp v10, v26, v97 row_newbcast:12 row_mask:0xf bank_mask:0xf
    v_dot2c_f32_bf16_dpp v11, v27, v97 row_newbcast:12 row_mask:0xf bank_mask:0xf
    v_dot2c_f32_bf16_dpp v12, v26, v98 row_newbcast:12 row_mask:0xf bank_mask:0xf
    v_dot2c_f32_bf16_dpp v13, v27, v98 row_newbcast:12 row_mask:0xf bank_mask:0xf
    v_dot2c_f32_bf16_dpp v14, v26, v99 row_newbcast:12 row_mask:0xf bank_mask:0xf
    v_dot2c_f32_bf16_dpp v15, v27, v99 row_newbcast:12 row_mask:0xf bank_mask:0xf
    s_waitcnt vmcnt(4)
    buffer_load_dwordx4 v[56:59], v3, s[24:27], 0 offen offset:0 nt
    buffer_load_dwordx4 v[60:63], v3, s[24:27], 0 offen offset:1024 nt
    v_dot2c_f32_bf16_dpp v8, v26, v100 row_newbcast:13 row_mask:0xf bank_mask:0xf
    v_dot2c_f32_bf16_dpp v9, v27, v100 row_newbcast:13 row_mask:0xf bank_mask:0xf
    v_dot2c_f32_bf16_dpp v10, v26, v101 row_newbcast:13 row_mask:0xf bank_mask:0xf
    v_dot2c_f32_bf16_dpp v11, v27, v101 row_newbcast:13 row_mask:0xf bank_mask:0xf
    v_dot2c_f32_bf16_dpp v12, v26, v102 row_newbcast:13 row_mask:0xf bank_mask:0xf
    v_dot2c_f32_bf16_dpp v13, v27, v102 row_newbcast:13 row_mask:0xf bank_mask:0xf
    v_dot2c_f32_bf16_dpp v14, v26, v103 row_newbcast:13 row_mask:0xf bank_mask:0xf
    v_dot2c_f32_bf16_dpp v15, v27, v103 row_newbcast:13 row_mask:0xf bank_mask:0xf
    s_waitcnt vmcnt(5)
    v_dot2_f32_bf16 v16, v40, v4, 0
    v_dot2_f32_bf16 v16, v41, v5, v16
    v_dot2_f32_bf16 v16, v42, v6, v16
    v_dot2_f32_bf16 v16, v43, v7, v16
    s_waitcnt vmcnt(4)
    buffer_load_dwordx4 v[64:67], v3, s[24:27], 0 offen offset:2048 nt
    v_dot2_f32_bf16 v17, v44, v4, 0
    v_dot2_f32_bf16 v17, v45, v5, v17
    v_dot2_f32_bf16 v17, v46, v6, v17
    v_dot2_f32_bf16 v17, v47, v7, v17
    s_waitcnt vmcnt(4)
    buffer_load_dwordx4 v[68:71], v3, s[24:27], 0 offen offset:3072 nt
    v_dot2_f32_bf16 v18, v48, v4, 0
    v_dot2_f32_bf16 v18, v49, v5, v18
    v_dot2_f32_bf16 v18, v50, v6, v18
    v_dot2_f32_bf16 v18, v51, v7, v18
    s_waitcnt vmcnt(4)
    buffer_load_dwordx4 v[72:75], v2, s[28:31], 0 offen offset:0 nt
    v_dot2_f32_bf16 v19, v52, v4, 0
    v_dot2_f32_bf16 v19, v53, v5, v19
    v_dot2_f32_bf16 v19, v54, v6, v19
    v_dot2_f32_bf16 v19, v55, v7, v19
    s_waitcnt vmcnt(4)
    buffer_load_dwordx4 v[76:79], v2, s[28:31], 0 offen offset:1024 nt
    v_dot2_f32_bf16 v20, v56, v4, 0
    v_dot2_f32_bf16 v20, v57, v5, v20
    v_dot2_f32_bf16 v20, v58, v6, v20
    v_dot2_f32_bf16 v20, v59, v7, v20
    s_waitcnt vmcnt(4)
    buffer_load_dwordx4 v[80:83], v2, s[28:31], 0 offen offset:2048 nt
    v_dot2_f32_bf16 v21, v60, v4, 0
    v_dot2_f32_bf16 v21, v61, v5, v21
    v_dot2_f32_bf16 v21, v62, v6, v21
    v_dot2_f32_bf16 v21, v63, v7, v21
    s_waitcnt vmcnt(4)
    buffer_load_dwordx4 v[84:87], v2, s[28:31], 0 offen offset:3072 nt
    v_dot2_f32_bf16 v22, v64, v4, 0
    v_dot2_f32_bf16 v22, v65, v5, v22
    v_dot2_f32_bf16 v22, v66, v6, v22
    v_dot2_f32_bf16 v22, v67, v7, v22
    s_waitcnt vmcnt(4)
    buffer_load_dwordx4 v[88:91], v3, s[28:31], 0 offen offset:0 nt
    buffer_load_dwordx4 v[92:95], v3, s[28:31], 0 offen offset:1024 nt
    v_dot2_f32_bf16 v23, v68, v4, 0
    v_dot2_f32_bf16 v23, v69, v5, v23
    v_dot2_f32_bf16 v23, v70, v6, v23
    v_dot2_f32_bf16 v23, v71, v7, v23
    s_nop 2
    v_add_f32_dpp v16, v16, v16 row_ror:8 row_mask:0xf bank_mask:0x3
    v_add_f32_dpp v17, v17, v17 row_ror:8 row_mask:0xf bank_mask:0x3
    v_add_f32_dpp v18, v18, v18 row_ror:8 row_mask:0xf bank_mask:0x3
    v_add_f32_dpp v19, v19, v19 row_ror:8 row_mask:0xf bank_mask:0x3
    v_add_f32_dpp v16, v20, v20 row_ror:8 row_mask:0xf bank_mask:0xc
    v_add_f32_dpp v17, v21, v21 row_ror:8 row_mask:0xf bank_mask:0xc
    v_add_f32_dpp v18, v22, v22 row_ror:8 row_mask:0xf bank_mask:0xc
    v_add_f32_dpp v19, v23, v23 row_ror:8 row_mask:0xf bank_mask:0xc
    v_add_f32_dpp v16, v16, v16 row_half_mirror row_mask:0xf bank_mask:0x5
    v_add_f32_dpp v17, v17, v17 row_half_mirror row_mask:0xf bank_mask:0x5
    v_add_f32_dpp v16, v18, v18 row_half_mirror row_mask:0xf bank_mask:0xa
    v_add_f32_dpp v17, v19, v19 row_half_mirror row_mask:0xf bank_mask:0xa
    s_nop 0
    v_add_f32_dpp v16, v16, v16 quad_perm:[1,0,3,2] row_mask:0xf bank_mask:0xf
    v_add_f32_dpp v17, v17, v17 quad_perm:[1,0,3,2] row_mask:0xf bank_mask:0xf
    s_nop 0
    v_cndmask_b32 v29, v16, v17, s[76:77]
    s_nop 1
    v_add_f32_dpp v29, v29, v29 quad_perm:[2,3,0,1] row_mask:0xf bank_mask:0xf
    v_mul_f32 v29, s74, v29
    s_nop 1
    v_max_f32_dpp v30, v29, v29 quad_perm:[1,0,3,2] row_mask:0xf bank_mask:0xf
    s_nop 1
    v_max_f32_dpp v30, v30, v30 row_ror:4 row_mask:0xf bank_mask:0xf
    s_nop 1
    v_max_f32_dpp v30, v30, v30 row_ror:8 row_mask:0xf bank_mask:0xf
    v_max_f32 v30, v30, v24
    v_sub_f32 v28, v24, v30
    v_sub_f32 v29, v29, v30
    v_exp_f32 v28, v28
    v_exp_f32 v29, v29
    v_mov_b32 v24, v30
    v_cvt_pk_bf16_f32 v26, v29, 0
    v_cvt_pk_bf16_f32 v27, 0, v29
    v_fma_f32 v25, v25, v28, v29
    v_mul_f32 v8, v28, v8
    v_mul_f32 v9, v28, v9
    v_mul_f32 v10, v28, v10
    v_mul_f32 v11, v28, v11
    v_mul_f32 v12, v28, v12
    v_mul_f32 v13, v28, v13
    v_mul_f32 v14, v28, v14
    v_mul_f32 v15, v28, v15
    s_waitcnt vmcnt(5)
    v_dot2c_f32_bf16_dpp v8, v26, v72 row_newbcast:0 row_mask:0xf bank_mask:0xf
    v_dot2c_f32_bf16_dpp v9, v27, v72 row_newbcast:0 row_mask:0xf bank_mask:0xf
    v_dot2c_f32_bf16_dpp v10, v26, v73 row_newbcast:0 row_mask:0xf bank_mask:0xf
    v_dot2c_f32_bf16_dpp v11, v27, v73 row_newbcast:0 row_mask:0xf bank_mask:0xf
    v_dot2c_f32_bf16_dpp v12, v26, v74 row_newbcast:0 row_mask:0xf bank_mask:0xf
    v_dot2c_f32_bf16_dpp v13, v27, v74 row_newbcast:0 row_mask:0xf bank_mask:0xf
    v_dot2c_f32_bf16_dpp v14, v26, v75 row_newbcast:0 row_mask:0xf bank_mask:0xf
    v_dot2c_f32_bf16_dpp v15, v27, v75 row_newbcast:0 row_mask:0xf bank_mask:0xf
    s_waitcnt vmcnt(4)
    buffer_load_dwordx4 v[96:99], v3, s[28:31], 0 offen offset:2048 nt
    v_dot2c_f32_bf16_dpp v8, v26, v76 row_newbcast:1 row_mask:0xf bank_mask:0xf
    v_dot2c_f32_bf16_dpp v9, v27, v76 row_newbcast:1 row_mask:0xf bank_mask:0xf
    v_dot2c_f32_bf16_dpp v10, v26, v77 row_newbcast:1 row_mask:0xf bank_mask:0xf
    v_dot2c_f32_bf16_dpp v11, v27, v77 row_newbcast:1 row_mask:0xf bank_mask:0xf
    v_dot2c_f32_bf16_dpp v12, v26, v78 row_newbcast:1 row_mask:0xf bank_mask:0xf
    v_dot2c_f32_bf16_dpp v13, v27, v78 row_newbcast:1 row_mask:0xf bank_mask:0xf
    v_dot2c_f32_bf16_dpp v14, v26, v79 row_newbcast:1 row_mask:0xf bank_mask:0xf
    v_dot2c_f32_bf16_dpp v15, v27, v79 row_newbcast:1 row_mask:0xf bank_mask:0xf
    s_waitcnt vmcnt(4)
    buffer_load_dwordx4 v[100:103], v3, s[28:31], 0 offen offset:3072 nt
    v_dot2c_f32_bf16_dpp v8, v26, v80 row_newbcast:4 row_mask:0xf bank_mask:0xf
    v_dot2c_f32_bf16_dpp v9, v27, v80 row_newbcast:4 row_mask:0xf bank_mask:0xf
    v_dot2c_f32_bf16_dpp v10, v26, v81 row_newbcast:4 row_mask:0xf bank_mask:0xf
    v_dot2c_f32_bf16_dpp v11, v27, v81 row_newbcast:4 row_mask:0xf bank_mask:0xf
    v_dot2c_f32_bf16_dpp v12, v26, v82 row_newbcast:4 row_mask:0xf bank_mask:0xf
    v_dot2c_f32_bf16_dpp v13, v27, v82 row_newbcast:4 row_mask:0xf bank_mask:0xf
    v_dot2c_f32_bf16_dpp v14, v26, v83 row_newbcast:4 row_mask:0xf bank_mask:0xf
    v_dot2c_f32_bf16_dpp v15, v27, v83 row_newbcast:4 row_mask:0xf bank_mask:0xf
    s_waitcnt vmcnt(4)
    v_add_u32 v2, 0x8000, v2
    v_add_u32 v3, 0x8000, v3
    buffer_load_dwordx4 v[40:43], v2, s[24:27], 0 offen offset:0 nt
    v_dot2c_f32_bf16_dpp v8, v26, v84 row_newbcast:5 row_mask:0xf bank_mask:0xf
    v_dot2c_f32_bf16_dpp v9, v27, v84 row_newbcast:5 row_mask:0xf bank_mask:0xf
    v_dot2c_f32_bf16_dpp v10, v26, v85 row_newbcast:5 row_mask:0xf bank_mask:0xf
    v_dot2c_f32_bf16_dpp v11, v27, v85 row_newbcast:5 row_mask:0xf bank_mask:0xf
    v_dot2c_f32_bf16_dpp v12, v26, v86 row_newbcast:5 row_mask:0xf bank_mask:0xf
    v_dot2c_f32_bf16_dpp v13, v27, v86 row_newbcast:5 row_mask:0xf bank_mask:0xf
    v_dot2c_f32_bf16_dpp v14, v26, v87 row_newbcast:5 row_mask:0xf bank_mask:0xf
    v_dot2c_f32_bf16_dpp v15, v27, v87 row_newbcast:5 row_mask:0xf bank_mask:0xf
    s_waitcnt vmcnt(4)
    buffer_load_dwordx4 v[44:47], v2, s[24:27], 0 offen offset:1024 nt
    v_dot2c_f32_bf16_dpp v8, v26, v88 row_newbcast:8 row_mask:0xf bank_mask:0xf
    v_dot2c_f32_bf16_dpp v9, v27, v88 row_newbcast:8 row_mask:0xf bank_mask:0xf
    v_dot2c_f32_bf16_dpp v10, v26, v89 row_newbcast:8 row_mask:0xf bank_mask:0xf
    v_dot2c_f32_bf16_dpp v11, v27, v89 row_newbcast:8 row_mask:0xf bank_mask:0xf
    v_dot2c_f32_bf16_dpp v12, v26, v90 row_newbcast:8 row_mask:0xf bank_mask:0xf
    v_dot2c_f32_bf16_dpp v13, v27, v90 row_newbcast:8 row_mask:0xf bank_mask:0xf
    v_dot2c_f32_bf16_dpp v14, v26, v91 row_newbcast:8 row_mask:0xf bank_mask:0xf
    v_dot2c_f32_bf16_dpp v15, v27, v91 row_newbcast:8 row_mask:0xf bank_mask:0xf
    s_waitcnt vmcnt(4)
    buffer_load_dwordx4 v[48:51], v2, s[24:27], 0 offen offset:2048 nt
    v_dot2c_f32_bf16_dpp v8, v26, v92 row_newbcast:9 row_mask:0xf bank_mask:0xf
    v_dot2c_f32_bf16_dpp v9, v27, v92 row_newbcast:9 row_mask:0xf bank_mask:0xf
    v_dot2c_f32_bf16_dpp v10, v26, v93 row_newbcast:9 row_mask:0xf bank_mask:0xf
    v_dot2c_f32_bf16_dpp v11, v27, v93 row_newbcast:9 row_mask:0xf bank_mask:0xf
    v_dot2c_f32_bf16_dpp v12, v26, v94 row_newbcast:9 row_mask:0xf bank_mask:0xf
    v_dot2c_f32_bf16_dpp v13, v27, v94 row_newbcast:9 row_mask:0xf bank_mask:0xf
    v_dot2c_f32_bf16_dpp v14, v26, v95 row_newbcast:9 row_mask:0xf bank_mask:0xf
    v_dot2c_f32_bf16_dpp v15, v27, v95 row_newbcast:9 row_mask:0xf bank_mask:0xf
    s_waitcnt vmcnt(4)
    buffer_load_dwordx4 v[52:55], v2, s[24:27], 0 offen offset:3072 nt
    v_dot2c_f32_bf16_dpp v8, v26, v96 row_newbcast:12 row_mask:0xf bank_mask:0xf
    v_dot2c_f32_bf16_dpp v9, v27, v96 row_newbcast:12 row_mask:0xf bank_mask:0xf
    v_dot2c_f32_bf16_dpp v10, v26, v97 row_newbcast:12 row_mask:0xf bank_mask:0xf
    v_dot2c_f32_bf16_dpp v11, v27, v97 row_newbcast:12 row_mask:0xf bank_mask:0xf
    v_dot2c_f32_bf16_dpp v12, v26, v98 row_newbcast:12 row_mask:0xf bank_mask:0xf
    v_dot2c_f32_bf16_dpp v13, v27, v98 row_newbcast:12 row_mask:0xf bank_mask:0xf
    v_dot2c_f32_bf16_dpp v14, v26, v99 row_newbcast:12 row_mask:0xf bank_mask:0xf
    v_dot2c_f32_bf16_dpp v15, v27, v99 row_newbcast:12 row_mask:0xf bank_mask:0xf
    s_waitcnt vmcnt(4)
    buffer_load_dwordx4 v[56:59], v3, s[24:27], 0 offen offset:0 nt
    buffer_load_dwordx4 v[60:63], v3, s[24:27], 0 offen offset:1024 nt
    v_dot2c_f32_bf16_dpp v8, v26, v100 row_newbcast:13 row_mask:0xf bank_mask:0xf
    v_dot2c_f32_bf16_dpp v9, v27, v100 row_newbcast:13 row_mask:0xf bank_mask:0xf
    v_dot2c_f32_bf16_dpp v10, v26, v101 row_newbcast:13 row_mask:0xf bank_mask:0xf
    v_dot2c_f32_bf16_dpp v11, v27, v101 row_newbcast:13 row_mask:0xf bank_mask:0xf
    v_dot2c_f32_bf16_dpp v12, v26, v102 row_newbcast:13 row_mask:0xf bank_mask:0xf
    v_dot2c_f32_bf16_dpp v13, v27, v102 row_newbcast:13 row_mask:0xf bank_mask:0xf
    v_dot2c_f32_bf16_dpp v14, v26, v103 row_newbcast:13 row_mask:0xf bank_mask:0xf
    v_dot2c_f32_bf16_dpp v15, v27, v103 row_newbcast:13 row_mask:0xf bank_mask:0xf
    s_waitcnt vmcnt(5)
    v_dot2_f32_bf16 v16, v40, v4, 0
    v_dot2_f32_bf16 v16, v41, v5, v16
    v_dot2_f32_bf16 v16, v42, v6, v16
    v_dot2_f32_bf16 v16, v43, v7, v16
    s_waitcnt vmcnt(4)
    buffer_load_dwordx4 v[64:67], v3, s[24:27], 0 offen offset:2048 nt
    v_dot2_f32_bf16 v17, v44, v4, 0
    v_dot2_f32_bf16 v17, v45, v5, v17
    v_dot2_f32_bf16 v17, v46, v6, v17
    v_dot2_f32_bf16 v17, v47, v7, v17
    s_waitcnt vmcnt(4)
    buffer_load_dwordx4 v[68:71], v3, s[24:27], 0 offen offset:3072 nt
    v_dot2_f32_bf16 v18, v48, v4, 0
    v_dot2_f32_bf16 v18, v49, v5, v18
    v_dot2_f32_bf16 v18, v50, v6, v18
    v_dot2_f32_bf16 v18, v51, v7, v18
    s_waitcnt vmcnt(4)
    buffer_load_dwordx4 v[72:75], v2, s[28:31], 0 offen offset:0 nt
    v_dot2_f32_bf16 v19, v52, v4, 0
    v_dot2_f32_bf16 v19, v53, v5, v19
    v_dot2_f32_bf16 v19, v54, v6, v19
    v_dot2_f32_bf16 v19, v55, v7, v19
    s_waitcnt vmcnt(4)
    buffer_load_dwordx4 v[76:79], v2, s[28:31], 0 offen offset:1024 nt
    v_dot2_f32_bf16 v20, v56, v4, 0
    v_dot2_f32_bf16 v20, v57, v5, v20
    v_dot2_f32_bf16 v20, v58, v6, v20
    v_dot2_f32_bf16 v20, v59, v7, v20
    s_waitcnt vmcnt(4)
    buffer_load_dwordx4 v[80:83], v2, s[28:31], 0 offen offset:2048 nt
    v_dot2_f32_bf16 v21, v60, v4, 0
    v_dot2_f32_bf16 v21, v61, v5, v21
    v_dot2_f32_bf16 v21, v62, v6, v21
    v_dot2_f32_bf16 v21, v63, v7, v21
    s_waitcnt vmcnt(4)
    buffer_load_dwordx4 v[84:87], v2, s[28:31], 0 offen offset:3072 nt
    v_dot2_f32_bf16 v22, v64, v4, 0
    v_dot2_f32_bf16 v22, v65, v5, v22
    v_dot2_f32_bf16 v22, v66, v6, v22
    v_dot2_f32_bf16 v22, v67, v7, v22
    s_waitcnt vmcnt(4)
    buffer_load_dwordx4 v[88:91], v3, s[28:31], 0 offen offset:0 nt
    buffer_load_dwordx4 v[92:95], v3, s[28:31], 0 offen offset:1024 nt
    v_dot2_f32_bf16 v23, v68, v4, 0
    v_dot2_f32_bf16 v23, v69, v5, v23
    v_dot2_f32_bf16 v23, v70, v6, v23
    v_dot2_f32_bf16 v23, v71, v7, v23
    s_nop 2
    v_add_f32_dpp v16, v16, v16 row_ror:8 row_mask:0xf bank_mask:0x3
    v_add_f32_dpp v17, v17, v17 row_ror:8 row_mask:0xf bank_mask:0x3
    v_add_f32_dpp v18, v18, v18 row_ror:8 row_mask:0xf bank_mask:0x3
    v_add_f32_dpp v19, v19, v19 row_ror:8 row_mask:0xf bank_mask:0x3
    v_add_f32_dpp v16, v20, v20 row_ror:8 row_mask:0xf bank_mask:0xc
    v_add_f32_dpp v17, v21, v21 row_ror:8 row_mask:0xf bank_mask:0xc
    v_add_f32_dpp v18, v22, v22 row_ror:8 row_mask:0xf bank_mask:0xc
    v_add_f32_dpp v19, v23, v23 row_ror:8 row_mask:0xf bank_mask:0xc
    v_add_f32_dpp v16, v16, v16 row_half_mirror row_mask:0xf bank_mask:0x5
    v_add_f32_dpp v17, v17, v17 row_half_mirror row_mask:0xf bank_mask:0x5
    v_add_f32_dpp v16, v18, v18 row_half_mirror row_mask:0xf bank_mask:0xa
    v_add_f32_dpp v17, v19, v19 row_half_mirror row_mask:0xf bank_mask:0xa
    s_nop 0
    v_add_f32_dpp v16, v16, v16 quad_perm:[1,0,3,2] row_mask:0xf bank_mask:0xf
    v_add_f32_dpp v17, v17, v17 quad_perm:[1,0,3,2] row_mask:0xf bank_mask:0xf
    s_nop 0
    v_cndmask_b32 v29, v16, v17, s[76:77]
    s_nop 1
    v_add_f32_dpp v29, v29, v29 quad_perm:[2,3,0,1] row_mask:0xf bank_mask:0xf
    v_mul_f32 v29, s74, v29
    s_nop 1
    v_max_f32_dpp v30, v29, v29 quad_perm:[1,0,3,2] row_mask:0xf bank_mask:0xf
    s_nop 1
    v_max_f32_dpp v30, v30, v30 row_ror:4 row_mask:0xf bank_mask:0xf
    s_nop 1
    v_max_f32_dpp v30, v30, v30 row_ror:8 row_mask:0xf bank_mask:0xf
    v_max_f32 v30, v30, v24
    v_sub_f32 v28, v24, v30
    v_sub_f32 v29, v29, v30
    v_exp_f32 v28, v28
    v_exp_f32 v29, v29
    v_mov_b32 v24, v30
    v_cvt_pk_bf16_f32 v26, v29, 0
    v_cvt_pk_bf16_f32 v27, 0, v29
    v_fma_f32 v25, v25, v28, v29
    v_mul_f32 v8, v28, v8
    v_mul_f32 v9, v28, v9
    v_mul_f32 v10, v28, v10
    v_mul_f32 v11, v28, v11
    v_mul_f32 v12, v28, v12
    v_mul_f32 v13, v28, v13
    v_mul_f32 v14, v28, v14
    v_mul_f32 v15, v28, v15
    s_waitcnt vmcnt(5)
    v_dot2c_f32_bf16_dpp v8, v26, v72 row_newbcast:0 row_mask:0xf bank_mask:0xf
    v_dot2c_f32_bf16_dpp v9, v27, v72 row_newbcast:0 row_mask:0xf bank_mask:0xf
    v_dot2c_f32_bf16_dpp v10, v26, v73 row_newbcast:0 row_mask:0xf bank_mask:0xf
    v_dot2c_f32_bf16_dpp v11, v27, v73 row_newbcast:0 row_mask:0xf bank_mask:0xf
    v_dot2c_f32_bf16_dpp v12, v26, v74 row_newbcast:0 row_mask:0xf bank_mask:0xf
    v_dot2c_f32_bf16_dpp v13, v27, v74 row_newbcast:0 row_mask:0xf bank_mask:0xf
    v_dot2c_f32_bf16_dpp v14, v26, v75 row_newbcast:0 row_mask:0xf bank_mask:0xf
    v_dot2c_f32_bf16_dpp v15, v27, v75 row_newbcast:0 row_mask:0xf bank_mask:0xf
    s_waitcnt vmcnt(4)
    buffer_load_dwordx4 v[96:99], v3, s[28:31], 0 offen offset:2048 nt
    v_dot2c_f32_bf16_dpp v8, v26, v76 row_newbcast:1 row_mask:0xf bank_mask:0xf
    v_dot2c_f32_bf16_dpp v9, v27, v76 row_newbcast:1 row_mask:0xf bank_mask:0xf
    v_dot2c_f32_bf16_dpp v10, v26, v77 row_newbcast:1 row_mask:0xf bank_mask:0xf
    v_dot2c_f32_bf16_dpp v11, v27, v77 row_newbcast:1 row_mask:0xf bank_mask:0xf
    v_dot2c_f32_bf16_dpp v12, v26, v78 row_newbcast:1 row_mask:0xf bank_mask:0xf
    v_dot2c_f32_bf16_dpp v13, v27, v78 row_newbcast:1 row_mask:0xf bank_mask:0xf
    v_dot2c_f32_bf16_dpp v14, v26, v79 row_newbcast:1 row_mask:0xf bank_mask:0xf
    v_dot2c_f32_bf16_dpp v15, v27, v79 row_newbcast:1 row_mask:0xf bank_mask:0xf
    s_waitcnt vmcnt(4)
    buffer_load_dwordx4 v[100:103], v3, s[28:31], 0 offen offset:3072 nt
    v_dot2c_f32_bf16_dpp v8, v26, v80 row_newbcast:4 row_mask:0xf bank_mask:0xf
    v_dot2c_f32_bf16_dpp v9, v27, v80 row_newbcast:4 row_mask:0xf bank_mask:0xf
    v_dot2c_f32_bf16_dpp v10, v26, v81 row_newbcast:4 row_mask:0xf bank_mask:0xf
    v_dot2c_f32_bf16_dpp v11, v27, v81 row_newbcast:4 row_mask:0xf bank_mask:0xf
    v_dot2c_f32_bf16_dpp v12, v26, v82 row_newbcast:4 row_mask:0xf bank_mask:0xf
    v_dot2c_f32_bf16_dpp v13, v27, v82 row_newbcast:4 row_mask:0xf bank_mask:0xf
    v_dot2c_f32_bf16_dpp v14, v26, v83 row_newbcast:4 row_mask:0xf bank_mask:0xf
    v_dot2c_f32_bf16_dpp v15, v27, v83 row_newbcast:4 row_mask:0xf bank_mask:0xf
    s_waitcnt vmcnt(4)
    v_add_u32 v2, 0x8000, v2
    v_add_u32 v3, 0x8000, v3
    buffer_load_dwordx4 v[40:43], v2, s[24:27], 0 offen offset:0 nt
    v_dot2c_f32_bf16_dpp v8, v26, v84 row_newbcast:5 row_mask:0xf bank_mask:0xf
    v_dot2c_f32_bf16_dpp v9, v27, v84 row_newbcast:5 row_mask:0xf bank_mask:0xf
    v_dot2c_f32_bf16_dpp v10, v26, v85 row_newbcast:5 row_mask:0xf bank_mask:0xf
    v_dot2c_f32_bf16_dpp v11, v27, v85 row_newbcast:5 row_mask:0xf bank_mask:0xf
    v_dot2c_f32_bf16_dpp v12, v26, v86 row_newbcast:5 row_mask:0xf bank_mask:0xf
    v_dot2c_f32_bf16_dpp v13, v27, v86 row_newbcast:5 row_mask:0xf bank_mask:0xf
    v_dot2c_f32_bf16_dpp v14, v26, v87 row_newbcast:5 row_mask:0xf bank_mask:0xf
    v_dot2c_f32_bf16_dpp v15, v27, v87 row_newbcast:5 row_mask:0xf bank_mask:0xf
    s_waitcnt vmcnt(4)
    buffer_load_dwordx4 v[44:47], v2, s[24:27], 0 offen offset:1024 nt
    v_dot2c_f32_bf16_dpp v8, v26, v88 row_newbcast:8 row_mask:0xf bank_mask:0xf
    v_dot2c_f32_bf16_dpp v9, v27, v88 row_newbcast:8 row_mask:0xf bank_mask:0xf
    v_dot2c_f32_bf16_dpp v10, v26, v89 row_newbcast:8 row_mask:0xf bank_mask:0xf
    v_dot2c_f32_bf16_dpp v11, v27, v89 row_newbcast:8 row_mask:0xf bank_mask:0xf
    v_dot2c_f32_bf16_dpp v12, v26, v90 row_newbcast:8 row_mask:0xf bank_mask:0xf
    v_dot2c_f32_bf16_dpp v13, v27, v90 row_newbcast:8 row_mask:0xf bank_mask:0xf
    v_dot2c_f32_bf16_dpp v14, v26, v91 row_newbcast:8 row_mask:0xf bank_mask:0xf
    v_dot2c_f32_bf16_dpp v15, v27, v91 row_newbcast:8 row_mask:0xf bank_mask:0xf
    s_waitcnt vmcnt(4)
    buffer_load_dwordx4 v[48:51], v2, s[24:27], 0 offen offset:2048 nt
    v_dot2c_f32_bf16_dpp v8, v26, v92 row_newbcast:9 row_mask:0xf bank_mask:0xf
    v_dot2c_f32_bf16_dpp v9, v27, v92 row_newbcast:9 row_mask:0xf bank_mask:0xf
    v_dot2c_f32_bf16_dpp v10, v26, v93 row_newbcast:9 row_mask:0xf bank_mask:0xf
    v_dot2c_f32_bf16_dpp v11, v27, v93 row_newbcast:9 row_mask:0xf bank_mask:0xf
    v_dot2c_f32_bf16_dpp v12, v26, v94 row_newbcast:9 row_mask:0xf bank_mask:0xf
    v_dot2c_f32_bf16_dpp v13, v27, v94 row_newbcast:9 row_mask:0xf bank_mask:0xf
    v_dot2c_f32_bf16_dpp v14, v26, v95 row_newbcast:9 row_mask:0xf bank_mask:0xf
    v_dot2c_f32_bf16_dpp v15, v27, v95 row_newbcast:9 row_mask:0xf bank_mask:0xf
    s_waitcnt vmcnt(4)
    buffer_load_dwordx4 v[52:55], v2, s[24:27], 0 offen offset:3072 nt
    v_dot2c_f32_bf16_dpp v8, v26, v96 row_newbcast:12 row_mask:0xf bank_mask:0xf
    v_dot2c_f32_bf16_dpp v9, v27, v96 row_newbcast:12 row_mask:0xf bank_mask:0xf
    v_dot2c_f32_bf16_dpp v10, v26, v97 row_newbcast:12 row_mask:0xf bank_mask:0xf
    v_dot2c_f32_bf16_dpp v11, v27, v97 row_newbcast:12 row_mask:0xf bank_mask:0xf
    v_dot2c_f32_bf16_dpp v12, v26, v98 row_newbcast:12 row_mask:0xf bank_mask:0xf
    v_dot2c_f32_bf16_dpp v13, v27, v98 row_newbcast:12 row_mask:0xf bank_mask:0xf
    v_dot2c_f32_bf16_dpp v14, v26, v99 row_newbcast:12 row_mask:0xf bank_mask:0xf
    v_dot2c_f32_bf16_dpp v15, v27, v99 row_newbcast:12 row_mask:0xf bank_mask:0xf
    s_waitcnt vmcnt(4)
    buffer_load_dwordx4 v[56:59], v3, s[24:27], 0 offen offset:0 nt
    buffer_load_dwordx4 v[60:63], v3, s[24:27], 0 offen offset:1024 nt
    v_dot2c_f32_bf16_dpp v8, v26, v100 row_newbcast:13 row_mask:0xf bank_mask:0xf
    v_dot2c_f32_bf16_dpp v9, v27, v100 row_newbcast:13 row_mask:0xf bank_mask:0xf
    v_dot2c_f32_bf16_dpp v10, v26, v101 row_newbcast:13 row_mask:0xf bank_mask:0xf
    v_dot2c_f32_bf16_dpp v11, v27, v101 row_newbcast:13 row_mask:0xf bank_mask:0xf
    v_dot2c_f32_bf16_dpp v12, v26, v102 row_newbcast:13 row_mask:0xf bank_mask:0xf
    v_dot2c_f32_bf16_dpp v13, v27, v102 row_newbcast:13 row_mask:0xf bank_mask:0xf
    v_dot2c_f32_bf16_dpp v14, v26, v103 row_newbcast:13 row_mask:0xf bank_mask:0xf
    v_dot2c_f32_bf16_dpp v15, v27, v103 row_newbcast:13 row_mask:0xf bank_mask:0xf
    s_waitcnt vmcnt(5)
    v_dot2_f32_bf16 v16, v40, v4, 0
    v_dot2_f32_bf16 v16, v41, v5, v16
    v_dot2_f32_bf16 v16, v42, v6, v16
    v_dot2_f32_bf16 v16, v43, v7, v16
    s_waitcnt vmcnt(4)
    buffer_load_dwordx4 v[64:67], v3, s[24:27], 0 offen offset:2048 nt
    v_dot2_f32_bf16 v17, v44, v4, 0
    v_dot2_f32_bf16 v17, v45, v5, v17
    v_dot2_f32_bf16 v17, v46, v6, v17
    v_dot2_f32_bf16 v17, v47, v7, v17
    s_waitcnt vmcnt(4)
    buffer_load_dwordx4 v[68:71], v3, s[24:27], 0 offen offset:3072 nt
    v_dot2_f32_bf16 v18, v48, v4, 0
    v_dot2_f32_bf16 v18, v49, v5, v18
    v_dot2_f32_bf16 v18, v50, v6, v18
    v_dot2_f32_bf16 v18, v51, v7, v18
    s_waitcnt vmcnt(4)
    buffer_load_dwordx4 v[72:75], v2, s[28:31], 0 offen offset:0 nt
    v_dot2_f32_bf16 v19, v52, v4, 0
    v_dot2_f32_bf16 v19, v53, v5, v19
    v_dot2_f32_bf16 v19, v54, v6, v19
    v_dot2_f32_bf16 v19, v55, v7, v19
    s_waitcnt vmcnt(4)
    buffer_load_dwordx4 v[76:79], v2, s[28:31], 0 offen offset:1024 nt
    v_dot2_f32_bf16 v20, v56, v4, 0
    v_dot2_f32_bf16 v20, v57, v5, v20
    v_dot2_f32_bf16 v20, v58, v6, v20
    v_dot2_f32_bf16 v20, v59, v7, v20
    s_waitcnt vmcnt(4)
    buffer_load_dwordx4 v[80:83], v2, s[28:31], 0 offen offset:2048 nt
    v_dot2_f32_bf16 v21, v60, v4, 0
    v_dot2_f32_bf16 v21, v61, v5, v21
    v_dot2_f32_bf16 v21, v62, v6, v21
    v_dot2_f32_bf16 v21, v63, v7, v21
    s_waitcnt vmcnt(4)
    buffer_load_dwordx4 v[84:87], v2, s[28:31], 0 offen offset:3072 nt
    v_dot2_f32_bf16 v22, v64, v4, 0
    v_dot2_f32_bf16 v22, v65, v5, v22
    v_dot2_f32_bf16 v22, v66, v6, v22
    v_dot2_f32_bf16 v22, v67, v7, v22
    s_waitcnt vmcnt(4)
    buffer_load_dwordx4 v[88:91], v3, s[28:31], 0 offen offset:0 nt
    buffer_load_dwordx4 v[92:95], v3, s[28:31], 0 offen offset:1024 nt
    v_dot2_f32_bf16 v23, v68, v4, 0
    v_dot2_f32_bf16 v23, v69, v5, v23
    v_dot2_f32_bf16 v23, v70, v6, v23
    v_dot2_f32_bf16 v23, v71, v7, v23
    s_nop 2
    v_add_f32_dpp v16, v16, v16 row_ror:8 row_mask:0xf bank_mask:0x3
    v_add_f32_dpp v17, v17, v17 row_ror:8 row_mask:0xf bank_mask:0x3
    v_add_f32_dpp v18, v18, v18 row_ror:8 row_mask:0xf bank_mask:0x3
    v_add_f32_dpp v19, v19, v19 row_ror:8 row_mask:0xf bank_mask:0x3
    v_add_f32_dpp v16, v20, v20 row_ror:8 row_mask:0xf bank_mask:0xc
    v_add_f32_dpp v17, v21, v21 row_ror:8 row_mask:0xf bank_mask:0xc
    v_add_f32_dpp v18, v22, v22 row_ror:8 row_mask:0xf bank_mask:0xc
    v_add_f32_dpp v19, v23, v23 row_ror:8 row_mask:0xf bank_mask:0xc
    v_add_f32_dpp v16, v16, v16 row_half_mirror row_mask:0xf bank_mask:0x5
    v_add_f32_dpp v17, v17, v17 row_half_mirror row_mask:0xf bank_mask:0x5
    v_add_f32_dpp v16, v18, v18 row_half_mirror row_mask:0xf bank_mask:0xa
    v_add_f32_dpp v17, v19, v19 row_half_mirror row_mask:0xf bank_mask:0xa
    s_nop 0
    v_add_f32_dpp v16, v16, v16 quad_perm:[1,0,3,2] row_mask:0xf bank_mask:0xf
    v_add_f32_dpp v17, v17, v17 quad_perm:[1,0,3,2] row_mask:0xf bank_mask:0xf
    s_nop 0
    v_cndmask_b32 v29, v16, v17, s[76:77]
    s_nop 1
    v_add_f32_dpp v29, v29, v29 quad_perm:[2,3,0,1] row_mask:0xf bank_mask:0xf
    v_mul_f32 v29, s74, v29
    s_nop 1
    v_max_f32_dpp v30, v29, v29 quad_perm:[1,0,3,2] row_mask:0xf bank_mask:0xf
    s_nop 1
    v_max_f32_dpp v30, v30, v30 row_ror:4 row_mask:0xf bank_mask:0xf
    s_nop 1
    v_max_f32_dpp v30, v30, v30 row_ror:8 row_mask:0xf bank_mask:0xf
    v_max_f32 v30, v30, v24
    v_sub_f32 v28, v24, v30
    v_sub_f32 v29, v29, v30
    v_exp_f32 v28, v28
    v_exp_f32 v29, v29
    v_mov_b32 v24, v30
    v_cvt_pk_bf16_f32 v26, v29, 0
    v_cvt_pk_bf16_f32 v27, 0, v29
    v_fma_f32 v25, v25, v28, v29
    v_mul_f32 v8, v28, v8
    v_mul_f32 v9, v28, v9
    v_mul_f32 v10, v28, v10
    v_mul_f32 v11, v28, v11
    v_mul_f32 v12, v28, v12
    v_mul_f32 v13, v28, v13
    v_mul_f32 v14, v28, v14
    v_mul_f32 v15, v28, v15
    s_waitcnt vmcnt(5)
    v_dot2c_f32_bf16_dpp v8, v26, v72 row_newbcast:0 row_mask:0xf bank_mask:0xf
    v_dot2c_f32_bf16_dpp v9, v27, v72 row_newbcast:0 row_mask:0xf bank_mask:0xf
    v_dot2c_f32_bf16_dpp v10, v26, v73 row_newbcast:0 row_mask:0xf bank_mask:0xf
    v_dot2c_f32_bf16_dpp v11, v27, v73 row_newbcast:0 row_mask:0xf bank_mask:0xf
    v_dot2c_f32_bf16_dpp v12, v26, v74 row_newbcast:0 row_mask:0xf bank_mask:0xf
    v_dot2c_f32_bf16_dpp v13, v27, v74 row_newbcast:0 row_mask:0xf bank_mask:0xf
    v_dot2c_f32_bf16_dpp v14, v26, v75 row_newbcast:0 row_mask:0xf bank_mask:0xf
    v_dot2c_f32_bf16_dpp v15, v27, v75 row_newbcast:0 row_mask:0xf bank_mask:0xf
    s_waitcnt vmcnt(4)
    buffer_load_dwordx4 v[96:99], v3, s[28:31], 0 offen offset:2048 nt
    v_dot2c_f32_bf16_dpp v8, v26, v76 row_newbcast:1 row_mask:0xf bank_mask:0xf
    v_dot2c_f32_bf16_dpp v9, v27, v76 row_newbcast:1 row_mask:0xf bank_mask:0xf
    v_dot2c_f32_bf16_dpp v10, v26, v77 row_newbcast:1 row_mask:0xf bank_mask:0xf
    v_dot2c_f32_bf16_dpp v11, v27, v77 row_newbcast:1 row_mask:0xf bank_mask:0xf
    v_dot2c_f32_bf16_dpp v12, v26, v78 row_newbcast:1 row_mask:0xf bank_mask:0xf
    v_dot2c_f32_bf16_dpp v13, v27, v78 row_newbcast:1 row_mask:0xf bank_mask:0xf
    v_dot2c_f32_bf16_dpp v14, v26, v79 row_newbcast:1 row_mask:0xf bank_mask:0xf
    v_dot2c_f32_bf16_dpp v15, v27, v79 row_newbcast:1 row_mask:0xf bank_mask:0xf
    s_waitcnt vmcnt(4)
    buffer_load_dwordx4 v[100:103], v3, s[28:31], 0 offen offset:3072 nt
    v_dot2c_f32_bf16_dpp v8, v26, v80 row_newbcast:4 row_mask:0xf bank_mask:0xf
    v_dot2c_f32_bf16_dpp v9, v27, v80 row_newbcast:4 row_mask:0xf bank_mask:0xf
    v_dot2c_f32_bf16_dpp v10, v26, v81 row_newbcast:4 row_mask:0xf bank_mask:0xf
    v_dot2c_f32_bf16_dpp v11, v27, v81 row_newbcast:4 row_mask:0xf bank_mask:0xf
    v_dot2c_f32_bf16_dpp v12, v26, v82 row_newbcast:4 row_mask:0xf bank_mask:0xf
    v_dot2c_f32_bf16_dpp v13, v27, v82 row_newbcast:4 row_mask:0xf bank_mask:0xf
    v_dot2c_f32_bf16_dpp v14, v26, v83 row_newbcast:4 row_mask:0xf bank_mask:0xf
    v_dot2c_f32_bf16_dpp v15, v27, v83 row_newbcast:4 row_mask:0xf bank_mask:0xf
    s_waitcnt vmcnt(4)
    v_add_u32 v2, 0x8000, v2
    v_add_u32 v3, 0x8000, v3
    buffer_load_dwordx4 v[40:43], v2, s[24:27], 0 offen offset:0 nt
    v_dot2c_f32_bf16_dpp v8, v26, v84 row_newbcast:5 row_mask:0xf bank_mask:0xf
    v_dot2c_f32_bf16_dpp v9, v27, v84 row_newbcast:5 row_mask:0xf bank_mask:0xf
    v_dot2c_f32_bf16_dpp v10, v26, v85 row_newbcast:5 row_mask:0xf bank_mask:0xf
    v_dot2c_f32_bf16_dpp v11, v27, v85 row_newbcast:5 row_mask:0xf bank_mask:0xf
    v_dot2c_f32_bf16_dpp v12, v26, v86 row_newbcast:5 row_mask:0xf bank_mask:0xf
    v_dot2c_f32_bf16_dpp v13, v27, v86 row_newbcast:5 row_mask:0xf bank_mask:0xf
    v_dot2c_f32_bf16_dpp v14, v26, v87 row_newbcast:5 row_mask:0xf bank_mask:0xf
    v_dot2c_f32_bf16_dpp v15, v27, v87 row_newbcast:5 row_mask:0xf bank_mask:0xf
    s_waitcnt vmcnt(4)
    buffer_load_dwordx4 v[44:47], v2, s[24:27], 0 offen offset:1024 nt
    v_dot2c_f32_bf16_dpp v8, v26, v88 row_newbcast:8 row_mask:0xf bank_mask:0xf
    v_dot2c_f32_bf16_dpp v9, v27, v88 row_newbcast:8 row_mask:0xf bank_mask:0xf
    v_dot2c_f32_bf16_dpp v10, v26, v89 row_newbcast:8 row_mask:0xf bank_mask:0xf
    v_dot2c_f32_bf16_dpp v11, v27, v89 row_newbcast:8 row_mask:0xf bank_mask:0xf
    v_dot2c_f32_bf16_dpp v12, v26, v90 row_newbcast:8 row_mask:0xf bank_mask:0xf
    v_dot2c_f32_bf16_dpp v13, v27, v90 row_newbcast:8 row_mask:0xf bank_mask:0xf
    v_dot2c_f32_bf16_dpp v14, v26, v91 row_newbcast:8 row_mask:0xf bank_mask:0xf
    v_dot2c_f32_bf16_dpp v15, v27, v91 row_newbcast:8 row_mask:0xf bank_mask:0xf
    s_waitcnt vmcnt(4)
    buffer_load_dwordx4 v[48:51], v2, s[24:27], 0 offen offset:2048 nt
    v_dot2c_f32_bf16_dpp v8, v26, v92 row_newbcast:9 row_mask:0xf bank_mask:0xf
    v_dot2c_f32_bf16_dpp v9, v27, v92 row_newbcast:9 row_mask:0xf bank_mask:0xf
    v_dot2c_f32_bf16_dpp v10, v26, v93 row_newbcast:9 row_mask:0xf bank_mask:0xf
    v_dot2c_f32_bf16_dpp v11, v27, v93 row_newbcast:9 row_mask:0xf bank_mask:0xf
    v_dot2c_f32_bf16_dpp v12, v26, v94 row_newbcast:9 row_mask:0xf bank_mask:0xf
    v_dot2c_f32_bf16_dpp v13, v27, v94 row_newbcast:9 row_mask:0xf bank_mask:0xf
    v_dot2c_f32_bf16_dpp v14, v26, v95 row_newbcast:9 row_mask:0xf bank_mask:0xf
    v_dot2c_f32_bf16_dpp v15, v27, v95 row_newbcast:9 row_mask:0xf bank_mask:0xf
    s_waitcnt vmcnt(4)
    buffer_load_dwordx4 v[52:55], v2, s[24:27], 0 offen offset:3072 nt
    v_dot2c_f32_bf16_dpp v8, v26, v96 row_newbcast:12 row_mask:0xf bank_mask:0xf
    v_dot2c_f32_bf16_dpp v9, v27, v96 row_newbcast:12 row_mask:0xf bank_mask:0xf
    v_dot2c_f32_bf16_dpp v10, v26, v97 row_newbcast:12 row_mask:0xf bank_mask:0xf
    v_dot2c_f32_bf16_dpp v11, v27, v97 row_newbcast:12 row_mask:0xf bank_mask:0xf
    v_dot2c_f32_bf16_dpp v12, v26, v98 row_newbcast:12 row_mask:0xf bank_mask:0xf
    v_dot2c_f32_bf16_dpp v13, v27, v98 row_newbcast:12 row_mask:0xf bank_mask:0xf
    v_dot2c_f32_bf16_dpp v14, v26, v99 row_newbcast:12 row_mask:0xf bank_mask:0xf
    v_dot2c_f32_bf16_dpp v15, v27, v99 row_newbcast:12 row_mask:0xf bank_mask:0xf
    s_waitcnt vmcnt(4)
    buffer_load_dwordx4 v[56:59], v3, s[24:27], 0 offen offset:0 nt
    buffer_load_dwordx4 v[60:63], v3, s[24:27], 0 offen offset:1024 nt
    v_dot2c_f32_bf16_dpp v8, v26, v100 row_newbcast:13 row_mask:0xf bank_mask:0xf
    v_dot2c_f32_bf16_dpp v9, v27, v100 row_newbcast:13 row_mask:0xf bank_mask:0xf
    v_dot2c_f32_bf16_dpp v10, v26, v101 row_newbcast:13 row_mask:0xf bank_mask:0xf
    v_dot2c_f32_bf16_dpp v11, v27, v101 row_newbcast:13 row_mask:0xf bank_mask:0xf
    v_dot2c_f32_bf16_dpp v12, v26, v102 row_newbcast:13 row_mask:0xf bank_mask:0xf
    v_dot2c_f32_bf16_dpp v13, v27, v102 row_newbcast:13 row_mask:0xf bank_mask:0xf
    v_dot2c_f32_bf16_dpp v14, v26, v103 row_newbcast:13 row_mask:0xf bank_mask:0xf
    v_dot2c_f32_bf16_dpp v15, v27, v103 row_newbcast:13 row_mask:0xf bank_mask:0xf
    s_waitcnt vmcnt(5)
    v_dot2_f32_bf16 v16, v40, v4, 0
    v_dot2_f32_bf16 v16, v41, v5, v16
    v_dot2_f32_bf16 v16, v42, v6, v16
    v_dot2_f32_bf16 v16, v43, v7, v16
    s_waitcnt vmcnt(4)
    buffer_load_dwordx4 v[64:67], v3, s[24:27], 0 offen offset:2048 nt
    v_dot2_f32_bf16 v17, v44, v4, 0
    v_dot2_f32_bf16 v17, v45, v5, v17
    v_dot2_f32_bf16 v17, v46, v6, v17
    v_dot2_f32_bf16 v17, v47, v7, v17
    s_waitcnt vmcnt(4)
    buffer_load_dwordx4 v[68:71], v3, s[24:27], 0 offen offset:3072 nt
    v_dot2_f32_bf16 v18, v48, v4, 0
    v_dot2_f32_bf16 v18, v49, v5, v18
    v_dot2_f32_bf16 v18, v50, v6, v18
    v_dot2_f32_bf16 v18, v51, v7, v18
    s_waitcnt vmcnt(4)
    buffer_load_dwordx4 v[72:75], v2, s[28:31], 0 offen offset:0 nt
    v_dot2_f32_bf16 v19, v52, v4, 0
    v_dot2_f32_bf16 v19, v53, v5, v19
    v_dot2_f32_bf16 v19, v54, v6, v19
    v_dot2_f32_bf16 v19, v55, v7, v19
    s_waitcnt vmcnt(4)
    buffer_load_dwordx4 v[76:79], v2, s[28:31], 0 offen offset:1024 nt
    v_dot2_f32_bf16 v20, v56, v4, 0
    v_dot2_f32_bf16 v20, v57, v5, v20
    v_dot2_f32_bf16 v20, v58, v6, v20
    v_dot2_f32_bf16 v20, v59, v7, v20
    s_waitcnt vmcnt(4)
    buffer_load_dwordx4 v[80:83], v2, s[28:31], 0 offen offset:2048 nt
    v_dot2_f32_bf16 v21, v60, v4, 0
    v_dot2_f32_bf16 v21, v61, v5, v21
    v_dot2_f32_bf16 v21, v62, v6, v21
    v_dot2_f32_bf16 v21, v63, v7, v21
    s_waitcnt vmcnt(4)
    buffer_load_dwordx4 v[84:87], v2, s[28:31], 0 offen offset:3072 nt
    v_dot2_f32_bf16 v22, v64, v4, 0
    v_dot2_f32_bf16 v22, v65, v5, v22
    v_dot2_f32_bf16 v22, v66, v6, v22
    v_dot2_f32_bf16 v22, v67, v7, v22
    s_waitcnt vmcnt(4)
    buffer_load_dwordx4 v[88:91], v3, s[28:31], 0 offen offset:0 nt
    buffer_load_dwordx4 v[92:95], v3, s[28:31], 0 offen offset:1024 nt
    v_dot2_f32_bf16 v23, v68, v4, 0
    v_dot2_f32_bf16 v23, v69, v5, v23
    v_dot2_f32_bf16 v23, v70, v6, v23
    v_dot2_f32_bf16 v23, v71, v7, v23
    s_nop 2
    v_add_f32_dpp v16, v16, v16 row_ror:8 row_mask:0xf bank_mask:0x3
    v_add_f32_dpp v17, v17, v17 row_ror:8 row_mask:0xf bank_mask:0x3
    v_add_f32_dpp v18, v18, v18 row_ror:8 row_mask:0xf bank_mask:0x3
    v_add_f32_dpp v19, v19, v19 row_ror:8 row_mask:0xf bank_mask:0x3
    v_add_f32_dpp v16, v20, v20 row_ror:8 row_mask:0xf bank_mask:0xc
    v_add_f32_dpp v17, v21, v21 row_ror:8 row_mask:0xf bank_mask:0xc
    v_add_f32_dpp v18, v22, v22 row_ror:8 row_mask:0xf bank_mask:0xc
    v_add_f32_dpp v19, v23, v23 row_ror:8 row_mask:0xf bank_mask:0xc
    v_add_f32_dpp v16, v16, v16 row_half_mirror row_mask:0xf bank_mask:0x5
    v_add_f32_dpp v17, v17, v17 row_half_mirror row_mask:0xf bank_mask:0x5
    v_add_f32_dpp v16, v18, v18 row_half_mirror row_mask:0xf bank_mask:0xa
    v_add_f32_dpp v17, v19, v19 row_half_mirror row_mask:0xf bank_mask:0xa
    s_nop 0
    v_add_f32_dpp v16, v16, v16 quad_perm:[1,0,3,2] row_mask:0xf bank_mask:0xf
    v_add_f32_dpp v17, v17, v17 quad_perm:[1,0,3,2] row_mask:0xf bank_mask:0xf
    s_nop 0
    v_cndmask_b32 v29, v16, v17, s[76:77]
    s_nop 1
    v_add_f32_dpp v29, v29, v29 quad_perm:[2,3,0,1] row_mask:0xf bank_mask:0xf
    v_mul_f32 v29, s74, v29
    s_nop 1
    v_max_f32_dpp v30, v29, v29 quad_perm:[1,0,3,2] row_mask:0xf bank_mask:0xf
    s_nop 1
    v_max_f32_dpp v30, v30, v30 row_ror:4 row_mask:0xf bank_mask:0xf
    s_nop 1
    v_max_f32_dpp v30, v30, v30 row_ror:8 row_mask:0xf bank_mask:0xf
    v_max_f32 v30, v30, v24
    v_sub_f32 v28, v24, v30
    v_sub_f32 v29, v29, v30
    v_exp_f32 v28, v28
    v_exp_f32 v29, v29
    v_mov_b32 v24, v30
    v_cvt_pk_bf16_f32 v26, v29, 0
    v_cvt_pk_bf16_f32 v27, 0, v29
    v_fma_f32 v25, v25, v28, v29
    v_mul_f32 v8, v28, v8
    v_mul_f32 v9, v28, v9
    v_mul_f32 v10, v28, v10
    v_mul_f32 v11, v28, v11
    v_mul_f32 v12, v28, v12
    v_mul_f32 v13, v28, v13
    v_mul_f32 v14, v28, v14
    v_mul_f32 v15, v28, v15
    s_waitcnt vmcnt(5)
    v_dot2c_f32_bf16_dpp v8, v26, v72 row_newbcast:0 row_mask:0xf bank_mask:0xf
    v_dot2c_f32_bf16_dpp v9, v27, v72 row_newbcast:0 row_mask:0xf bank_mask:0xf
    v_dot2c_f32_bf16_dpp v10, v26, v73 row_newbcast:0 row_mask:0xf bank_mask:0xf
    v_dot2c_f32_bf16_dpp v11, v27, v73 row_newbcast:0 row_mask:0xf bank_mask:0xf
    v_dot2c_f32_bf16_dpp v12, v26, v74 row_newbcast:0 row_mask:0xf bank_mask:0xf
    v_dot2c_f32_bf16_dpp v13, v27, v74 row_newbcast:0 row_mask:0xf bank_mask:0xf
    v_dot2c_f32_bf16_dpp v14, v26, v75 row_newbcast:0 row_mask:0xf bank_mask:0xf
    v_dot2c_f32_bf16_dpp v15, v27, v75 row_newbcast:0 row_mask:0xf bank_mask:0xf
    s_waitcnt vmcnt(4)
    buffer_load_dwordx4 v[96:99], v3, s[28:31], 0 offen offset:2048 nt
    v_dot2c_f32_bf16_dpp v8, v26, v76 row_newbcast:1 row_mask:0xf bank_mask:0xf
    v_dot2c_f32_bf16_dpp v9, v27, v76 row_newbcast:1 row_mask:0xf bank_mask:0xf
    v_dot2c_f32_bf16_dpp v10, v26, v77 row_newbcast:1 row_mask:0xf bank_mask:0xf
    v_dot2c_f32_bf16_dpp v11, v27, v77 row_newbcast:1 row_mask:0xf bank_mask:0xf
    v_dot2c_f32_bf16_dpp v12, v26, v78 row_newbcast:1 row_mask:0xf bank_mask:0xf
    v_dot2c_f32_bf16_dpp v13, v27, v78 row_newbcast:1 row_mask:0xf bank_mask:0xf
    v_dot2c_f32_bf16_dpp v14, v26, v79 row_newbcast:1 row_mask:0xf bank_mask:0xf
    v_dot2c_f32_bf16_dpp v15, v27, v79 row_newbcast:1 row_mask:0xf bank_mask:0xf
    s_waitcnt vmcnt(4)
    buffer_load_dwordx4 v[100:103], v3, s[28:31], 0 offen offset:3072 nt
    v_dot2c_f32_bf16_dpp v8, v26, v80 row_newbcast:4 row_mask:0xf bank_mask:0xf
    v_dot2c_f32_bf16_dpp v9, v27, v80 row_newbcast:4 row_mask:0xf bank_mask:0xf
    v_dot2c_f32_bf16_dpp v10, v26, v81 row_newbcast:4 row_mask:0xf bank_mask:0xf
    v_dot2c_f32_bf16_dpp v11, v27, v81 row_newbcast:4 row_mask:0xf bank_mask:0xf
    v_dot2c_f32_bf16_dpp v12, v26, v82 row_newbcast:4 row_mask:0xf bank_mask:0xf
    v_dot2c_f32_bf16_dpp v13, v27, v82 row_newbcast:4 row_mask:0xf bank_mask:0xf
    v_dot2c_f32_bf16_dpp v14, v26, v83 row_newbcast:4 row_mask:0xf bank_mask:0xf
    v_dot2c_f32_bf16_dpp v15, v27, v83 row_newbcast:4 row_mask:0xf bank_mask:0xf
    s_waitcnt vmcnt(4)
    v_add_u32 v2, 0x8000, v2
    v_add_u32 v3, 0x8000, v3
    buffer_load_dwordx4 v[40:43], v2, s[24:27], 0 offen offset:0 nt
    v_dot2c_f32_bf16_dpp v8, v26, v84 row_newbcast:5 row_mask:0xf bank_mask:0xf
    v_dot2c_f32_bf16_dpp v9, v27, v84 row_newbcast:5 row_mask:0xf bank_mask:0xf
    v_dot2c_f32_bf16_dpp v10, v26, v85 row_newbcast:5 row_mask:0xf bank_mask:0xf
    v_dot2c_f32_bf16_dpp v11, v27, v85 row_newbcast:5 row_mask:0xf bank_mask:0xf
    v_dot2c_f32_bf16_dpp v12, v26, v86 row_newbcast:5 row_mask:0xf bank_mask:0xf
    v_dot2c_f32_bf16_dpp v13, v27, v86 row_newbcast:5 row_mask:0xf bank_mask:0xf
    v_dot2c_f32_bf16_dpp v14, v26, v87 row_newbcast:5 row_mask:0xf bank_mask:0xf
    v_dot2c_f32_bf16_dpp v15, v27, v87 row_newbcast:5 row_mask:0xf bank_mask:0xf
    s_waitcnt vmcnt(4)
    buffer_load_dwordx4 v[44:47], v2, s[24:27], 0 offen offset:1024 nt
    v_dot2c_f32_bf16_dpp v8, v26, v88 row_newbcast:8 row_mask:0xf bank_mask:0xf
    v_dot2c_f32_bf16_dpp v9, v27, v88 row_newbcast:8 row_mask:0xf bank_mask:0xf
    v_dot2c_f32_bf16_dpp v10, v26, v89 row_newbcast:8 row_mask:0xf bank_mask:0xf
    v_dot2c_f32_bf16_dpp v11, v27, v89 row_newbcast:8 row_mask:0xf bank_mask:0xf
    v_dot2c_f32_bf16_dpp v12, v26, v90 row_newbcast:8 row_mask:0xf bank_mask:0xf
    v_dot2c_f32_bf16_dpp v13, v27, v90 row_newbcast:8 row_mask:0xf bank_mask:0xf
    v_dot2c_f32_bf16_dpp v14, v26, v91 row_newbcast:8 row_mask:0xf bank_mask:0xf
    v_dot2c_f32_bf16_dpp v15, v27, v91 row_newbcast:8 row_mask:0xf bank_mask:0xf
    s_waitcnt vmcnt(4)
    buffer_load_dwordx4 v[48:51], v2, s[24:27], 0 offen offset:2048 nt
    v_dot2c_f32_bf16_dpp v8, v26, v92 row_newbcast:9 row_mask:0xf bank_mask:0xf
    v_dot2c_f32_bf16_dpp v9, v27, v92 row_newbcast:9 row_mask:0xf bank_mask:0xf
    v_dot2c_f32_bf16_dpp v10, v26, v93 row_newbcast:9 row_mask:0xf bank_mask:0xf
    v_dot2c_f32_bf16_dpp v11, v27, v93 row_newbcast:9 row_mask:0xf bank_mask:0xf
    v_dot2c_f32_bf16_dpp v12, v26, v94 row_newbcast:9 row_mask:0xf bank_mask:0xf
    v_dot2c_f32_bf16_dpp v13, v27, v94 row_newbcast:9 row_mask:0xf bank_mask:0xf
    v_dot2c_f32_bf16_dpp v14, v26, v95 row_newbcast:9 row_mask:0xf bank_mask:0xf
    v_dot2c_f32_bf16_dpp v15, v27, v95 row_newbcast:9 row_mask:0xf bank_mask:0xf
    s_waitcnt vmcnt(4)
    buffer_load_dwordx4 v[52:55], v2, s[24:27], 0 offen offset:3072 nt
    v_dot2c_f32_bf16_dpp v8, v26, v96 row_newbcast:12 row_mask:0xf bank_mask:0xf
    v_dot2c_f32_bf16_dpp v9, v27, v96 row_newbcast:12 row_mask:0xf bank_mask:0xf
    v_dot2c_f32_bf16_dpp v10, v26, v97 row_newbcast:12 row_mask:0xf bank_mask:0xf
    v_dot2c_f32_bf16_dpp v11, v27, v97 row_newbcast:12 row_mask:0xf bank_mask:0xf
    v_dot2c_f32_bf16_dpp v12, v26, v98 row_newbcast:12 row_mask:0xf bank_mask:0xf
    v_dot2c_f32_bf16_dpp v13, v27, v98 row_newbcast:12 row_mask:0xf bank_mask:0xf
    v_dot2c_f32_bf16_dpp v14, v26, v99 row_newbcast:12 row_mask:0xf bank_mask:0xf
    v_dot2c_f32_bf16_dpp v15, v27, v99 row_newbcast:12 row_mask:0xf bank_mask:0xf
    s_waitcnt vmcnt(4)
    buffer_load_dwordx4 v[56:59], v3, s[24:27], 0 offen offset:0 nt
    buffer_load_dwordx4 v[60:63], v3, s[24:27], 0 offen offset:1024 nt
    v_dot2c_f32_bf16_dpp v8, v26, v100 row_newbcast:13 row_mask:0xf bank_mask:0xf
    v_dot2c_f32_bf16_dpp v9, v27, v100 row_newbcast:13 row_mask:0xf bank_mask:0xf
    v_dot2c_f32_bf16_dpp v10, v26, v101 row_newbcast:13 row_mask:0xf bank_mask:0xf
    v_dot2c_f32_bf16_dpp v11, v27, v101 row_newbcast:13 row_mask:0xf bank_mask:0xf
    v_dot2c_f32_bf16_dpp v12, v26, v102 row_newbcast:13 row_mask:0xf bank_mask:0xf
    v_dot2c_f32_bf16_dpp v13, v27, v102 row_newbcast:13 row_mask:0xf bank_mask:0xf
    v_dot2c_f32_bf16_dpp v14, v26, v103 row_newbcast:13 row_mask:0xf bank_mask:0xf
    v_dot2c_f32_bf16_dpp v15, v27, v103 row_newbcast:13 row_mask:0xf bank_mask:0xf
    s_waitcnt vmcnt(5)
    v_dot2_f32_bf16 v16, v40, v4, 0
    v_dot2_f32_bf16 v16, v41, v5, v16
    v_dot2_f32_bf16 v16, v42, v6, v16
    v_dot2_f32_bf16 v16, v43, v7, v16
    s_waitcnt vmcnt(4)
    buffer_load_dwordx4 v[64:67], v3, s[24:27], 0 offen offset:2048 nt
    v_dot2_f32_bf16 v17, v44, v4, 0
    v_dot2_f32_bf16 v17, v45, v5, v17
    v_dot2_f32_bf16 v17, v46, v6, v17
    v_dot2_f32_bf16 v17, v47, v7, v17
    s_waitcnt vmcnt(4)
    buffer_load_dwordx4 v[68:71], v3, s[24:27], 0 offen offset:3072 nt
    v_dot2_f32_bf16 v18, v48, v4, 0
    v_dot2_f32_bf16 v18, v49, v5, v18
    v_dot2_f32_bf16 v18, v50, v6, v18
    v_dot2_f32_bf16 v18, v51, v7, v18
    s_waitcnt vmcnt(4)
    buffer_load_dwordx4 v[72:75], v2, s[28:31], 0 offen offset:0 nt
    v_dot2_f32_bf16 v19, v52, v4, 0
    v_dot2_f32_bf16 v19, v53, v5, v19
    v_dot2_f32_bf16 v19, v54, v6, v19
    v_dot2_f32_bf16 v19, v55, v7, v19
    s_waitcnt vmcnt(4)
    buffer_load_dwordx4 v[76:79], v2, s[28:31], 0 offen offset:1024 nt
    v_dot2_f32_bf16 v20, v56, v4, 0
    v_dot2_f32_bf16 v20, v57, v5, v20
    v_dot2_f32_bf16 v20, v58, v6, v20
    v_dot2_f32_bf16 v20, v59, v7, v20
    s_waitcnt vmcnt(4)
    buffer_load_dwordx4 v[80:83], v2, s[28:31], 0 offen offset:2048 nt
    v_dot2_f32_bf16 v21, v60, v4, 0
    v_dot2_f32_bf16 v21, v61, v5, v21
    v_dot2_f32_bf16 v21, v62, v6, v21
    v_dot2_f32_bf16 v21, v63, v7, v21
    s_waitcnt vmcnt(4)
    buffer_load_dwordx4 v[84:87], v2, s[28:31], 0 offen offset:3072 nt
    v_dot2_f32_bf16 v22, v64, v4, 0
    v_dot2_f32_bf16 v22, v65, v5, v22
    v_dot2_f32_bf16 v22, v66, v6, v22
    v_dot2_f32_bf16 v22, v67, v7, v22
    s_waitcnt vmcnt(4)
    buffer_load_dwordx4 v[88:91], v3, s[28:31], 0 offen offset:0 nt
    buffer_load_dwordx4 v[92:95], v3, s[28:31], 0 offen offset:1024 nt
    v_dot2_f32_bf16 v23, v68, v4, 0
    v_dot2_f32_bf16 v23, v69, v5, v23
    v_dot2_f32_bf16 v23, v70, v6, v23
    v_dot2_f32_bf16 v23, v71, v7, v23
    s_nop 2
    v_add_f32_dpp v16, v16, v16 row_ror:8 row_mask:0xf bank_mask:0x3
    v_add_f32_dpp v17, v17, v17 row_ror:8 row_mask:0xf bank_mask:0x3
    v_add_f32_dpp v18, v18, v18 row_ror:8 row_mask:0xf bank_mask:0x3
    v_add_f32_dpp v19, v19, v19 row_ror:8 row_mask:0xf bank_mask:0x3
    v_add_f32_dpp v16, v20, v20 row_ror:8 row_mask:0xf bank_mask:0xc
    v_add_f32_dpp v17, v21, v21 row_ror:8 row_mask:0xf bank_mask:0xc
    v_add_f32_dpp v18, v22, v22 row_ror:8 row_mask:0xf bank_mask:0xc
    v_add_f32_dpp v19, v23, v23 row_ror:8 row_mask:0xf bank_mask:0xc
    v_add_f32_dpp v16, v16, v16 row_half_mirror row_mask:0xf bank_mask:0x5
    v_add_f32_dpp v17, v17, v17 row_half_mirror row_mask:0xf bank_mask:0x5
    v_add_f32_dpp v16, v18, v18 row_half_mirror row_mask:0xf bank_mask:0xa
    v_add_f32_dpp v17, v19, v19 row_half_mirror row_mask:0xf bank_mask:0xa
    s_nop 0
    v_add_f32_dpp v16, v16, v16 quad_perm:[1,0,3,2] row_mask:0xf bank_mask:0xf
    v_add_f32_dpp v17, v17, v17 quad_perm:[1,0,3,2] row_mask:0xf bank_mask:0xf
    s_nop 0
    v_cndmask_b32 v29, v16, v17, s[76:77]
    s_nop 1
    v_add_f32_dpp v29, v29, v29 quad_perm:[2,3,0,1] row_mask:0xf bank_mask:0xf
    v_mul_f32 v29, s74, v29
    s_nop 1
    v_max_f32_dpp v30, v29, v29 quad_perm:[1,0,3,2] row_mask:0xf bank_mask:0xf
    s_nop 1
    v_max_f32_dpp v30, v30, v30 row_ror:4 row_mask:0xf bank_mask:0xf
    s_nop 1
    v_max_f32_dpp v30, v30, v30 row_ror:8 row_mask:0xf bank_mask:0xf
    v_max_f32 v30, v30, v24
    v_sub_f32 v28, v24, v30
    v_sub_f32 v29, v29, v30
    v_exp_f32 v28, v28
    v_exp_f32 v29, v29
    v_mov_b32 v24, v30
    v_cvt_pk_bf16_f32 v26, v29, 0
    v_cvt_pk_bf16_f32 v27, 0, v29
    v_fma_f32 v25, v25, v28, v29
    v_mul_f32 v8, v28, v8
    v_mul_f32 v9, v28, v9
    v_mul_f32 v10, v28, v10
    v_mul_f32 v11, v28, v11
    v_mul_f32 v12, v28, v12
    v_mul_f32 v13, v28, v13
    v_mul_f32 v14, v28, v14
    v_mul_f32 v15, v28, v15
    s_waitcnt vmcnt(5)
    v_dot2c_f32_bf16_dpp v8, v26, v72 row_newbcast:0 row_mask:0xf bank_mask:0xf
    v_dot2c_f32_bf16_dpp v9, v27, v72 row_newbcast:0 row_mask:0xf bank_mask:0xf
    v_dot2c_f32_bf16_dpp v10, v26, v73 row_newbcast:0 row_mask:0xf bank_mask:0xf
    v_dot2c_f32_bf16_dpp v11, v27, v73 row_newbcast:0 row_mask:0xf bank_mask:0xf
    v_dot2c_f32_bf16_dpp v12, v26, v74 row_newbcast:0 row_mask:0xf bank_mask:0xf
    v_dot2c_f32_bf16_dpp v13, v27, v74 row_newbcast:0 row_mask:0xf bank_mask:0xf
    v_dot2c_f32_bf16_dpp v14, v26, v75 row_newbcast:0 row_mask:0xf bank_mask:0xf
    v_dot2c_f32_bf16_dpp v15, v27, v75 row_newbcast:0 row_mask:0xf bank_mask:0xf
    s_waitcnt vmcnt(4)
    buffer_load_dwordx4 v[96:99], v3, s[28:31], 0 offen offset:2048 nt
    v_dot2c_f32_bf16_dpp v8, v26, v76 row_newbcast:1 row_mask:0xf bank_mask:0xf
    v_dot2c_f32_bf16_dpp v9, v27, v76 row_newbcast:1 row_mask:0xf bank_mask:0xf
    v_dot2c_f32_bf16_dpp v10, v26, v77 row_newbcast:1 row_mask:0xf bank_mask:0xf
    v_dot2c_f32_bf16_dpp v11, v27, v77 row_newbcast:1 row_mask:0xf bank_mask:0xf
    v_dot2c_f32_bf16_dpp v12, v26, v78 row_newbcast:1 row_mask:0xf bank_mask:0xf
    v_dot2c_f32_bf16_dpp v13, v27, v78 row_newbcast:1 row_mask:0xf bank_mask:0xf
    v_dot2c_f32_bf16_dpp v14, v26, v79 row_newbcast:1 row_mask:0xf bank_mask:0xf
    v_dot2c_f32_bf16_dpp v15, v27, v79 row_newbcast:1 row_mask:0xf bank_mask:0xf
    s_waitcnt vmcnt(4)
    buffer_load_dwordx4 v[100:103], v3, s[28:31], 0 offen offset:3072 nt
    v_dot2c_f32_bf16_dpp v8, v26, v80 row_newbcast:4 row_mask:0xf bank_mask:0xf
    v_dot2c_f32_bf16_dpp v9, v27, v80 row_newbcast:4 row_mask:0xf bank_mask:0xf
    v_dot2c_f32_bf16_dpp v10, v26, v81 row_newbcast:4 row_mask:0xf bank_mask:0xf
    v_dot2c_f32_bf16_dpp v11, v27, v81 row_newbcast:4 row_mask:0xf bank_mask:0xf
    v_dot2c_f32_bf16_dpp v12, v26, v82 row_newbcast:4 row_mask:0xf bank_mask:0xf
    v_dot2c_f32_bf16_dpp v13, v27, v82 row_newbcast:4 row_mask:0xf bank_mask:0xf
    v_dot2c_f32_bf16_dpp v14, v26, v83 row_newbcast:4 row_mask:0xf bank_mask:0xf
    v_dot2c_f32_bf16_dpp v15, v27, v83 row_newbcast:4 row_mask:0xf bank_mask:0xf
    s_waitcnt vmcnt(4)
    v_add_u32 v2, 0x8000, v2
    v_add_u32 v3, 0x8000, v3
    buffer_load_dwordx4 v[40:43], v2, s[24:27], 0 offen offset:0 nt
    v_dot2c_f32_bf16_dpp v8, v26, v84 row_newbcast:5 row_mask:0xf bank_mask:0xf
    v_dot2c_f32_bf16_dpp v9, v27, v84 row_newbcast:5 row_mask:0xf bank_mask:0xf
    v_dot2c_f32_bf16_dpp v10, v26, v85 row_newbcast:5 row_mask:0xf bank_mask:0xf
    v_dot2c_f32_bf16_dpp v11, v27, v85 row_newbcast:5 row_mask:0xf bank_mask:0xf
    v_dot2c_f32_bf16_dpp v12, v26, v86 row_newbcast:5 row_mask:0xf bank_mask:0xf
    v_dot2c_f32_bf16_dpp v13, v27, v86 row_newbcast:5 row_mask:0xf bank_mask:0xf
    v_dot2c_f32_bf16_dpp v14, v26, v87 row_newbcast:5 row_mask:0xf bank_mask:0xf
    v_dot2c_f32_bf16_dpp v15, v27, v87 row_newbcast:5 row_mask:0xf bank_mask:0xf
    s_waitcnt vmcnt(4)
    buffer_load_dwordx4 v[44:47], v2, s[24:27], 0 offen offset:1024 nt
    v_dot2c_f32_bf16_dpp v8, v26, v88 row_newbcast:8 row_mask:0xf bank_mask:0xf
    v_dot2c_f32_bf16_dpp v9, v27, v88 row_newbcast:8 row_mask:0xf bank_mask:0xf
    v_dot2c_f32_bf16_dpp v10, v26, v89 row_newbcast:8 row_mask:0xf bank_mask:0xf
    v_dot2c_f32_bf16_dpp v11, v27, v89 row_newbcast:8 row_mask:0xf bank_mask:0xf
    v_dot2c_f32_bf16_dpp v12, v26, v90 row_newbcast:8 row_mask:0xf bank_mask:0xf
    v_dot2c_f32_bf16_dpp v13, v27, v90 row_newbcast:8 row_mask:0xf bank_mask:0xf
    v_dot2c_f32_bf16_dpp v14, v26, v91 row_newbcast:8 row_mask:0xf bank_mask:0xf
    v_dot2c_f32_bf16_dpp v15, v27, v91 row_newbcast:8 row_mask:0xf bank_mask:0xf
    s_waitcnt vmcnt(4)
    buffer_load_dwordx4 v[48:51], v2, s[24:27], 0 offen offset:2048 nt
    v_dot2c_f32_bf16_dpp v8, v26, v92 row_newbcast:9 row_mask:0xf bank_mask:0xf
    v_dot2c_f32_bf16_dpp v9, v27, v92 row_newbcast:9 row_mask:0xf bank_mask:0xf
    v_dot2c_f32_bf16_dpp v10, v26, v93 row_newbcast:9 row_mask:0xf bank_mask:0xf
    v_dot2c_f32_bf16_dpp v11, v27, v93 row_newbcast:9 row_mask:0xf bank_mask:0xf
    v_dot2c_f32_bf16_dpp v12, v26, v94 row_newbcast:9 row_mask:0xf bank_mask:0xf
    v_dot2c_f32_bf16_dpp v13, v27, v94 row_newbcast:9 row_mask:0xf bank_mask:0xf
    v_dot2c_f32_bf16_dpp v14, v26, v95 row_newbcast:9 row_mask:0xf bank_mask:0xf
    v_dot2c_f32_bf16_dpp v15, v27, v95 row_newbcast:9 row_mask:0xf bank_mask:0xf
    s_waitcnt vmcnt(4)
    buffer_load_dwordx4 v[52:55], v2, s[24:27], 0 offen offset:3072 nt
    v_dot2c_f32_bf16_dpp v8, v26, v96 row_newbcast:12 row_mask:0xf bank_mask:0xf
    v_dot2c_f32_bf16_dpp v9, v27, v96 row_newbcast:12 row_mask:0xf bank_mask:0xf
    v_dot2c_f32_bf16_dpp v10, v26, v97 row_newbcast:12 row_mask:0xf bank_mask:0xf
    v_dot2c_f32_bf16_dpp v11, v27, v97 row_newbcast:12 row_mask:0xf bank_mask:0xf
    v_dot2c_f32_bf16_dpp v12, v26, v98 row_newbcast:12 row_mask:0xf bank_mask:0xf
    v_dot2c_f32_bf16_dpp v13, v27, v98 row_newbcast:12 row_mask:0xf bank_mask:0xf
    v_dot2c_f32_bf16_dpp v14, v26, v99 row_newbcast:12 row_mask:0xf bank_mask:0xf
    v_dot2c_f32_bf16_dpp v15, v27, v99 row_newbcast:12 row_mask:0xf bank_mask:0xf
    s_waitcnt vmcnt(4)
    buffer_load_dwordx4 v[56:59], v3, s[24:27], 0 offen offset:0 nt
    buffer_load_dwordx4 v[60:63], v3, s[24:27], 0 offen offset:1024 nt
    v_dot2c_f32_bf16_dpp v8, v26, v100 row_newbcast:13 row_mask:0xf bank_mask:0xf
    v_dot2c_f32_bf16_dpp v9, v27, v100 row_newbcast:13 row_mask:0xf bank_mask:0xf
    v_dot2c_f32_bf16_dpp v10, v26, v101 row_newbcast:13 row_mask:0xf bank_mask:0xf
    v_dot2c_f32_bf16_dpp v11, v27, v101 row_newbcast:13 row_mask:0xf bank_mask:0xf
    v_dot2c_f32_bf16_dpp v12, v26, v102 row_newbcast:13 row_mask:0xf bank_mask:0xf
    v_dot2c_f32_bf16_dpp v13, v27, v102 row_newbcast:13 row_mask:0xf bank_mask:0xf
    v_dot2c_f32_bf16_dpp v14, v26, v103 row_newbcast:13 row_mask:0xf bank_mask:0xf
    v_dot2c_f32_bf16_dpp v15, v27, v103 row_newbcast:13 row_mask:0xf bank_mask:0xf
    s_waitcnt vmcnt(5)
    buffer_load_dwordx4 v[64:67], v3, s[24:27], 0 offen offset:2048 nt
    buffer_load_dwordx4 v[68:71], v3, s[24:27], 0 offen offset:3072 nt
    v_dot2_f32_bf16 v16, v40, v4, 0
    v_dot2_f32_bf16 v16, v41, v5, v16
    v_dot2_f32_bf16 v16, v42, v6, v16
    v_dot2_f32_bf16 v16, v43, v7, v16
    s_waitcnt vmcnt(6)
    buffer_load_dwordx4 v[72:75], v2, s[28:31], 0 offen offset:0 nt
    v_dot2_f32_bf16 v17, v44, v4, 0
    v_dot2_f32_bf16 v17, v45, v5, v17
    v_dot2_f32_bf16 v17, v46, v6, v17
    v_dot2_f32_bf16 v17, v47, v7, v17
    s_waitcnt vmcnt(6)
    buffer_load_dwordx4 v[76:79], v2, s[28:31], 0 offen offset:1024 nt
    v_dot2_f32_bf16 v18, v48, v4, 0
    v_dot2_f32_bf16 v18, v49, v5, v18
    v_dot2_f32_bf16 v18, v50, v6, v18
    v_dot2_f32_bf16 v18, v51, v7, v18
    s_waitcnt vmcnt(6)
    buffer_load_dwordx4 v[80:83], v2, s[28:31], 0 offen offset:2048 nt
    v_dot2_f32_bf16 v19, v52, v4, 0
    v_dot2_f32_bf16 v19, v53, v5, v19
    v_dot2_f32_bf16 v19, v54, v6, v19
    v_dot2_f32_bf16 v19, v55, v7, v19
    s_waitcnt vmcnt(6)
    buffer_load_dwordx4 v[84:87], v2, s[28:31], 0 offen offset:3072 nt
    v_dot2_f32_bf16 v20, v56, v4, 0
    v_dot2_f32_bf16 v20, v57, v5, v20
    v_dot2_f32_bf16 v20, v58, v6, v20
    v_dot2_f32_bf16 v20, v59, v7, v20
    s_waitcnt vmcnt(6)
    buffer_load_dwordx4 v[88:91], v3, s[28:31], 0 offen offset:0 nt
    v_dot2_f32_bf16 v21, v60, v4, 0
    v_dot2_f32_bf16 v21, v61, v5, v21
    v_dot2_f32_bf16 v21, v62, v6, v21
    v_dot2_f32_bf16 v21, v63, v7, v21
    s_waitcnt vmcnt(6)
    buffer_load_dwordx4 v[92:95], v3, s[28:31], 0 offen offset:1024 nt
    v_dot2_f32_bf16 v22, v64, v4, 0
    v_dot2_f32_bf16 v22, v65, v5, v22
    v_dot2_f32_bf16 v22, v66, v6, v22
    v_dot2_f32_bf16 v22, v67, v7, v22
    s_waitcnt vmcnt(6)
    buffer_load_dwordx4 v[96:99], v3, s[28:31], 0 offen offset:2048 nt
    v_dot2_f32_bf16 v23, v68, v4, 0
    v_dot2_f32_bf16 v23, v69, v5, v23
    v_dot2_f32_bf16 v23, v70, v6, v23
    v_dot2_f32_bf16 v23, v71, v7, v23
    s_nop 2
    v_add_f32_dpp v16, v16, v16 row_ror:8 row_mask:0xf bank_mask:0x3
    v_add_f32_dpp v17, v17, v17 row_ror:8 row_mask:0xf bank_mask:0x3
    v_add_f32_dpp v18, v18, v18 row_ror:8 row_mask:0xf bank_mask:0x3
    v_add_f32_dpp v19, v19, v19 row_ror:8 row_mask:0xf bank_mask:0x3
    v_add_f32_dpp v16, v20, v20 row_ror:8 row_mask:0xf bank_mask:0xc
    v_add_f32_dpp v17, v21, v21 row_ror:8 row_mask:0xf bank_mask:0xc
    v_add_f32_dpp v18, v22, v22 row_ror:8 row_mask:0xf bank_mask:0xc
    v_add_f32_dpp v19, v23, v23 row_ror:8 row_mask:0xf bank_mask:0xc
    v_add_f32_dpp v16, v16, v16 row_half_mirror row_mask:0xf bank_mask:0x5
    v_add_f32_dpp v17, v17, v17 row_half_mirror row_mask:0xf bank_mask:0x5
    v_add_f32_dpp v16, v18, v18 row_half_mirror row_mask:0xf bank_mask:0xa
    v_add_f32_dpp v17, v19, v19 row_half_mirror row_mask:0xf bank_mask:0xa
    s_nop 0
    v_add_f32_dpp v16, v16, v16 quad_perm:[1,0,3,2] row_mask:0xf bank_mask:0xf
    v_add_f32_dpp v17, v17, v17 quad_perm:[1,0,3,2] row_mask:0xf bank_mask:0xf
    s_nop 0
    v_cndmask_b32 v29, v16, v17, s[76:77]
    s_nop 1
    v_add_f32_dpp v29, v29, v29 quad_perm:[2,3,0,1] row_mask:0xf bank_mask:0xf
    v_mul_f32 v29, s74, v29
    s_nop 1
    v_max_f32_dpp v30, v29, v29 quad_perm:[1,0,3,2] row_mask:0xf bank_mask:0xf
    s_nop 1
    v_max_f32_dpp v30, v30, v30 row_ror:4 row_mask:0xf bank_mask:0xf
    s_nop 1
    v_max_f32_dpp v30, v30, v30 row_ror:8 row_mask:0xf bank_mask:0xf
    v_max_f32 v30, v30, v24
    v_sub_f32 v28, v24, v30
    v_sub_f32 v29, v29, v30
    v_exp_f32 v28, v28
    v_exp_f32 v29, v29
    v_mov_b32 v24, v30
    v_cvt_pk_bf16_f32 v26, v29, 0
    v_cvt_pk_bf16_f32 v27, 0, v29
    v_fma_f32 v25, v25, v28, v29
    v_mul_f32 v8, v28, v8
    v_mul_f32 v9, v28, v9
    v_mul_f32 v10, v28, v10
    v_mul_f32 v11, v28, v11
    v_mul_f32 v12, v28, v12
    v_mul_f32 v13, v28, v13
    v_mul_f32 v14, v28, v14
    v_mul_f32 v15, v28, v15
    s_waitcnt vmcnt(6)
    buffer_load_dwordx4 v[100:103], v3, s[28:31], 0 offen offset:3072 nt
    v_dot2c_f32_bf16_dpp v8, v26, v72 row_newbcast:0 row_mask:0xf bank_mask:0xf
    v_dot2c_f32_bf16_dpp v9, v27, v72 row_newbcast:0 row_mask:0xf bank_mask:0xf
    v_dot2c_f32_bf16_dpp v10, v26, v73 row_newbcast:0 row_mask:0xf bank_mask:0xf
    v_dot2c_f32_bf16_dpp v11, v27, v73 row_newbcast:0 row_mask:0xf bank_mask:0xf
    v_dot2c_f32_bf16_dpp v12, v26, v74 row_newbcast:0 row_mask:0xf bank_mask:0xf
    v_dot2c_f32_bf16_dpp v13, v27, v74 row_newbcast:0 row_mask:0xf bank_mask:0xf
    v_dot2c_f32_bf16_dpp v14, v26, v75 row_newbcast:0 row_mask:0xf bank_mask:0xf
    v_dot2c_f32_bf16_dpp v15, v27, v75 row_newbcast:0 row_mask:0xf bank_mask:0xf
    s_waitcnt vmcnt(6)
    v_add_u32 v2, 0x8000, v2
    v_add_u32 v3, 0x8000, v3
    buffer_load_dwordx4 v[40:43], v2, s[24:27], 0 offen offset:0 nt
    v_dot2c_f32_bf16_dpp v8, v26, v76 row_newbcast:1 row_mask:0xf bank_mask:0xf
    v_dot2c_f32_bf16_dpp v9, v27, v76 row_newbcast:1 row_mask:0xf bank_mask:0xf
    v_dot2c_f32_bf16_dpp v10, v26, v77 row_newbcast:1 row_mask:0xf bank_mask:0xf
    v_dot2c_f32_bf16_dpp v11, v27, v77 row_newbcast:1 row_mask:0xf bank_mask:0xf
    v_dot2c_f32_bf16_dpp v12, v26, v78 row_newbcast:1 row_mask:0xf bank_mask:0xf
    v_dot2c_f32_bf16_dpp v13, v27, v78 row_newbcast:1 row_mask:0xf bank_mask:0xf
    v_dot2c_f32_bf16_dpp v14, v26, v79 row_newbcast:1 row_mask:0xf bank_mask:0xf
    v_dot2c_f32_bf16_dpp v15, v27, v79 row_newbcast:1 row_mask:0xf bank_mask:0xf
    s_waitcnt vmcnt(6)
    buffer_load_dwordx4 v[44:47], v2, s[24:27], 0 offen offset:1024 nt
    v_dot2c_f32_bf16_dpp v8, v26, v80 row_newbcast:4 row_mask:0xf bank_mask:0xf
    v_dot2c_f32_bf16_dpp v9, v27, v80 row_newbcast:4 row_mask:0xf bank_mask:0xf
    v_dot2c_f32_bf16_dpp v10, v26, v81 row_newbcast:4 row_mask:0xf bank_mask:0xf
    v_dot2c_f32_bf16_dpp v11, v27, v81 row_newbcast:4 row_mask:0xf bank_mask:0xf
    v_dot2c_f32_bf16_dpp v12, v26, v82 row_newbcast:4 row_mask:0xf bank_mask:0xf
    v_dot2c_f32_bf16_dpp v13, v27, v82 row_newbcast:4 row_mask:0xf bank_mask:0xf
    v_dot2c_f32_bf16_dpp v14, v26, v83 row_newbcast:4 row_mask:0xf bank_mask:0xf
    v_dot2c_f32_bf16_dpp v15, v27, v83 row_newbcast:4 row_mask:0xf bank_mask:0xf
    s_waitcnt vmcnt(6)
    buffer_load_dwordx4 v[48:51], v2, s[24:27], 0 offen offset:2048 nt
    v_dot2c_f32_bf16_dpp v8, v26, v84 row_newbcast:5 row_mask:0xf bank_mask:0xf
    v_dot2c_f32_bf16_dpp v9, v27, v84 row_newbcast:5 row_mask:0xf bank_mask:0xf
    v_dot2c_f32_bf16_dpp v10, v26, v85 row_newbcast:5 row_mask:0xf bank_mask:0xf
    v_dot2c_f32_bf16_dpp v11, v27, v85 row_newbcast:5 row_mask:0xf bank_mask:0xf
    v_dot2c_f32_bf16_dpp v12, v26, v86 row_newbcast:5 row_mask:0xf bank_mask:0xf
    v_dot2c_f32_bf16_dpp v13, v27, v86 row_newbcast:5 row_mask:0xf bank_mask:0xf
    v_dot2c_f32_bf16_dpp v14, v26, v87 row_newbcast:5 row_mask:0xf bank_mask:0xf
    v_dot2c_f32_bf16_dpp v15, v27, v87 row_newbcast:5 row_mask:0xf bank_mask:0xf
    s_waitcnt vmcnt(6)
    buffer_load_dwordx4 v[52:55], v2, s[24:27], 0 offen offset:3072 nt
    v_dot2c_f32_bf16_dpp v8, v26, v88 row_newbcast:8 row_mask:0xf bank_mask:0xf
    v_dot2c_f32_bf16_dpp v9, v27, v88 row_newbcast:8 row_mask:0xf bank_mask:0xf
    v_dot2c_f32_bf16_dpp v10, v26, v89 row_newbcast:8 row_mask:0xf bank_mask:0xf
    v_dot2c_f32_bf16_dpp v11, v27, v89 row_newbcast:8 row_mask:0xf bank_mask:0xf
    v_dot2c_f32_bf16_dpp v12, v26, v90 row_newbcast:8 row_mask:0xf bank_mask:0xf
    v_dot2c_f32_bf16_dpp v13, v27, v90 row_newbcast:8 row_mask:0xf bank_mask:0xf
    v_dot2c_f32_bf16_dpp v14, v26, v91 row_newbcast:8 row_mask:0xf bank_mask:0xf
    v_dot2c_f32_bf16_dpp v15, v27, v91 row_newbcast:8 row_mask:0xf bank_mask:0xf
    s_waitcnt vmcnt(6)
    buffer_load_dwordx4 v[56:59], v3, s[24:27], 0 offen offset:0 nt
    v_dot2c_f32_bf16_dpp v8, v26, v92 row_newbcast:9 row_mask:0xf bank_mask:0xf
    v_dot2c_f32_bf16_dpp v9, v27, v92 row_newbcast:9 row_mask:0xf bank_mask:0xf
    v_dot2c_f32_bf16_dpp v10, v26, v93 row_newbcast:9 row_mask:0xf bank_mask:0xf
    v_dot2c_f32_bf16_dpp v11, v27, v93 row_newbcast:9 row_mask:0xf bank_mask:0xf
    v_dot2c_f32_bf16_dpp v12, v26, v94 row_newbcast:9 row_mask:0xf bank_mask:0xf
    v_dot2c_f32_bf16_dpp v13, v27, v94 row_newbcast:9 row_mask:0xf bank_mask:0xf
    v_dot2c_f32_bf16_dpp v14, v26, v95 row_newbcast:9 row_mask:0xf bank_mask:0xf
    v_dot2c_f32_bf16_dpp v15, v27, v95 row_newbcast:9 row_mask:0xf bank_mask:0xf
    s_waitcnt vmcnt(6)
    buffer_load_dwordx4 v[60:63], v3, s[24:27], 0 offen offset:1024 nt
    v_dot2c_f32_bf16_dpp v8, v26, v96 row_newbcast:12 row_mask:0xf bank_mask:0xf
    v_dot2c_f32_bf16_dpp v9, v27, v96 row_newbcast:12 row_mask:0xf bank_mask:0xf
    v_dot2c_f32_bf16_dpp v10, v26, v97 row_newbcast:12 row_mask:0xf bank_mask:0xf
    v_dot2c_f32_bf16_dpp v11, v27, v97 row_newbcast:12 row_mask:0xf bank_mask:0xf
    v_dot2c_f32_bf16_dpp v12, v26, v98 row_newbcast:12 row_mask:0xf bank_mask:0xf
    v_dot2c_f32_bf16_dpp v13, v27, v98 row_newbcast:12 row_mask:0xf bank_mask:0xf
    v_dot2c_f32_bf16_dpp v14, v26, v99 row_newbcast:12 row_mask:0xf bank_mask:0xf
    v_dot2c_f32_bf16_dpp v15, v27, v99 row_newbcast:12 row_mask:0xf bank_mask:0xf
    s_waitcnt vmcnt(6)
    buffer_load_dwordx4 v[64:67], v3, s[24:27], 0 offen offset:2048 nt
    v_dot2c_f32_bf16_dpp v8, v26, v100 row_newbcast:13 row_mask:0xf bank_mask:0xf
    v_dot2c_f32_bf16_dpp v9, v27, v100 row_newbcast:13 row_mask:0xf bank_mask:0xf
    v_dot2c_f32_bf16_dpp v10, v26, v101 row_newbcast:13 row_mask:0xf bank_mask:0xf
    v_dot2c_f32_bf16_dpp v11, v27, v101 row_newbcast:13 row_mask:0xf bank_mask:0xf
    v_dot2c_f32_bf16_dpp v12, v26, v102 row_newbcast:13 row_mask:0xf bank_mask:0xf
    v_dot2c_f32_bf16_dpp v13, v27, v102 row_newbcast:13 row_mask:0xf bank_mask:0xf
    v_dot2c_f32_bf16_dpp v14, v26, v103 row_newbcast:13 row_mask:0xf bank_mask:0xf
    v_dot2c_f32_bf16_dpp v15, v27, v103 row_newbcast:13 row_mask:0xf bank_mask:0xf
    s_waitcnt vmcnt(6)
    buffer_load_dwordx4 v[68:71], v3, s[24:27], 0 offen offset:3072 nt
    buffer_load_dwordx4 v[72:75], v2, s[28:31], 0 offen offset:0 nt
    buffer_load_dwordx4 v[76:79], v2, s[28:31], 0 offen offset:1024 nt
    buffer_load_dwordx4 v[80:83], v2, s[28:31], 0 offen offset:2048 nt
    v_dot2_f32_bf16 v16, v40, v4, 0
    v_dot2_f32_bf16 v16, v41, v5, v16
    v_dot2_f32_bf16 v16, v42, v6, v16
    v_dot2_f32_bf16 v16, v43, v7, v16
    s_waitcnt vmcnt(9)
    buffer_load_dwordx4 v[84:87], v2, s[28:31], 0 offen offset:3072 nt
    v_dot2_f32_bf16 v17, v44, v4, 0
    v_dot2_f32_bf16 v17, v45, v5, v17
    v_dot2_f32_bf16 v17, v46, v6, v17
    v_dot2_f32_bf16 v17, v47, v7, v17
    s_waitcnt vmcnt(9)
    buffer_load_dwordx4 v[88:91], v3, s[28:31], 0 offen offset:0 nt
    v_dot2_f32_bf16 v18, v48, v4, 0
    v_dot2_f32_bf16 v18, v49, v5, v18
    v_dot2_f32_bf16 v18, v50, v6, v18
    v_dot2_f32_bf16 v18, v51, v7, v18
    s_waitcnt vmcnt(9)
    buffer_load_dwordx4 v[92:95], v3, s[28:31], 0 offen offset:1024 nt
    v_dot2_f32_bf16 v19, v52, v4, 0
    v_dot2_f32_bf16 v19, v53, v5, v19
    v_dot2_f32_bf16 v19, v54, v6, v19
    v_dot2_f32_bf16 v19, v55, v7, v19
    s_waitcnt vmcnt(9)
    buffer_load_dwordx4 v[96:99], v3, s[28:31], 0 offen offset:2048 nt
    v_dot2_f32_bf16 v20, v56, v4, 0
    v_dot2_f32_bf16 v20, v57, v5, v20
    v_dot2_f32_bf16 v20, v58, v6, v20
    v_dot2_f32_bf16 v20, v59, v7, v20
    s_waitcnt vmcnt(9)
    buffer_load_dwordx4 v[100:103], v3, s[28:31], 0 offen offset:3072 nt
    v_dot2_f32_bf16 v21, v60, v4, 0
    v_dot2_f32_bf16 v21, v61, v5, v21
    v_dot2_f32_bf16 v21, v62, v6, v21
    v_dot2_f32_bf16 v21, v63, v7, v21
    s_waitcnt vmcnt(9)
    v_dot2_f32_bf16 v22, v64, v4, 0
    v_dot2_f32_bf16 v22, v65, v5, v22
    v_dot2_f32_bf16 v22, v66, v6, v22
    v_dot2_f32_bf16 v22, v67, v7, v22
    s_waitcnt vmcnt(8)
    v_dot2_f32_bf16 v23, v68, v4, 0
    v_dot2_f32_bf16 v23, v69, v5, v23
    v_dot2_f32_bf16 v23, v70, v6, v23
    v_dot2_f32_bf16 v23, v71, v7, v23
    s_nop 2
    v_add_f32_dpp v16, v16, v16 row_ror:8 row_mask:0xf bank_mask:0x3
    v_add_f32_dpp v17, v17, v17 row_ror:8 row_mask:0xf bank_mask:0x3
    v_add_f32_dpp v18, v18, v18 row_ror:8 row_mask:0xf bank_mask:0x3
    v_add_f32_dpp v19, v19, v19 row_ror:8 row_mask:0xf bank_mask:0x3
    v_add_f32_dpp v16, v20, v20 row_ror:8 row_mask:0xf bank_mask:0xc
    v_add_f32_dpp v17, v21, v21 row_ror:8 row_mask:0xf bank_mask:0xc
    v_add_f32_dpp v18, v22, v22 row_ror:8 row_mask:0xf bank_mask:0xc
    v_add_f32_dpp v19, v23, v23 row_ror:8 row_mask:0xf bank_mask:0xc
    v_add_f32_dpp v16, v16, v16 row_half_mirror row_mask:0xf bank_mask:0x5
    v_add_f32_dpp v17, v17, v17 row_half_mirror row_mask:0xf bank_mask:0x5
    v_add_f32_dpp v16, v18, v18 row_half_mirror row_mask:0xf bank_mask:0xa
    v_add_f32_dpp v17, v19, v19 row_half_mirror row_mask:0xf bank_mask:0xa
    s_nop 0
    v_add_f32_dpp v16, v16, v16 quad_perm:[1,0,3,2] row_mask:0xf bank_mask:0xf
    v_add_f32_dpp v17, v17, v17 quad_perm:[1,0,3,2] row_mask:0xf bank_mask:0xf
    s_nop 0
    v_cndmask_b32 v29, v16, v17, s[76:77]
    s_nop 1
    v_add_f32_dpp v29, v29, v29 quad_perm:[2,3,0,1] row_mask:0xf bank_mask:0xf
    v_mul_f32 v29, s74, v29
    s_nop 1
    v_max_f32_dpp v30, v29, v29 quad_perm:[1,0,3,2] row_mask:0xf bank_mask:0xf
    s_nop 1
    v_max_f32_dpp v30, v30, v30 row_ror:4 row_mask:0xf bank_mask:0xf
    s_nop 1
    v_max_f32_dpp v30, v30, v30 row_ror:8 row_mask:0xf bank_mask:0xf
    v_max_f32 v30, v30, v24
    v_sub_f32 v28, v24, v30
    v_sub_f32 v29, v29, v30
    v_exp_f32 v28, v28
    v_exp_f32 v29, v29
    v_mov_b32 v24, v30
    v_cvt_pk_bf16_f32 v26, v29, 0
    v_cvt_pk_bf16_f32 v27, 0, v29
    v_fma_f32 v25, v25, v28, v29
    v_mul_f32 v8, v28, v8
    v_mul_f32 v9, v28, v9
    v_mul_f32 v10, v28, v10
    v_mul_f32 v11, v28, v11
    v_mul_f32 v12, v28, v12
    v_mul_f32 v13, v28, v13
    v_mul_f32 v14, v28, v14
    v_mul_f32 v15, v28, v15
    s_waitcnt vmcnt(7)
    v_dot2c_f32_bf16_dpp v8, v26, v72 row_newbcast:0 row_mask:0xf bank_mask:0xf
    v_dot2c_f32_bf16_dpp v9, v27, v72 row_newbcast:0 row_mask:0xf bank_mask:0xf
    v_dot2c_f32_bf16_dpp v10, v26, v73 row_newbcast:0 row_mask:0xf bank_mask:0xf
    v_dot2c_f32_bf16_dpp v11, v27, v73 row_newbcast:0 row_mask:0xf bank_mask:0xf
    v_dot2c_f32_bf16_dpp v12, v26, v74 row_newbcast:0 row_mask:0xf bank_mask:0xf
    v_dot2c_f32_bf16_dpp v13, v27, v74 row_newbcast:0 row_mask:0xf bank_mask:0xf
    v_dot2c_f32_bf16_dpp v14, v26, v75 row_newbcast:0 row_mask:0xf bank_mask:0xf
    v_dot2c_f32_bf16_dpp v15, v27, v75 row_newbcast:0 row_mask:0xf bank_mask:0xf
    s_waitcnt vmcnt(6)
    v_dot2c_f32_bf16_dpp v8, v26, v76 row_newbcast:1 row_mask:0xf bank_mask:0xf
    v_dot2c_f32_bf16_dpp v9, v27, v76 row_newbcast:1 row_mask:0xf bank_mask:0xf
    v_dot2c_f32_bf16_dpp v10, v26, v77 row_newbcast:1 row_mask:0xf bank_mask:0xf
    v_dot2c_f32_bf16_dpp v11, v27, v77 row_newbcast:1 row_mask:0xf bank_mask:0xf
    v_dot2c_f32_bf16_dpp v12, v26, v78 row_newbcast:1 row_mask:0xf bank_mask:0xf
    v_dot2c_f32_bf16_dpp v13, v27, v78 row_newbcast:1 row_mask:0xf bank_mask:0xf
    v_dot2c_f32_bf16_dpp v14, v26, v79 row_newbcast:1 row_mask:0xf bank_mask:0xf
    v_dot2c_f32_bf16_dpp v15, v27, v79 row_newbcast:1 row_mask:0xf bank_mask:0xf
    s_waitcnt vmcnt(5)
    v_dot2c_f32_bf16_dpp v8, v26, v80 row_newbcast:4 row_mask:0xf bank_mask:0xf
    v_dot2c_f32_bf16_dpp v9, v27, v80 row_newbcast:4 row_mask:0xf bank_mask:0xf
    v_dot2c_f32_bf16_dpp v10, v26, v81 row_newbcast:4 row_mask:0xf bank_mask:0xf
    v_dot2c_f32_bf16_dpp v11, v27, v81 row_newbcast:4 row_mask:0xf bank_mask:0xf
    v_dot2c_f32_bf16_dpp v12, v26, v82 row_newbcast:4 row_mask:0xf bank_mask:0xf
    v_dot2c_f32_bf16_dpp v13, v27, v82 row_newbcast:4 row_mask:0xf bank_mask:0xf
    v_dot2c_f32_bf16_dpp v14, v26, v83 row_newbcast:4 row_mask:0xf bank_mask:0xf
    v_dot2c_f32_bf16_dpp v15, v27, v83 row_newbcast:4 row_mask:0xf bank_mask:0xf
    s_waitcnt vmcnt(4)
    v_dot2c_f32_bf16_dpp v8, v26, v84 row_newbcast:5 row_mask:0xf bank_mask:0xf
    v_dot2c_f32_bf16_dpp v9, v27, v84 row_newbcast:5 row_mask:0xf bank_mask:0xf
    v_dot2c_f32_bf16_dpp v10, v26, v85 row_newbcast:5 row_mask:0xf bank_mask:0xf
    v_dot2c_f32_bf16_dpp v11, v27, v85 row_newbcast:5 row_mask:0xf bank_mask:0xf
    v_dot2c_f32_bf16_dpp v12, v26, v86 row_newbcast:5 row_mask:0xf bank_mask:0xf
    v_dot2c_f32_bf16_dpp v13, v27, v86 row_newbcast:5 row_mask:0xf bank_mask:0xf
    v_dot2c_f32_bf16_dpp v14, v26, v87 row_newbcast:5 row_mask:0xf bank_mask:0xf
    v_dot2c_f32_bf16_dpp v15, v27, v87 row_newbcast:5 row_mask:0xf bank_mask:0xf
    s_waitcnt vmcnt(3)
    v_dot2c_f32_bf16_dpp v8, v26, v88 row_newbcast:8 row_mask:0xf bank_mask:0xf
    v_dot2c_f32_bf16_dpp v9, v27, v88 row_newbcast:8 row_mask:0xf bank_mask:0xf
    v_dot2c_f32_bf16_dpp v10, v26, v89 row_newbcast:8 row_mask:0xf bank_mask:0xf
    v_dot2c_f32_bf16_dpp v11, v27, v89 row_newbcast:8 row_mask:0xf bank_mask:0xf
    v_dot2c_f32_bf16_dpp v12, v26, v90 row_newbcast:8 row_mask:0xf bank_mask:0xf
    v_dot2c_f32_bf16_dpp v13, v27, v90 row_newbcast:8 row_mask:0xf bank_mask:0xf
    v_dot2c_f32_bf16_dpp v14, v26, v91 row_newbcast:8 row_mask:0xf bank_mask:0xf
    v_dot2c_f32_bf16_dpp v15, v27, v91 row_newbcast:8 row_mask:0xf bank_mask:0xf
    s_waitcnt vmcnt(2)
    v_dot2c_f32_bf16_dpp v8, v26, v92 row_newbcast:9 row_mask:0xf bank_mask:0xf
    v_dot2c_f32_bf16_dpp v9, v27, v92 row_newbcast:9 row_mask:0xf bank_mask:0xf
    v_dot2c_f32_bf16_dpp v10, v26, v93 row_newbcast:9 row_mask:0xf bank_mask:0xf
    v_dot2c_f32_bf16_dpp v11, v27, v93 row_newbcast:9 row_mask:0xf bank_mask:0xf
    v_dot2c_f32_bf16_dpp v12, v26, v94 row_newbcast:9 row_mask:0xf bank_mask:0xf
    v_dot2c_f32_bf16_dpp v13, v27, v94 row_newbcast:9 row_mask:0xf bank_mask:0xf
    v_dot2c_f32_bf16_dpp v14, v26, v95 row_newbcast:9 row_mask:0xf bank_mask:0xf
    v_dot2c_f32_bf16_dpp v15, v27, v95 row_newbcast:9 row_mask:0xf bank_mask:0xf
    s_waitcnt vmcnt(1)
    v_dot2c_f32_bf16_dpp v8, v26, v96 row_newbcast:12 row_mask:0xf bank_mask:0xf
    v_dot2c_f32_bf16_dpp v9, v27, v96 row_newbcast:12 row_mask:0xf bank_mask:0xf
    v_dot2c_f32_bf16_dpp v10, v26, v97 row_newbcast:12 row_mask:0xf bank_mask:0xf
    v_dot2c_f32_bf16_dpp v11, v27, v97 row_newbcast:12 row_mask:0xf bank_mask:0xf
    v_dot2c_f32_bf16_dpp v12, v26, v98 row_newbcast:12 row_mask:0xf bank_mask:0xf
    v_dot2c_f32_bf16_dpp v13, v27, v98 row_newbcast:12 row_mask:0xf bank_mask:0xf
    v_dot2c_f32_bf16_dpp v14, v26, v99 row_newbcast:12 row_mask:0xf bank_mask:0xf
    v_dot2c_f32_bf16_dpp v15, v27, v99 row_newbcast:12 row_mask:0xf bank_mask:0xf
    s_waitcnt vmcnt(0)
    v_dot2c_f32_bf16_dpp v8, v26, v100 row_newbcast:13 row_mask:0xf bank_mask:0xf
    v_dot2c_f32_bf16_dpp v9, v27, v100 row_newbcast:13 row_mask:0xf bank_mask:0xf
    v_dot2c_f32_bf16_dpp v10, v26, v101 row_newbcast:13 row_mask:0xf bank_mask:0xf
    v_dot2c_f32_bf16_dpp v11, v27, v101 row_newbcast:13 row_mask:0xf bank_mask:0xf
    v_dot2c_f32_bf16_dpp v12, v26, v102 row_newbcast:13 row_mask:0xf bank_mask:0xf
    v_dot2c_f32_bf16_dpp v13, v27, v102 row_newbcast:13 row_mask:0xf bank_mask:0xf
    v_dot2c_f32_bf16_dpp v14, v26, v103 row_newbcast:13 row_mask:0xf bank_mask:0xf
    v_dot2c_f32_bf16_dpp v15, v27, v103 row_newbcast:13 row_mask:0xf bank_mask:0xf
    v_mov_b32 v31, v24
    v_mov_b32 v29, v31
    v_mov_b32 v30, v31
    s_nop 1
    v_permlane32_swap_b32 v29, v30
    s_nop 1
    v_max_f32 v29, v29, v30
    v_mov_b32 v30, v29
    s_nop 1
    v_permlane16_swap_b32 v29, v30
    s_nop 1
    v_max_f32 v31, v29, v30
    v_sub_f32 v28, v24, v31
    v_exp_f32 v28, v28
    v_mov_b32 v24, v31
    v_mul_f32 v25, v28, v25
    v_mul_f32 v8, v28, v8
    v_mul_f32 v9, v28, v9
    v_mul_f32 v10, v28, v10
    v_mul_f32 v11, v28, v11
    v_mul_f32 v12, v28, v12
    v_mul_f32 v13, v28, v13
    v_mul_f32 v14, v28, v14
    v_mul_f32 v15, v28, v15
    v_add_f32_dpp v25, v25, v25 quad_perm:[1,0,3,2] row_mask:0xf bank_mask:0xf
    s_lshl_b32 s62, s59, 9
    v_add_u32 v31, s62, v35
    v_add_f32_dpp v25, v25, v25 quad_perm:[2,3,0,1] row_mask:0xf bank_mask:0xf
    v_permlane32_swap_b32 v8, v12
    v_permlane32_swap_b32 v9, v13
    v_permlane32_swap_b32 v10, v14
    v_permlane32_swap_b32 v11, v15
    s_nop 1
    v_add_f32 v8, v8, v12
    v_add_f32 v9, v9, v13
    v_add_f32 v10, v10, v14
    v_add_f32 v11, v11, v15
    s_nop 1
    v_permlane16_swap_b32 v8, v10
    v_permlane16_swap_b32 v9, v11
    s_nop 1
    v_add_f32 v8, v8, v10
    v_add_f32 v9, v9, v11
    ds_write_b64 v31, v[8:9] offset:2048
    v_add_f32_dpp v25, v25, v25 row_ror:4 row_mask:0xf bank_mask:0xf
    s_lshl_b32 s62, s59, 3
    v_mov_b32 v31, s62
    v_add_f32_dpp v25, v25, v25 row_ror:8 row_mask:0xf bank_mask:0xf
    v_mov_b32 v29, v25
    v_mov_b32 v30, v25
    s_nop 1
    v_permlane32_swap_b32 v29, v30
    s_nop 1
    v_add_f32 v29, v29, v30
    v_mov_b32 v30, v29
    s_nop 1
    v_permlane16_swap_b32 v29, v30
    s_nop 1
    v_add_f32 v25, v29, v30
    v_mul_f32 v25, 0.5, v25
    ds_write_b64 v31, v[24:25] offset:4096
    v_mov_b32 v16, 0
    v_mov_b32 v17, 0
    v_mov_b32 v18, 0
    v_mov_b32 v19, 0
    v_mov_b32 v20, 0
    v_mov_b32 v21, 0
    v_mov_b32 v22, 0
    v_mov_b32 v23, 0
    v_mov_b32 v30, 0
    s_waitcnt lgkmcnt(0)
    s_barrier
    ds_read_b128 v[40:43], v30 offset:4096
    ds_read_b128 v[44:47], v30 offset:4112
    ds_read_b64 v[72:73], v35 offset:2048
    ds_read_b64 v[74:75], v35 offset:2560
    ds_read_b64 v[76:77], v35 offset:3072
    ds_read_b64 v[78:79], v35 offset:3584
    s_mul_i32 s62, s61, 2176
    s_add_u32 s64, s62, 2048
    s_lshl_b32 s63, s59, 9
    s_add_u32 s62, s62, s63
    v_and_b32 v29, 15, v1
    v_lshlrev_b32 v29, 5, v29
    v_lshrrev_b32 v30, 5, v1
    v_lshl_add_u32 v29, v30, 4, v29
    s_waitcnt lgkmcnt(4)
    v_max3_f32 v24, v40, v42, v44
    v_max_f32 v24, v24, v46
    v_sub_f32 v40, v40, v24
    v_sub_f32 v42, v42, v24
    v_sub_f32 v44, v44, v24
    v_sub_f32 v46, v46, v24
    v_exp_f32 v40, v40
    v_exp_f32 v42, v42
    v_exp_f32 v44, v44
    v_exp_f32 v46, v46
    s_waitcnt lgkmcnt(0)
    v_mul_f32 v8, v40, v72
    v_mul_f32 v9, v40, v73
    v_fma_f32 v8, v42, v74, v8
    v_fma_f32 v9, v42, v75, v9
    v_fma_f32 v8, v44, v76, v8
    v_fma_f32 v9, v44, v77, v9
    v_fma_f32 v8, v46, v78, v8
    v_fma_f32 v9, v46, v79, v9
    v_cvt_pk_bf16_f32 v26, v8, v9
    v_mul_f32 v25, v40, v41
    v_fma_f32 v25, v42, v43, v25
    v_fma_f32 v25, v44, v45, v25
    v_fma_f32 v25, v46, v47, v25
    v_dot2c_f32_bf16_dpp v16, v26, v104 row_newbcast:0 row_mask:0xf bank_mask:0xf
    v_dot2c_f32_bf16_dpp v17, v26, v108 row_newbcast:0 row_mask:0xf bank_mask:0xf
    v_dot2c_f32_bf16_dpp v18, v26, v105 row_newbcast:0 row_mask:0xf bank_mask:0xf
    v_dot2c_f32_bf16_dpp v19, v26, v109 row_newbcast:0 row_mask:0xf bank_mask:0xf
    v_dot2c_f32_bf16_dpp v20, v26, v106 row_newbcast:0 row_mask:0xf bank_mask:0xf
    v_dot2c_f32_bf16_dpp v21, v26, v110 row_newbcast:0 row_mask:0xf bank_mask:0xf
    v_dot2c_f32_bf16_dpp v22, v26, v107 row_newbcast:0 row_mask:0xf bank_mask:0xf
    v_dot2c_f32_bf16_dpp v23, v26, v111 row_newbcast:0 row_mask:0xf bank_mask:0xf
    v_dot2c_f32_bf16_dpp v16, v26, v112 row_newbcast:1 row_mask:0xf bank_mask:0xf
    v_dot2c_f32_bf16_dpp v17, v26, v116 row_newbcast:1 row_mask:0xf bank_mask:0xf
    v_dot2c_f32_bf16_dpp v18, v26, v113 row_newbcast:1 row_mask:0xf bank_mask:0xf
    v_dot2c_f32_bf16_dpp v19, v26, v117 row_newbcast:1 row_mask:0xf bank_mask:0xf
    v_dot2c_f32_bf16_dpp v20, v26, v114 row_newbcast:1 row_mask:0xf bank_mask:0xf
    v_dot2c_f32_bf16_dpp v21, v26, v118 row_newbcast:1 row_mask:0xf bank_mask:0xf
    v_dot2c_f32_bf16_dpp v22, v26, v115 row_newbcast:1 row_mask:0xf bank_mask:0xf
    v_dot2c_f32_bf16_dpp v23, v26, v119 row_newbcast:1 row_mask:0xf bank_mask:0xf
    v_dot2c_f32_bf16_dpp v16, v26, v120 row_newbcast:2 row_mask:0xf bank_mask:0xf
    v_dot2c_f32_bf16_dpp v17, v26, v124 row_newbcast:2 row_mask:0xf bank_mask:0xf
    v_dot2c_f32_bf16_dpp v18, v26, v121 row_newbcast:2 row_mask:0xf bank_mask:0xf
    v_dot2c_f32_bf16_dpp v19, v26, v125 row_newbcast:2 row_mask:0xf bank_mask:0xf
    v_dot2c_f32_bf16_dpp v20, v26, v122 row_newbcast:2 row_mask:0xf bank_mask:0xf
    v_dot2c_f32_bf16_dpp v21, v26, v126 row_newbcast:2 row_mask:0xf bank_mask:0xf
    v_dot2c_f32_bf16_dpp v22, v26, v123 row_newbcast:2 row_mask:0xf bank_mask:0xf
    v_dot2c_f32_bf16_dpp v23, v26, v127 row_newbcast:2 row_mask:0xf bank_mask:0xf
    v_dot2c_f32_bf16_dpp v16, v26, v128 row_newbcast:3 row_mask:0xf bank_mask:0xf
    v_dot2c_f32_bf16_dpp v17, v26, v132 row_newbcast:3 row_mask:0xf bank_mask:0xf
    v_dot2c_f32_bf16_dpp v18, v26, v129 row_newbcast:3 row_mask:0xf bank_mask:0xf
    v_dot2c_f32_bf16_dpp v19, v26, v133 row_newbcast:3 row_mask:0xf bank_mask:0xf
    v_dot2c_f32_bf16_dpp v20, v26, v130 row_newbcast:3 row_mask:0xf bank_mask:0xf
    v_dot2c_f32_bf16_dpp v21, v26, v134 row_newbcast:3 row_mask:0xf bank_mask:0xf
    v_dot2c_f32_bf16_dpp v22, v26, v131 row_newbcast:3 row_mask:0xf bank_mask:0xf
    v_dot2c_f32_bf16_dpp v23, v26, v135 row_newbcast:3 row_mask:0xf bank_mask:0xf
    v_dot2c_f32_bf16_dpp v16, v26, v136 row_newbcast:4 row_mask:0xf bank_mask:0xf
    v_dot2c_f32_bf16_dpp v17, v26, v140 row_newbcast:4 row_mask:0xf bank_mask:0xf
    v_dot2c_f32_bf16_dpp v18, v26, v137 row_newbcast:4 row_mask:0xf bank_mask:0xf
    v_dot2c_f32_bf16_dpp v19, v26, v141 row_newbcast:4 row_mask:0xf bank_mask:0xf
    v_dot2c_f32_bf16_dpp v20, v26, v138 row_newbcast:4 row_mask:0xf bank_mask:0xf
    v_dot2c_f32_bf16_dpp v21, v26, v142 row_newbcast:4 row_mask:0xf bank_mask:0xf
    v_dot2c_f32_bf16_dpp v22, v26, v139 row_newbcast:4 row_mask:0xf bank_mask:0xf
    v_dot2c_f32_bf16_dpp v23, v26, v143 row_newbcast:4 row_mask:0xf bank_mask:0xf
    v_dot2c_f32_bf16_dpp v16, v26, v144 row_newbcast:5 row_mask:0xf bank_mask:0xf
    v_dot2c_f32_bf16_dpp v17, v26, v148 row_newbcast:5 row_mask:0xf bank_mask:0xf
    v_dot2c_f32_bf16_dpp v18, v26, v145 row_newbcast:5 row_mask:0xf bank_mask:0xf
    v_dot2c_f32_bf16_dpp v19, v26, v149 row_newbcast:5 row_mask:0xf bank_mask:0xf
    v_dot2c_f32_bf16_dpp v20, v26, v146 row_newbcast:5 row_mask:0xf bank_mask:0xf
    v_dot2c_f32_bf16_dpp v21, v26, v150 row_newbcast:5 row_mask:0xf bank_mask:0xf
    v_dot2c_f32_bf16_dpp v22, v26, v147 row_newbcast:5 row_mask:0xf bank_mask:0xf
    v_dot2c_f32_bf16_dpp v23, v26, v151 row_newbcast:5 row_mask:0xf bank_mask:0xf
    v_dot2c_f32_bf16_dpp v16, v26, v152 row_newbcast:6 row_mask:0xf bank_mask:0xf
    v_dot2c_f32_bf16_dpp v17, v26, v156 row_newbcast:6 row_mask:0xf bank_mask:0xf
    v_dot2c_f32_bf16_dpp v18, v26, v153 row_newbcast:6 row_mask:0xf bank_mask:0xf
    v_dot2c_f32_bf16_dpp v19, v26, v157 row_newbcast:6 row_mask:0xf bank_mask:0xf
    v_dot2c_f32_bf16_dpp v20, v26, v154 row_newbcast:6 row_mask:0xf bank_mask:0xf
    v_dot2c_f32_bf16_dpp v21, v26, v158 row_newbcast:6 row_mask:0xf bank_mask:0xf
    v_dot2c_f32_bf16_dpp v22, v26, v155 row_newbcast:6 row_mask:0xf bank_mask:0xf
    v_dot2c_f32_bf16_dpp v23, v26, v159 row_newbcast:6 row_mask:0xf bank_mask:0xf
    v_dot2c_f32_bf16_dpp v16, v26, v160 row_newbcast:7 row_mask:0xf bank_mask:0xf
    v_dot2c_f32_bf16_dpp v17, v26, v164 row_newbcast:7 row_mask:0xf bank_mask:0xf
    v_dot2c_f32_bf16_dpp v18, v26, v161 row_newbcast:7 row_mask:0xf bank_mask:0xf
    v_dot2c_f32_bf16_dpp v19, v26, v165 row_newbcast:7 row_mask:0xf bank_mask:0xf
    v_dot2c_f32_bf16_dpp v20, v26, v162 row_newbcast:7 row_mask:0xf bank_mask:0xf
    v_dot2c_f32_bf16_dpp v21, v26, v166 row_newbcast:7 row_mask:0xf bank_mask:0xf
    v_dot2c_f32_bf16_dpp v22, v26, v163 row_newbcast:7 row_mask:0xf bank_mask:0xf
    v_dot2c_f32_bf16_dpp v23, v26, v167 row_newbcast:7 row_mask:0xf bank_mask:0xf
    v_dot2c_f32_bf16_dpp v16, v26, v168 row_newbcast:8 row_mask:0xf bank_mask:0xf
    v_dot2c_f32_bf16_dpp v17, v26, v172 row_newbcast:8 row_mask:0xf bank_mask:0xf
    v_dot2c_f32_bf16_dpp v18, v26, v169 row_newbcast:8 row_mask:0xf bank_mask:0xf
    v_dot2c_f32_bf16_dpp v19, v26, v173 row_newbcast:8 row_mask:0xf bank_mask:0xf
    v_dot2c_f32_bf16_dpp v20, v26, v170 row_newbcast:8 row_mask:0xf bank_mask:0xf
    v_dot2c_f32_bf16_dpp v21, v26, v174 row_newbcast:8 row_mask:0xf bank_mask:0xf
    v_dot2c_f32_bf16_dpp v22, v26, v171 row_newbcast:8 row_mask:0xf bank_mask:0xf
    v_dot2c_f32_bf16_dpp v23, v26, v175 row_newbcast:8 row_mask:0xf bank_mask:0xf
    v_dot2c_f32_bf16_dpp v16, v26, v176 row_newbcast:9 row_mask:0xf bank_mask:0xf
    v_dot2c_f32_bf16_dpp v17, v26, v180 row_newbcast:9 row_mask:0xf bank_mask:0xf
    v_dot2c_f32_bf16_dpp v18, v26, v177 row_newbcast:9 row_mask:0xf bank_mask:0xf
    v_dot2c_f32_bf16_dpp v19, v26, v181 row_newbcast:9 row_mask:0xf bank_mask:0xf
    v_dot2c_f32_bf16_dpp v20, v26, v178 row_newbcast:9 row_mask:0xf bank_mask:0xf
    v_dot2c_f32_bf16_dpp v21, v26, v182 row_newbcast:9 row_mask:0xf bank_mask:0xf
    v_dot2c_f32_bf16_dpp v22, v26, v179 row_newbcast:9 row_mask:0xf bank_mask:0xf
    v_dot2c_f32_bf16_dpp v23, v26, v183 row_newbcast:9 row_mask:0xf bank_mask:0xf
    v_dot2c_f32_bf16_dpp v16, v26, v184 row_newbcast:10 row_mask:0xf bank_mask:0xf
    v_dot2c_f32_bf16_dpp v17, v26, v188 row_newbcast:10 row_mask:0xf bank_mask:0xf
    v_dot2c_f32_bf16_dpp v18, v26, v185 row_newbcast:10 row_mask:0xf bank_mask:0xf
    v_dot2c_f32_bf16_dpp v19, v26, v189 row_newbcast:10 row_mask:0xf bank_mask:0xf
    v_dot2c_f32_bf16_dpp v20, v26, v186 row_newbcast:10 row_mask:0xf bank_mask:0xf
    v_dot2c_f32_bf16_dpp v21, v26, v190 row_newbcast:10 row_mask:0xf bank_mask:0xf
    v_dot2c_f32_bf16_dpp v22, v26, v187 row_newbcast:10 row_mask:0xf bank_mask:0xf
    v_dot2c_f32_bf16_dpp v23, v26, v191 row_newbcast:10 row_mask:0xf bank_mask:0xf
    v_dot2c_f32_bf16_dpp v16, v26, v192 row_newbcast:11 row_mask:0xf bank_mask:0xf
    v_dot2c_f32_bf16_dpp v17, v26, v196 row_newbcast:11 row_mask:0xf bank_mask:0xf
    v_dot2c_f32_bf16_dpp v18, v26, v193 row_newbcast:11 row_mask:0xf bank_mask:0xf
    v_dot2c_f32_bf16_dpp v19, v26, v197 row_newbcast:11 row_mask:0xf bank_mask:0xf
    v_dot2c_f32_bf16_dpp v20, v26, v194 row_newbcast:11 row_mask:0xf bank_mask:0xf
    v_dot2c_f32_bf16_dpp v21, v26, v198 row_newbcast:11 row_mask:0xf bank_mask:0xf
    v_dot2c_f32_bf16_dpp v22, v26, v195 row_newbcast:11 row_mask:0xf bank_mask:0xf
    v_dot2c_f32_bf16_dpp v23, v26, v199 row_newbcast:11 row_mask:0xf bank_mask:0xf
    v_dot2c_f32_bf16_dpp v16, v26, v200 row_newbcast:12 row_mask:0xf bank_mask:0xf
    v_dot2c_f32_bf16_dpp v17, v26, v204 row_newbcast:12 row_mask:0xf bank_mask:0xf
    v_dot2c_f32_bf16_dpp v18, v26, v201 row_newbcast:12 row_mask:0xf bank_mask:0xf
    v_dot2c_f32_bf16_dpp v19, v26, v205 row_newbcast:12 row_mask:0xf bank_mask:0xf
    v_dot2c_f32_bf16_dpp v20, v26, v202 row_newbcast:12 row_mask:0xf bank_mask:0xf
    v_dot2c_f32_bf16_dpp v21, v26, v206 row_newbcast:12 row_mask:0xf bank_mask:0xf
    v_dot2c_f32_bf16_dpp v22, v26, v203 row_newbcast:12 row_mask:0xf bank_mask:0xf
    v_dot2c_f32_bf16_dpp v23, v26, v207 row_newbcast:12 row_mask:0xf bank_mask:0xf
    v_dot2c_f32_bf16_dpp v16, v26, v208 row_newbcast:13 row_mask:0xf bank_mask:0xf
    v_dot2c_f32_bf16_dpp v17, v26, v212 row_newbcast:13 row_mask:0xf bank_mask:0xf
    v_dot2c_f32_bf16_dpp v18, v26, v209 row_newbcast:13 row_mask:0xf bank_mask:0xf
    v_dot2c_f32_bf16_dpp v19, v26, v213 row_newbcast:13 row_mask:0xf bank_mask:0xf
    v_dot2c_f32_bf16_dpp v20, v26, v210 row_newbcast:13 row_mask:0xf bank_mask:0xf
    v_dot2c_f32_bf16_dpp v21, v26, v214 row_newbcast:13 row_mask:0xf bank_mask:0xf
    v_dot2c_f32_bf16_dpp v22, v26, v211 row_newbcast:13 row_mask:0xf bank_mask:0xf
    v_dot2c_f32_bf16_dpp v23, v26, v215 row_newbcast:13 row_mask:0xf bank_mask:0xf
    v_dot2c_f32_bf16_dpp v16, v26, v216 row_newbcast:14 row_mask:0xf bank_mask:0xf
    v_dot2c_f32_bf16_dpp v17, v26, v220 row_newbcast:14 row_mask:0xf bank_mask:0xf
    v_dot2c_f32_bf16_dpp v18, v26, v217 row_newbcast:14 row_mask:0xf bank_mask:0xf
    v_dot2c_f32_bf16_dpp v19, v26, v221 row_newbcast:14 row_mask:0xf bank_mask:0xf
    v_dot2c_f32_bf16_dpp v20, v26, v218 row_newbcast:14 row_mask:0xf bank_mask:0xf
    v_dot2c_f32_bf16_dpp v21, v26, v222 row_newbcast:14 row_mask:0xf bank_mask:0xf
    v_dot2c_f32_bf16_dpp v22, v26, v219 row_newbcast:14 row_mask:0xf bank_mask:0xf
    v_dot2c_f32_bf16_dpp v23, v26, v223 row_newbcast:14 row_mask:0xf bank_mask:0xf
    v_dot2c_f32_bf16_dpp v16, v26, v224 row_newbcast:15 row_mask:0xf bank_mask:0xf
    v_dot2c_f32_bf16_dpp v17, v26, v228 row_newbcast:15 row_mask:0xf bank_mask:0xf
    v_dot2c_f32_bf16_dpp v18, v26, v225 row_newbcast:15 row_mask:0xf bank_mask:0xf
    v_dot2c_f32_bf16_dpp v19, v26, v229 row_newbcast:15 row_mask:0xf bank_mask:0xf
    v_dot2c_f32_bf16_dpp v20, v26, v226 row_newbcast:15 row_mask:0xf bank_mask:0xf
    v_dot2c_f32_bf16_dpp v21, v26, v230 row_newbcast:15 row_mask:0xf bank_mask:0xf
    v_dot2c_f32_bf16_dpp v22, v26, v227 row_newbcast:15 row_mask:0xf bank_mask:0xf
    v_dot2c_f32_bf16_dpp v23, v26, v231 row_newbcast:15 row_mask:0xf bank_mask:0xf
    v_and_b32 v30, 16, v1
    v_cmp_eq_u32 vcc, 0, v30
    s_nop 0
    v_permlane32_swap_b32 v16, v20
    v_permlane32_swap_b32 v17, v21
    v_permlane32_swap_b32 v18, v22
    v_permlane32_swap_b32 v19, v23
    s_nop 1
    v_add_f32 v16, v16, v20
    v_add_f32 v17, v17, v21
    v_add_f32 v18, v18, v22
    v_add_f32 v19, v19, v23
    v_mov_b32 v20, v16
    v_mov_b32 v21, v17
    v_mov_b32 v22, v18
    v_mov_b32 v23, v19
    s_nop 1
    v_permlane16_swap_b32 v16, v20
    v_permlane16_swap_b32 v17, v21
    v_permlane16_swap_b32 v18, v22
    v_permlane16_swap_b32 v19, v23
    s_nop 1
    v_add_f32 v16, v16, v20
    v_add_f32 v17, v17, v21
    v_add_f32 v18, v18, v22
    v_add_f32 v19, v19, v23
    s_and_saveexec_b64 s[66:67], vcc
    buffer_store_dwordx4 v[16:19], v29, s[52:55], s62 offen sc1
    s_cmp_lg_u32 s59, 0
    s_cbranch_scc1 L_no_ml
    s_mov_b64 exec, 1
    v_mov_b32 v30, 0
    buffer_store_dwordx2 v[24:25], v30, s[52:55], s64 offen sc1
L_no_ml:
    s_mov_b64 exec, s[66:67]
    s_endpgm
.p2align 6
L_aux:
    s_setprio 3
    s_waitcnt lgkmcnt(0)
    s_mov_b32 s52, s22
    s_and_b32 s53, s23, 0xffff
    s_mov_b32 s54, 0x138200
    s_mov_b32 s55, 0x00020000
    v_mov_b32 v26, -1
    v_mov_b32 v27, -1
    v_mov_b32 v28, -1
    v_mov_b32 v29, -1
    v_lshlrev_b32 v119, 4, v1
    s_mul_i32 s62, s61, 2176
    s_lshl_b32 s63, s61, 11
    s_add_u32 s63, s63, 655360
    buffer_store_dwordx4 v[26:29], v119, s[52:55], s62 offen sc1
    buffer_store_dwordx4 v[26:29], v119, s[52:55], s62 offen offset:1024 sc1
    buffer_store_dwordx4 v[26:29], v119, s[52:55], s63 offen sc1
    buffer_store_dwordx4 v[26:29], v119, s[52:55], s63 offen offset:1024 sc1
    v_cmp_gt_u32 vcc, 8, v1
    s_and_saveexec_b64 s[66:67], vcc
    buffer_store_dwordx4 v[26:29], v119, s[52:55], s62 offen offset:2048 sc1
    s_mov_b64 exec, s[66:67]
    s_nop 1
    s_setprio 3
    s_lshl_b32 s63, s57, 1
    s_add_u32 s63, s63, s58
    v_lshlrev_b32 v26, 7, v1
    s_lshl_b32 s62, s56, 17
    s_lshl_b32 s64, s63, 14
    s_add_u32 s62, s62, s64
    s_add_u32 s36, s12, s62
    s_addc_u32 s37, s13, 0
    s_and_b32 s37, s37, 0xffff
    s_mov_b32 s38, 0x4000
    s_mov_b32 s39, 0x00020000
    s_mov_b32 s64, 0x2000
    buffer_load_dword v128, v26, s[36:39], 0 offen
    buffer_load_dword v129, v26, s[36:39], s64 offen
    s_min_u32 s65, s60, 55
    s_lshr_b32 s62, s65, 1
    s_lshl_b32 s62, s62, 7
    s_add_u32 s44, s16, s62
    s_addc_u32 s45, s17, 0
    s_and_b32 s45, s45, 0xffff
    s_mov_b32 s46, 0x1c0000
    s_mov_b32 s47, 0x00020000
    s_sub_u32 s46, s46, s62
    s_lshl_b32 s64, s63, 6
    v_add_u32 v27, s64, v1
    v_mul_u32_u24 v27, 3584, v27
    buffer_load_dword v130, v27, s[44:47], 0 offen
    s_lshl_b32 s62, s65, 15
    s_lshl_b32 s64, s57, 13
    s_add_u32 s62, s62, s64
    s_add_u32 s48, s20, s62
    s_addc_u32 s49, s21, 0
    s_and_b32 s49, s49, 0xffff
    s_mov_b32 s50, 0x2000
    s_mov_b32 s51, 0x00020000
    buffer_load_dword v131, v26, s[48:51], 0 offen
    s_setprio 0
    s_load_dwordx4 s[8:11], s[0:1], 72
    s_load_dwordx4 s[12:15], s[0:1], 88
    s_waitcnt lgkmcnt(0)
    s_mov_b32 s40, s4
    s_and_b32 s41, s5, 0xffff
    s_mov_b32 s42, 0x1000
    s_mov_b32 s43, 0x00020000
    s_mov_b32 s52, s22
    s_and_b32 s53, s23, 0xffff
    s_mov_b32 s54, 0x138200
    s_mov_b32 s55, 0x00020000
    s_and_b32 s78, s56, 7
    s_lshl_b32 s78, s78, 3
    s_lshr_b32 s62, s56, 3
    s_lshl_b32 s62, s62, 1
    s_add_u32 s78, s78, s62
    s_add_u32 s78, s78, s58
    v_mov_b32 v30, 0
    s_lshl_b32 s62, s57, 7
    s_add_u32 s62, s62, 1277952
    buffer_load_dword v122, v30, s[52:55], s62 offen sc1
    v_mov_b32 v26, 4160
    v_mov_b32 v27, 0
    ds_write_b32 v26, v27
    s_waitcnt lgkmcnt(0)
    s_barrier
    s_waitcnt vmcnt(0)
    v_add_u32 v122, 1, v122
    s_lshl_b32 s62, s61, 7
    s_add_u32 s62, s62, 1179648
    v_mov_b32 v30, 0
    v_cmp_eq_u32 vcc, 0, v1
    s_and_saveexec_b64 s[66:67], vcc
    buffer_store_dword v122, v30, s[52:55], s62 offen sc1
    s_mov_b64 exec, s[66:67]
    s_min_u32 s65, s60, 55
    s_lshl_b32 s62, s65, 6
    s_add_u32 s44, s16, s62
    s_addc_u32 s45, s17, 0
    s_and_b32 s45, s45, 0xffff
    s_mov_b32 s46, 0x1c0000
    s_mov_b32 s47, 0x00020000
    s_sub_u32 s46, s46, s62
    s_lshl_b32 s62, s65, 15
    s_add_u32 s48, s20, s62
    s_addc_u32 s49, s21, 0
    s_and_b32 s49, s49, 0xffff
    s_mov_b32 s50, 0x8000
    s_mov_b32 s51, 0x00020000
    s_cmp_ge_u32 s60, 56
    s_cselect_b32 s46, 0, s46
    s_cselect_b32 s50, 0, s50
    v_lshrrev_b32 v26, 2, v1
    v_lshlrev_b32 v27, 6, v26
    s_lshl_b32 s63, s57, 10
    buffer_load_dwordx4 v[2:5], v27, s[40:43], s63 offen offset:0
    buffer_load_dwordx4 v[6:9], v27, s[40:43], s63 offen offset:16
    buffer_load_dwordx4 v[10:13], v27, s[40:43], s63 offen offset:32
    buffer_load_dwordx4 v[14:17], v27, s[40:43], s63 offen offset:48
    s_mov_b32 s62, 114688
    v_mul_lo_u32 v28, s62, v26
    v_and_b32 v29, 3, v1
    v_lshl_add_u32 v28, v29, 4, v28
    v_mov_b32 v18, 0
    v_mov_b32 v19, 0
    v_mov_b32 v20, 0
    v_mov_b32 v21, 0
    v_mov_b32 v22, 0
    v_mov_b32 v23, 0
    v_mov_b32 v24, 0
    v_mov_b32 v25, 0
    s_mov_b32 s64, 0
    buffer_load_dwordx4 v[40:43], v28, s[44:47], s64 offen
    s_mov_b32 s64, 3584
    buffer_load_dwordx4 v[44:47], v28, s[44:47], s64 offen
    s_mov_b32 s64, 7168
    buffer_load_dwordx4 v[48:51], v28, s[44:47], s64 offen
    s_mov_b32 s64, 10752
    buffer_load_dwordx4 v[52:55], v28, s[44:47], s64 offen
    s_waitcnt vmcnt(2)
    v_perm_b32 v30, v44, v40, s72
    v_perm_b32 v31, v44, v40, s73
    v_dot2c_f32_bf16 v18, v30, v2
    v_dot2c_f32_bf16 v19, v31, v2
    v_perm_b32 v30, v45, v41, s72
    v_perm_b32 v31, v45, v41, s73
    v_dot2c_f32_bf16 v20, v30, v2
    v_dot2c_f32_bf16 v21, v31, v2
    v_perm_b32 v30, v46, v42, s72
    v_perm_b32 v31, v46, v42, s73
    v_dot2c_f32_bf16 v22, v30, v2
    v_dot2c_f32_bf16 v23, v31, v2
    v_perm_b32 v30, v47, v43, s72
    v_perm_b32 v31, v47, v43, s73
    v_dot2c_f32_bf16 v24, v30, v2
    v_dot2c_f32_bf16 v25, v31, v2
    s_mov_b32 s64, 14336
    buffer_load_dwordx4 v[56:59], v28, s[44:47], s64 offen
    s_mov_b32 s64, 17920
    buffer_load_dwordx4 v[60:63], v28, s[44:47], s64 offen
    s_waitcnt vmcnt(2)
    v_perm_b32 v30, v52, v48, s72
    v_perm_b32 v31, v52, v48, s73
    v_dot2c_f32_bf16 v18, v30, v3
    v_dot2c_f32_bf16 v19, v31, v3
    v_perm_b32 v30, v53, v49, s72
    v_perm_b32 v31, v53, v49, s73
    v_dot2c_f32_bf16 v20, v30, v3
    v_dot2c_f32_bf16 v21, v31, v3
    v_perm_b32 v30, v54, v50, s72
    v_perm_b32 v31, v54, v50, s73
    v_dot2c_f32_bf16 v22, v30, v3
    v_dot2c_f32_bf16 v23, v31, v3
    v_perm_b32 v30, v55, v51, s72
    v_perm_b32 v31, v55, v51, s73
    v_dot2c_f32_bf16 v24, v30, v3
    v_dot2c_f32_bf16 v25, v31, v3
    s_mov_b32 s64, 21504
    buffer_load_dwordx4 v[64:67], v28, s[44:47], s64 offen
    s_mov_b32 s64, 25088
    buffer_load_dwordx4 v[68:71], v28, s[44:47], s64 offen
    s_waitcnt vmcnt(2)
    v_perm_b32 v30, v60, v56, s72
    v_perm_b32 v31, v60, v56, s73
    v_dot2c_f32_bf16 v18, v30, v4
    v_dot2c_f32_bf16 v19, v31, v4
    v_perm_b32 v30, v61, v57, s72
    v_perm_b32 v31, v61, v57, s73
    v_dot2c_f32_bf16 v20, v30, v4
    v_dot2c_f32_bf16 v21, v31, v4
    v_perm_b32 v30, v62, v58, s72
    v_perm_b32 v31, v62, v58, s73
    v_dot2c_f32_bf16 v22, v30, v4
    v_dot2c_f32_bf16 v23, v31, v4
    v_perm_b32 v30, v63, v59, s72
    v_perm_b32 v31, v63, v59, s73
    v_dot2c_f32_bf16 v24, v30, v4
    v_dot2c_f32_bf16 v25, v31, v4
    s_mov_b32 s64, 28672
    buffer_load_dwordx4 v[72:75], v28, s[44:47], s64 offen
    s_mov_b32 s64, 32256
    buffer_load_dwordx4 v[76:79], v28, s[44:47], s64 offen
    s_waitcnt vmcnt(2)
    v_perm_b32 v30, v68, v64, s72
    v_perm_b32 v31, v68, v64, s73
    v_dot2c_f32_bf16 v18, v30, v5
    v_dot2c_f32_bf16 v19, v31, v5
    v_perm_b32 v30, v69, v65, s72
    v_perm_b32 v31, v69, v65, s73
    v_dot2c_f32_bf16 v20, v30, v5
    v_dot2c_f32_bf16 v21, v31, v5
    v_perm_b32 v30, v70, v66, s72
    v_perm_b32 v31, v70, v66, s73
    v_dot2c_f32_bf16 v22, v30, v5
    v_dot2c_f32_bf16 v23, v31, v5
    v_perm_b32 v30, v71, v67, s72
    v_perm_b32 v31, v71, v67, s73
    v_dot2c_f32_bf16 v24, v30, v5
    v_dot2c_f32_bf16 v25, v31, v5
    s_mov_b32 s64, 35840
    buffer_load_dwordx4 v[80:83], v28, s[44:47], s64 offen
    s_mov_b32 s64, 39424
    buffer_load_dwordx4 v[84:87], v28, s[44:47], s64 offen
    s_waitcnt vmcnt(2)
    v_perm_b32 v30, v76, v72, s72
    v_perm_b32 v31, v76, v72, s73
    v_dot2c_f32_bf16 v18, v30, v6
    v_dot2c_f32_bf16 v19, v31, v6
    v_perm_b32 v30, v77, v73, s72
    v_perm_b32 v31, v77, v73, s73
    v_dot2c_f32_bf16 v20, v30, v6
    v_dot2c_f32_bf16 v21, v31, v6
    v_perm_b32 v30, v78, v74, s72
    v_perm_b32 v31, v78, v74, s73
    v_dot2c_f32_bf16 v22, v30, v6
    v_dot2c_f32_bf16 v23, v31, v6
    v_perm_b32 v30, v79, v75, s72
    v_perm_b32 v31, v79, v75, s73
    v_dot2c_f32_bf16 v24, v30, v6
    v_dot2c_f32_bf16 v25, v31, v6
    s_mov_b32 s64, 43008
    buffer_load_dwordx4 v[88:91], v28, s[44:47], s64 offen
    s_mov_b32 s64, 46592
    buffer_load_dwordx4 v[92:95], v28, s[44:47], s64 offen
    s_waitcnt vmcnt(2)
    v_perm_b32 v30, v84, v80, s72
    v_perm_b32 v31, v84, v80, s73
    v_dot2c_f32_bf16 v18, v30, v7
    v_dot2c_f32_bf16 v19, v31, v7
    v_perm_b32 v30, v85, v81, s72
    v_perm_b32 v31, v85, v81, s73
    v_dot2c_f32_bf16 v20, v30, v7
    v_dot2c_f32_bf16 v21, v31, v7
    v_perm_b32 v30, v86, v82, s72
    v_perm_b32 v31, v86, v82, s73
    v_dot2c_f32_bf16 v22, v30, v7
    v_dot2c_f32_bf16 v23, v31, v7
    v_perm_b32 v30, v87, v83, s72
    v_perm_b32 v31, v87, v83, s73
    v_dot2c_f32_bf16 v24, v30, v7
    v_dot2c_f32_bf16 v25, v31, v7
    s_mov_b32 s64, 50176
    buffer_load_dwordx4 v[96:99], v28, s[44:47], s64 offen
    s_mov_b32 s64, 53760
    buffer_load_dwordx4 v[100:103], v28, s[44:47], s64 offen
    s_waitcnt vmcnt(2)
    v_perm_b32 v30, v92, v88, s72
    v_perm_b32 v31, v92, v88, s73
    v_dot2c_f32_bf16 v18, v30, v8
    v_dot2c_f32_bf16 v19, v31, v8
    v_perm_b32 v30, v93, v89, s72
    v_perm_b32 v31, v93, v89, s73
    v_dot2c_f32_bf16 v20, v30, v8
    v_dot2c_f32_bf16 v21, v31, v8
    v_perm_b32 v30, v94, v90, s72
    v_perm_b32 v31, v94, v90, s73
    v_dot2c_f32_bf16 v22, v30, v8
    v_dot2c_f32_bf16 v23, v31, v8
    v_perm_b32 v30, v95, v91, s72
    v_perm_b32 v31, v95, v91, s73
    v_dot2c_f32_bf16 v24, v30, v8
    v_dot2c_f32_bf16 v25, v31, v8
    s_mov_b32 s64, 57344
    buffer_load_dwordx4 v[40:43], v28, s[44:47], s64 offen
    s_mov_b32 s64, 60928
    buffer_load_dwordx4 v[44:47], v28, s[44:47], s64 offen
    s_waitcnt vmcnt(2)
    v_perm_b32 v30, v100, v96, s72
    v_perm_b32 v31, v100, v96, s73
    v_dot2c_f32_bf16 v18, v30, v9
    v_dot2c_f32_bf16 v19, v31, v9
    v_perm_b32 v30, v101, v97, s72
    v_perm_b32 v31, v101, v97, s73
    v_dot2c_f32_bf16 v20, v30, v9
    v_dot2c_f32_bf16 v21, v31, v9
    v_perm_b32 v30, v102, v98, s72
    v_perm_b32 v31, v102, v98, s73
    v_dot2c_f32_bf16 v22, v30, v9
    v_dot2c_f32_bf16 v23, v31, v9
    v_perm_b32 v30, v103, v99, s72
    v_perm_b32 v31, v103, v99, s73
    v_dot2c_f32_bf16 v24, v30, v9
    v_dot2c_f32_bf16 v25, v31, v9
    s_mov_b32 s64, 64512
    buffer_load_dwordx4 v[48:51], v28, s[44:47], s64 offen
    s_mov_b32 s64, 68096
    buffer_load_dwordx4 v[52:55], v28, s[44:47], s64 offen
    s_waitcnt vmcnt(2)
    v_perm_b32 v30, v44, v40, s72
    v_perm_b32 v31, v44, v40, s73
    v_dot2c_f32_bf16 v18, v30, v10
    v_dot2c_f32_bf16 v19, v31, v10
    v_perm_b32 v30, v45, v41, s72
    v_perm_b32 v31, v45, v41, s73
    v_dot2c_f32_bf16 v20, v30, v10
    v_dot2c_f32_bf16 v21, v31, v10
    v_perm_b32 v30, v46, v42, s72
    v_perm_b32 v31, v46, v42, s73
    v_dot2c_f32_bf16 v22, v30, v10
    v_dot2c_f32_bf16 v23, v31, v10
    v_perm_b32 v30, v47, v43, s72
    v_perm_b32 v31, v47, v43, s73
    v_dot2c_f32_bf16 v24, v30, v10
    v_dot2c_f32_bf16 v25, v31, v10
    s_mov_b32 s64, 71680
    buffer_load_dwordx4 v[56:59], v28, s[44:47], s64 offen
    s_mov_b32 s64, 75264
    buffer_load_dwordx4 v[60:63], v28, s[44:47], s64 offen
    s_waitcnt vmcnt(2)
    v_perm_b32 v30, v52, v48, s72
    v_perm_b32 v31, v52, v48, s73
    v_dot2c_f32_bf16 v18, v30, v11
    v_dot2c_f32_bf16 v19, v31, v11
    v_perm_b32 v30, v53, v49, s72
    v_perm_b32 v31, v53, v49, s73
    v_dot2c_f32_bf16 v20, v30, v11
    v_dot2c_f32_bf16 v21, v31, v11
    v_perm_b32 v30, v54, v50, s72
    v_perm_b32 v31, v54, v50, s73
    v_dot2c_f32_bf16 v22, v30, v11
    v_dot2c_f32_bf16 v23, v31, v11
    v_perm_b32 v30, v55, v51, s72
    v_perm_b32 v31, v55, v51, s73
    v_dot2c_f32_bf16 v24, v30, v11
    v_dot2c_f32_bf16 v25, v31, v11
    s_mov_b32 s64, 78848
    buffer_load_dwordx4 v[64:67], v28, s[44:47], s64 offen
    s_mov_b32 s64, 82432
    buffer_load_dwordx4 v[68:71], v28, s[44:47], s64 offen
    s_waitcnt vmcnt(2)
    v_perm_b32 v30, v60, v56, s72
    v_perm_b32 v31, v60, v56, s73
    v_dot2c_f32_bf16 v18, v30, v12
    v_dot2c_f32_bf16 v19, v31, v12
    v_perm_b32 v30, v61, v57, s72
    v_perm_b32 v31, v61, v57, s73
    v_dot2c_f32_bf16 v20, v30, v12
    v_dot2c_f32_bf16 v21, v31, v12
    v_perm_b32 v30, v62, v58, s72
    v_perm_b32 v31, v62, v58, s73
    v_dot2c_f32_bf16 v22, v30, v12
    v_dot2c_f32_bf16 v23, v31, v12
    v_perm_b32 v30, v63, v59, s72
    v_perm_b32 v31, v63, v59, s73
    v_dot2c_f32_bf16 v24, v30, v12
    v_dot2c_f32_bf16 v25, v31, v12
    s_mov_b32 s64, 86016
    buffer_load_dwordx4 v[72:75], v28, s[44:47], s64 offen
    s_mov_b32 s64, 89600
    buffer_load_dwordx4 v[76:79], v28, s[44:47], s64 offen
    s_waitcnt vmcnt(2)
    v_perm_b32 v30, v68, v64, s72
    v_perm_b32 v31, v68, v64, s73
    v_dot2c_f32_bf16 v18, v30, v13
    v_dot2c_f32_bf16 v19, v31, v13
    v_perm_b32 v30, v69, v65, s72
    v_perm_b32 v31, v69, v65, s73
    v_dot2c_f32_bf16 v20, v30, v13
    v_dot2c_f32_bf16 v21, v31, v13
    v_perm_b32 v30, v70, v66, s72
    v_perm_b32 v31, v70, v66, s73
    v_dot2c_f32_bf16 v22, v30, v13
    v_dot2c_f32_bf16 v23, v31, v13
    v_perm_b32 v30, v71, v67, s72
    v_perm_b32 v31, v71, v67, s73
    v_dot2c_f32_bf16 v24, v30, v13
    v_dot2c_f32_bf16 v25, v31, v13
    s_mov_b32 s64, 93184
    buffer_load_dwordx4 v[80:83], v28, s[44:47], s64 offen
    s_mov_b32 s64, 96768
    buffer_load_dwordx4 v[84:87], v28, s[44:47], s64 offen
    s_waitcnt vmcnt(2)
    v_perm_b32 v30, v76, v72, s72
    v_perm_b32 v31, v76, v72, s73
    v_dot2c_f32_bf16 v18, v30, v14
    v_dot2c_f32_bf16 v19, v31, v14
    v_perm_b32 v30, v77, v73, s72
    v_perm_b32 v31, v77, v73, s73
    v_dot2c_f32_bf16 v20, v30, v14
    v_dot2c_f32_bf16 v21, v31, v14
    v_perm_b32 v30, v78, v74, s72
    v_perm_b32 v31, v78, v74, s73
    v_dot2c_f32_bf16 v22, v30, v14
    v_dot2c_f32_bf16 v23, v31, v14
    v_perm_b32 v30, v79, v75, s72
    v_perm_b32 v31, v79, v75, s73
    v_dot2c_f32_bf16 v24, v30, v14
    v_dot2c_f32_bf16 v25, v31, v14
    s_mov_b32 s64, 100352
    buffer_load_dwordx4 v[88:91], v28, s[44:47], s64 offen
    s_mov_b32 s64, 103936
    buffer_load_dwordx4 v[92:95], v28, s[44:47], s64 offen
    s_waitcnt vmcnt(2)
    v_perm_b32 v30, v84, v80, s72
    v_perm_b32 v31, v84, v80, s73
    v_dot2c_f32_bf16 v18, v30, v15
    v_dot2c_f32_bf16 v19, v31, v15
    v_perm_b32 v30, v85, v81, s72
    v_perm_b32 v31, v85, v81, s73
    v_dot2c_f32_bf16 v20, v30, v15
    v_dot2c_f32_bf16 v21, v31, v15
    v_perm_b32 v30, v86, v82, s72
    v_perm_b32 v31, v86, v82, s73
    v_dot2c_f32_bf16 v22, v30, v15
    v_dot2c_f32_bf16 v23, v31, v15
    v_perm_b32 v30, v87, v83, s72
    v_perm_b32 v31, v87, v83, s73
    v_dot2c_f32_bf16 v24, v30, v15
    v_dot2c_f32_bf16 v25, v31, v15
    s_mov_b32 s64, 107520
    buffer_load_dwordx4 v[96:99], v28, s[44:47], s64 offen
    s_mov_b32 s64, 111104
    buffer_load_dwordx4 v[100:103], v28, s[44:47], s64 offen
    s_waitcnt vmcnt(2)
    v_perm_b32 v30, v92, v88, s72
    v_perm_b32 v31, v92, v88, s73
    v_dot2c_f32_bf16 v18, v30, v16
    v_dot2c_f32_bf16 v19, v31, v16
    v_perm_b32 v30, v93, v89, s72
    v_perm_b32 v31, v93, v89, s73
    v_dot2c_f32_bf16 v20, v30, v16
    v_dot2c_f32_bf16 v21, v31, v16
    v_perm_b32 v30, v94, v90, s72
    v_perm_b32 v31, v94, v90, s73
    v_dot2c_f32_bf16 v22, v30, v16
    v_dot2c_f32_bf16 v23, v31, v16
    v_perm_b32 v30, v95, v91, s72
    v_perm_b32 v31, v95, v91, s73
    v_dot2c_f32_bf16 v24, v30, v16
    v_dot2c_f32_bf16 v25, v31, v16
    s_waitcnt vmcnt(0)
    v_perm_b32 v30, v100, v96, s72
    v_perm_b32 v31, v100, v96, s73
    v_dot2c_f32_bf16 v18, v30, v17
    v_dot2c_f32_bf16 v19, v31, v17
    v_perm_b32 v30, v101, v97, s72
    v_perm_b32 v31, v101, v97, s73
    v_dot2c_f32_bf16 v20, v30, v17
    v_dot2c_f32_bf16 v21, v31, v17
    v_perm_b32 v30, v102, v98, s72
    v_perm_b32 v31, v102, v98, s73
    v_dot2c_f32_bf16 v22, v30, v17
    v_dot2c_f32_bf16 v23, v31, v17
    v_perm_b32 v30, v103, v99, s72
    v_perm_b32 v31, v103, v99, s73
    v_dot2c_f32_bf16 v24, v30, v17
    v_dot2c_f32_bf16 v25, v31, v17
    s_nop 2
    v_permlane32_swap_b32 v18, v22
    v_permlane32_swap_b32 v19, v23
    v_permlane32_swap_b32 v20, v24
    v_permlane32_swap_b32 v21, v25
    s_nop 1
    v_add_f32 v18, v18, v22
    v_add_f32 v19, v19, v23
    v_add_f32 v20, v20, v24
    v_add_f32 v21, v21, v25
    s_nop 1
    v_permlane16_swap_b32 v18, v20
    v_permlane16_swap_b32 v19, v21
    s_nop 1
    v_add_f32 v18, v18, v20
    v_add_f32 v19, v19, v21
    s_nop 1
    v_add_f32_dpp v18, v18, v18 row_ror:8 row_mask:0xf bank_mask:0xf
    v_add_f32_dpp v19, v19, v19 row_ror:8 row_mask:0xf bank_mask:0xf
    s_nop 0
    v_add_f32_dpp v18, v18, v18 row_ror:4 row_mask:0xf bank_mask:0xf
    v_add_f32_dpp v19, v19, v19 row_ror:4 row_mask:0xf bank_mask:0xf
    s_lshl_b32 s62, s65, 6
    s_add_u32 s44, s18, s62
    s_addc_u32 s45, s19, 0
    s_and_b32 s45, s45, 0xffff
    s_mov_b32 s46, 64
    s_mov_b32 s47, 0x00020000
    v_lshrrev_b32 v26, 4, v1
    v_lshlrev_b32 v26, 2, v26
    v_and_b32 v27, 3, v1
    v_lshl_add_u32 v26, v27, 4, v26
    buffer_load_dword v27, v26, s[44:47], 0 offen
    v_cvt_pk_bf16_f32 v28, v18, v19
    v_lshlrev_b32 v18, 16, v28
    v_and_b32 v19, 0xffff0000, v28
    s_waitcnt vmcnt(0)
    v_lshlrev_b32 v28, 16, v27
    v_and_b32 v29, 0xffff0000, v27
    v_add_f32 v18, v18, v28
    v_add_f32 v19, v19, v29
    v_cvt_pk_bf16_f32 v28, v18, v19
    v_lshlrev_b32 v18, 16, v28
    v_and_b32 v19, 0xffff0000, v28
    v_max_f32 v18, 0, v18
    v_max_f32 v19, 0, v19
    v_mul_f32 v18, v18, v18
    v_mul_f32 v19, v19, v19
    v_cvt_pk_bf16_f32 v120, v18, v19
    v_lshlrev_b32 v28, 4, v1
    v_mov_b32 v18, 0
    v_mov_b32 v19, 0
    v_mov_b32 v20, 0
    v_mov_b32 v21, 0
    v_mov_b32 v22, 0
    v_mov_b32 v23, 0
    v_mov_b32 v24, 0
    v_mov_b32 v25, 0
    s_mov_b32 s64, 0
    buffer_load_dwordx4 v[40:43], v28, s[48:51], s64 offen offset:0
    s_mov_b32 s64, 0
    buffer_load_dwordx4 v[44:47], v28, s[48:51], s64 offen offset:1024
    s_mov_b32 s64, 0
    buffer_load_dwordx4 v[48:51], v28, s[48:51], s64 offen offset:2048
    s_mov_b32 s64, 0
    buffer_load_dwordx4 v[52:55], v28, s[48:51], s64 offen offset:3072
    s_waitcnt vmcnt(2)
    v_readlane_b32 s62, v120, 0
    v_perm_b32 v30, v44, v40, s72
    v_perm_b32 v31, v44, v40, s73
    v_dot2c_f32_bf16 v18, s62, v30
    v_dot2c_f32_bf16 v19, s62, v31
    v_perm_b32 v30, v45, v41, s72
    v_perm_b32 v31, v45, v41, s73
    v_dot2c_f32_bf16 v20, s62, v30
    v_dot2c_f32_bf16 v21, s62, v31
    v_perm_b32 v30, v46, v42, s72
    v_perm_b32 v31, v46, v42, s73
    v_dot2c_f32_bf16 v22, s62, v30
    v_dot2c_f32_bf16 v23, s62, v31
    v_perm_b32 v30, v47, v43, s72
    v_perm_b32 v31, v47, v43, s73
    v_dot2c_f32_bf16 v24, s62, v30
    v_dot2c_f32_bf16 v25, s62, v31
    s_mov_b32 s64, 4096
    buffer_load_dwordx4 v[56:59], v28, s[48:51], s64 offen offset:0
    s_mov_b32 s64, 4096
    buffer_load_dwordx4 v[60:63], v28, s[48:51], s64 offen offset:1024
    s_waitcnt vmcnt(2)
    v_readlane_b32 s62, v120, 16
    v_perm_b32 v30, v52, v48, s72
    v_perm_b32 v31, v52, v48, s73
    v_dot2c_f32_bf16 v18, s62, v30
    v_dot2c_f32_bf16 v19, s62, v31
    v_perm_b32 v30, v53, v49, s72
    v_perm_b32 v31, v53, v49, s73
    v_dot2c_f32_bf16 v20, s62, v30
    v_dot2c_f32_bf16 v21, s62, v31
    v_perm_b32 v30, v54, v50, s72
    v_perm_b32 v31, v54, v50, s73
    v_dot2c_f32_bf16 v22, s62, v30
    v_dot2c_f32_bf16 v23, s62, v31
    v_perm_b32 v30, v55, v51, s72
    v_perm_b32 v31, v55, v51, s73
    v_dot2c_f32_bf16 v24, s62, v30
    v_dot2c_f32_bf16 v25, s62, v31
    s_mov_b32 s64, 4096
    buffer_load_dwordx4 v[64:67], v28, s[48:51], s64 offen offset:2048
    s_mov_b32 s64, 4096
    buffer_load_dwordx4 v[68:71], v28, s[48:51], s64 offen offset:3072
    s_waitcnt vmcnt(2)
    v_readlane_b32 s62, v120, 32
    v_perm_b32 v30, v60, v56, s72
    v_perm_b32 v31, v60, v56, s73
    v_dot2c_f32_bf16 v18, s62, v30
    v_dot2c_f32_bf16 v19, s62, v31
    v_perm_b32 v30, v61, v57, s72
    v_perm_b32 v31, v61, v57, s73
    v_dot2c_f32_bf16 v20, s62, v30
    v_dot2c_f32_bf16 v21, s62, v31
    v_perm_b32 v30, v62, v58, s72
    v_perm_b32 v31, v62, v58, s73
    v_dot2c_f32_bf16 v22, s62, v30
    v_dot2c_f32_bf16 v23, s62, v31
    v_perm_b32 v30, v63, v59, s72
    v_perm_b32 v31, v63, v59, s73
    v_dot2c_f32_bf16 v24, s62, v30
    v_dot2c_f32_bf16 v25, s62, v31
    s_mov_b32 s64, 8192
    buffer_load_dwordx4 v[72:75], v28, s[48:51], s64 offen offset:0
    s_mov_b32 s64, 8192
    buffer_load_dwordx4 v[76:79], v28, s[48:51], s64 offen offset:1024
    s_waitcnt vmcnt(2)
    v_readlane_b32 s62, v120, 48
    v_perm_b32 v30, v68, v64, s72
    v_perm_b32 v31, v68, v64, s73
    v_dot2c_f32_bf16 v18, s62, v30
    v_dot2c_f32_bf16 v19, s62, v31
    v_perm_b32 v30, v69, v65, s72
    v_perm_b32 v31, v69, v65, s73
    v_dot2c_f32_bf16 v20, s62, v30
    v_dot2c_f32_bf16 v21, s62, v31
    v_perm_b32 v30, v70, v66, s72
    v_perm_b32 v31, v70, v66, s73
    v_dot2c_f32_bf16 v22, s62, v30
    v_dot2c_f32_bf16 v23, s62, v31
    v_perm_b32 v30, v71, v67, s72
    v_perm_b32 v31, v71, v67, s73
    v_dot2c_f32_bf16 v24, s62, v30
    v_dot2c_f32_bf16 v25, s62, v31
    s_mov_b32 s64, 8192
    buffer_load_dwordx4 v[80:83], v28, s[48:51], s64 offen offset:2048
    s_mov_b32 s64, 8192
    buffer_load_dwordx4 v[84:87], v28, s[48:51], s64 offen offset:3072
    s_waitcnt vmcnt(2)
    v_readlane_b32 s62, v120, 1
    v_perm_b32 v30, v76, v72, s72
    v_perm_b32 v31, v76, v72, s73
    v_dot2c_f32_bf16 v18, s62, v30
    v_dot2c_f32_bf16 v19, s62, v31
    v_perm_b32 v30, v77, v73, s72
    v_perm_b32 v31, v77, v73, s73
    v_dot2c_f32_bf16 v20, s62, v30
    v_dot2c_f32_bf16 v21, s62, v31
    v_perm_b32 v30, v78, v74, s72
    v_perm_b32 v31, v78, v74, s73
    v_dot2c_f32_bf16 v22, s62, v30
    v_dot2c_f32_bf16 v23, s62, v31
    v_perm_b32 v30, v79, v75, s72
    v_perm_b32 v31, v79, v75, s73
    v_dot2c_f32_bf16 v24, s62, v30
    v_dot2c_f32_bf16 v25, s62, v31
    s_mov_b32 s64, 12288
    buffer_load_dwordx4 v[88:91], v28, s[48:51], s64 offen offset:0
    s_mov_b32 s64, 12288
    buffer_load_dwordx4 v[92:95], v28, s[48:51], s64 offen offset:1024
    s_waitcnt vmcnt(2)
    v_readlane_b32 s62, v120, 17
    v_perm_b32 v30, v84, v80, s72
    v_perm_b32 v31, v84, v80, s73
    v_dot2c_f32_bf16 v18, s62, v30
    v_dot2c_f32_bf16 v19, s62, v31
    v_perm_b32 v30, v85, v81, s72
    v_perm_b32 v31, v85, v81, s73
    v_dot2c_f32_bf16 v20, s62, v30
    v_dot2c_f32_bf16 v21, s62, v31
    v_perm_b32 v30, v86, v82, s72
    v_perm_b32 v31, v86, v82, s73
    v_dot2c_f32_bf16 v22, s62, v30
    v_dot2c_f32_bf16 v23, s62, v31
    v_perm_b32 v30, v87, v83, s72
    v_perm_b32 v31, v87, v83, s73
    v_dot2c_f32_bf16 v24, s62, v30
    v_dot2c_f32_bf16 v25, s62, v31
    s_mov_b32 s64, 12288
    buffer_load_dwordx4 v[96:99], v28, s[48:51], s64 offen offset:2048
    s_mov_b32 s64, 12288
    buffer_load_dwordx4 v[100:103], v28, s[48:51], s64 offen offset:3072
    s_waitcnt vmcnt(2)
    v_readlane_b32 s62, v120, 33
    v_perm_b32 v30, v92, v88, s72
    v_perm_b32 v31, v92, v88, s73
    v_dot2c_f32_bf16 v18, s62, v30
    v_dot2c_f32_bf16 v19, s62, v31
    v_perm_b32 v30, v93, v89, s72
    v_perm_b32 v31, v93, v89, s73
    v_dot2c_f32_bf16 v20, s62, v30
    v_dot2c_f32_bf16 v21, s62, v31
    v_perm_b32 v30, v94, v90, s72
    v_perm_b32 v31, v94, v90, s73
    v_dot2c_f32_bf16 v22, s62, v30
    v_dot2c_f32_bf16 v23, s62, v31
    v_perm_b32 v30, v95, v91, s72
    v_perm_b32 v31, v95, v91, s73
    v_dot2c_f32_bf16 v24, s62, v30
    v_dot2c_f32_bf16 v25, s62, v31
    s_mov_b32 s64, 16384
    buffer_load_dwordx4 v[40:43], v28, s[48:51], s64 offen offset:0
    s_mov_b32 s64, 16384
    buffer_load_dwordx4 v[44:47], v28, s[48:51], s64 offen offset:1024
    s_waitcnt vmcnt(2)
    v_readlane_b32 s62, v120, 49
    v_perm_b32 v30, v100, v96, s72
    v_perm_b32 v31, v100, v96, s73
    v_dot2c_f32_bf16 v18, s62, v30
    v_dot2c_f32_bf16 v19, s62, v31
    v_perm_b32 v30, v101, v97, s72
    v_perm_b32 v31, v101, v97, s73
    v_dot2c_f32_bf16 v20, s62, v30
    v_dot2c_f32_bf16 v21, s62, v31
    v_perm_b32 v30, v102, v98, s72
    v_perm_b32 v31, v102, v98, s73
    v_dot2c_f32_bf16 v22, s62, v30
    v_dot2c_f32_bf16 v23, s62, v31
    v_perm_b32 v30, v103, v99, s72
    v_perm_b32 v31, v103, v99, s73
    v_dot2c_f32_bf16 v24, s62, v30
    v_dot2c_f32_bf16 v25, s62, v31
    s_mov_b32 s64, 16384
    buffer_load_dwordx4 v[48:51], v28, s[48:51], s64 offen offset:2048
    s_mov_b32 s64, 16384
    buffer_load_dwordx4 v[52:55], v28, s[48:51], s64 offen offset:3072
    s_waitcnt vmcnt(2)
    v_readlane_b32 s62, v120, 2
    v_perm_b32 v30, v44, v40, s72
    v_perm_b32 v31, v44, v40, s73
    v_dot2c_f32_bf16 v18, s62, v30
    v_dot2c_f32_bf16 v19, s62, v31
    v_perm_b32 v30, v45, v41, s72
    v_perm_b32 v31, v45, v41, s73
    v_dot2c_f32_bf16 v20, s62, v30
    v_dot2c_f32_bf16 v21, s62, v31
    v_perm_b32 v30, v46, v42, s72
    v_perm_b32 v31, v46, v42, s73
    v_dot2c_f32_bf16 v22, s62, v30
    v_dot2c_f32_bf16 v23, s62, v31
    v_perm_b32 v30, v47, v43, s72
    v_perm_b32 v31, v47, v43, s73
    v_dot2c_f32_bf16 v24, s62, v30
    v_dot2c_f32_bf16 v25, s62, v31
    s_mov_b32 s64, 20480
    buffer_load_dwordx4 v[56:59], v28, s[48:51], s64 offen offset:0
    s_mov_b32 s64, 20480
    buffer_load_dwordx4 v[60:63], v28, s[48:51], s64 offen offset:1024
    s_waitcnt vmcnt(2)
    v_readlane_b32 s62, v120, 18
    v_perm_b32 v30, v52, v48, s72
    v_perm_b32 v31, v52, v48, s73
    v_dot2c_f32_bf16 v18, s62, v30
    v_dot2c_f32_bf16 v19, s62, v31
    v_perm_b32 v30, v53, v49, s72
    v_perm_b32 v31, v53, v49, s73
    v_dot2c_f32_bf16 v20, s62, v30
    v_dot2c_f32_bf16 v21, s62, v31
    v_perm_b32 v30, v54, v50, s72
    v_perm_b32 v31, v54, v50, s73
    v_dot2c_f32_bf16 v22, s62, v30
    v_dot2c_f32_bf16 v23, s62, v31
    v_perm_b32 v30, v55, v51, s72
    v_perm_b32 v31, v55, v51, s73
    v_dot2c_f32_bf16 v24, s62, v30
    v_dot2c_f32_bf16 v25, s62, v31
    s_mov_b32 s64, 20480
    buffer_load_dwordx4 v[64:67], v28, s[48:51], s64 offen offset:2048
    s_mov_b32 s64, 20480
    buffer_load_dwordx4 v[68:71], v28, s[48:51], s64 offen offset:3072
    s_waitcnt vmcnt(2)
    v_readlane_b32 s62, v120, 34
    v_perm_b32 v30, v60, v56, s72
    v_perm_b32 v31, v60, v56, s73
    v_dot2c_f32_bf16 v18, s62, v30
    v_dot2c_f32_bf16 v19, s62, v31
    v_perm_b32 v30, v61, v57, s72
    v_perm_b32 v31, v61, v57, s73
    v_dot2c_f32_bf16 v20, s62, v30
    v_dot2c_f32_bf16 v21, s62, v31
    v_perm_b32 v30, v62, v58, s72
    v_perm_b32 v31, v62, v58, s73
    v_dot2c_f32_bf16 v22, s62, v30
    v_dot2c_f32_bf16 v23, s62, v31
    v_perm_b32 v30, v63, v59, s72
    v_perm_b32 v31, v63, v59, s73
    v_dot2c_f32_bf16 v24, s62, v30
    v_dot2c_f32_bf16 v25, s62, v31
    s_mov_b32 s64, 24576
    buffer_load_dwordx4 v[72:75], v28, s[48:51], s64 offen offset:0
    s_mov_b32 s64, 24576
    buffer_load_dwordx4 v[76:79], v28, s[48:51], s64 offen offset:1024
    s_waitcnt vmcnt(2)
    v_readlane_b32 s62, v120, 50
    v_perm_b32 v30, v68, v64, s72
    v_perm_b32 v31, v68, v64, s73
    v_dot2c_f32_bf16 v18, s62, v30
    v_dot2c_f32_bf16 v19, s62, v31
    v_perm_b32 v30, v69, v65, s72
    v_perm_b32 v31, v69, v65, s73
    v_dot2c_f32_bf16 v20, s62, v30
    v_dot2c_f32_bf16 v21, s62, v31
    v_perm_b32 v30, v70, v66, s72
    v_perm_b32 v31, v70, v66, s73
    v_dot2c_f32_bf16 v22, s62, v30
    v_dot2c_f32_bf16 v23, s62, v31
    v_perm_b32 v30, v71, v67, s72
    v_perm_b32 v31, v71, v67, s73
    v_dot2c_f32_bf16 v24, s62, v30
    v_dot2c_f32_bf16 v25, s62, v31
    s_mov_b32 s64, 24576
    buffer_load_dwordx4 v[80:83], v28, s[48:51], s64 offen offset:2048
    s_mov_b32 s64, 24576
    buffer_load_dwordx4 v[84:87], v28, s[48:51], s64 offen offset:3072
    s_waitcnt vmcnt(2)
    v_readlane_b32 s62, v120, 3
    v_perm_b32 v30, v76, v72, s72
    v_perm_b32 v31, v76, v72, s73
    v_dot2c_f32_bf16 v18, s62, v30
    v_dot2c_f32_bf16 v19, s62, v31
    v_perm_b32 v30, v77, v73, s72
    v_perm_b32 v31, v77, v73, s73
    v_dot2c_f32_bf16 v20, s62, v30
    v_dot2c_f32_bf16 v21, s62, v31
    v_perm_b32 v30, v78, v74, s72
    v_perm_b32 v31, v78, v74, s73
    v_dot2c_f32_bf16 v22, s62, v30
    v_dot2c_f32_bf16 v23, s62, v31
    v_perm_b32 v30, v79, v75, s72
    v_perm_b32 v31, v79, v75, s73
    v_dot2c_f32_bf16 v24, s62, v30
    v_dot2c_f32_bf16 v25, s62, v31
    s_mov_b32 s64, 28672
    buffer_load_dwordx4 v[88:91], v28, s[48:51], s64 offen offset:0
    s_mov_b32 s64, 28672
    buffer_load_dwordx4 v[92:95], v28, s[48:51], s64 offen offset:1024
    s_waitcnt vmcnt(2)
    v_readlane_b32 s62, v120, 19
    v_perm_b32 v30, v84, v80, s72
    v_perm_b32 v31, v84, v80, s73
    v_dot2c_f32_bf16 v18, s62, v30
    v_dot2c_f32_bf16 v19, s62, v31
    v_perm_b32 v30, v85, v81, s72
    v_perm_b32 v31, v85, v81, s73
    v_dot2c_f32_bf16 v20, s62, v30
    v_dot2c_f32_bf16 v21, s62, v31
    v_perm_b32 v30, v86, v82, s72
    v_perm_b32 v31, v86, v82, s73
    v_dot2c_f32_bf16 v22, s62, v30
    v_dot2c_f32_bf16 v23, s62, v31
    v_perm_b32 v30, v87, v83, s72
    v_perm_b32 v31, v87, v83, s73
    v_dot2c_f32_bf16 v24, s62, v30
    v_dot2c_f32_bf16 v25, s62, v31
    s_mov_b32 s64, 28672
    buffer_load_dwordx4 v[96:99], v28, s[48:51], s64 offen offset:2048
    s_mov_b32 s64, 28672
    buffer_load_dwordx4 v[100:103], v28, s[48:51], s64 offen offset:3072
    s_waitcnt vmcnt(2)
    v_readlane_b32 s62, v120, 35
    v_perm_b32 v30, v92, v88, s72
    v_perm_b32 v31, v92, v88, s73
    v_dot2c_f32_bf16 v18, s62, v30
    v_dot2c_f32_bf16 v19, s62, v31
    v_perm_b32 v30, v93, v89, s72
    v_perm_b32 v31, v93, v89, s73
    v_dot2c_f32_bf16 v20, s62, v30
    v_dot2c_f32_bf16 v21, s62, v31
    v_perm_b32 v30, v94, v90, s72
    v_perm_b32 v31, v94, v90, s73
    v_dot2c_f32_bf16 v22, s62, v30
    v_dot2c_f32_bf16 v23, s62, v31
    v_perm_b32 v30, v95, v91, s72
    v_perm_b32 v31, v95, v91, s73
    v_dot2c_f32_bf16 v24, s62, v30
    v_dot2c_f32_bf16 v25, s62, v31
    s_waitcnt vmcnt(0)
    v_readlane_b32 s62, v120, 51
    v_perm_b32 v30, v100, v96, s72
    v_perm_b32 v31, v100, v96, s73
    v_dot2c_f32_bf16 v18, s62, v30
    v_dot2c_f32_bf16 v19, s62, v31
    v_perm_b32 v30, v101, v97, s72
    v_perm_b32 v31, v101, v97, s73
    v_dot2c_f32_bf16 v20, s62, v30
    v_dot2c_f32_bf16 v21, s62, v31
    v_perm_b32 v30, v102, v98, s72
    v_perm_b32 v31, v102, v98, s73
    v_dot2c_f32_bf16 v22, s62, v30
    v_dot2c_f32_bf16 v23, s62, v31
    v_perm_b32 v30, v103, v99, s72
    v_perm_b32 v31, v103, v99, s73
    v_dot2c_f32_bf16 v24, s62, v30
    v_dot2c_f32_bf16 v25, s62, v31
    s_lshl_b32 s62, s61, 11
    s_add_u32 s63, s62, 655360
    s_nop 1
    v_lshlrev_b32 v26, 4, v1
    s_mov_b32 s44, s10
    s_and_b32 s45, s11, 0xffff
    s_mov_b32 s46, 1024
    s_mov_b32 s47, 0x00020000
    s_lshl_b32 s63, s57, 10
    buffer_load_dwordx4 v[40:43], v26, s[40:43], s63 offen
    buffer_load_dwordx4 v[44:47], v26, s[44:47], 0 offen
    s_lshl_b32 s62, s78, 4
    s_add_u32 s48, s8, s62
    s_addc_u32 s49, s9, 0
    s_and_b32 s49, s49, 0xffff
    s_mov_b32 s50, 16
    s_mov_b32 s51, 0x00020000
    v_lshrrev_b32 v27, 4, v1
    v_lshlrev_b32 v27, 2, v27
    v_bfe_u32 v28, v1, 3, 1
    v_lshl_add_u32 v121, v28, 1, v27
    buffer_load_ushort v118, v121, s[48:51], 0 offen
    s_waitcnt vmcnt(1)
    v_mov_b32 v116, 0
    v_lshlrev_b32 v26, 16, v40
    v_and_b32 v27, 0xffff0000, v40
    v_lshlrev_b32 v28, 16, v44
    v_and_b32 v29, 0xffff0000, v44
    v_mul_f32 v26, v26, v28
    v_mul_f32 v27, v27, v29
    v_cvt_pk_bf16_f32 v26, v26, v27
    v_lshlrev_b32 v27, 16, v26
    v_and_b32 v26, 0xffff0000, v26
    v_add_f32 v116, v116, v27
    v_add_f32 v116, v116, v26
    v_lshlrev_b32 v26, 16, v41
    v_and_b32 v27, 0xffff0000, v41
    v_lshlrev_b32 v28, 16, v45
    v_and_b32 v29, 0xffff0000, v45
    v_mul_f32 v26, v26, v28
    v_mul_f32 v27, v27, v29
    v_cvt_pk_bf16_f32 v26, v26, v27
    v_lshlrev_b32 v27, 16, v26
    v_and_b32 v26, 0xffff0000, v26
    v_add_f32 v116, v116, v27
    v_add_f32 v116, v116, v26
    v_lshlrev_b32 v26, 16, v42
    v_and_b32 v27, 0xffff0000, v42
    v_lshlrev_b32 v28, 16, v46
    v_and_b32 v29, 0xffff0000, v46
    v_mul_f32 v26, v26, v28
    v_mul_f32 v27, v27, v29
    v_cvt_pk_bf16_f32 v26, v26, v27
    v_lshlrev_b32 v27, 16, v26
    v_and_b32 v26, 0xffff0000, v26
    v_add_f32 v116, v116, v27
    v_add_f32 v116, v116, v26
    v_lshlrev_b32 v26, 16, v43
    v_and_b32 v27, 0xffff0000, v43
    v_lshlrev_b32 v28, 16, v47
    v_and_b32 v29, 0xffff0000, v47
    v_mul_f32 v26, v26, v28
    v_mul_f32 v27, v27, v29
    v_cvt_pk_bf16_f32 v26, v26, v27
    v_lshlrev_b32 v27, 16, v26
    v_and_b32 v26, 0xffff0000, v26
    v_add_f32 v116, v116, v27
    v_add_f32 v116, v116, v26
    s_nop 1
    v_add_f32_dpp v116, v116, v116 quad_perm:[1,0,3,2] row_mask:0xf bank_mask:0xf
    s_nop 1
    v_add_f32_dpp v116, v116, v116 quad_perm:[2,3,0,1] row_mask:0xf bank_mask:0xf
    s_nop 1
    v_add_f32_dpp v116, v116, v116 row_ror:4 row_mask:0xf bank_mask:0xf
    s_nop 1
    v_add_f32_dpp v116, v116, v116 row_ror:8 row_mask:0xf bank_mask:0xf
    v_mov_b32 v26, v116
    v_mov_b32 v27, v116
    s_nop 1
    v_permlane32_swap_b32 v26, v27
    s_nop 1
    v_add_f32 v26, v26, v27
    v_mov_b32 v27, v26
    s_nop 1
    v_permlane16_swap_b32 v26, v27
    s_nop 1
    v_add_f32 v116, v26, v27
    v_cvt_pk_bf16_f32 v116, v116, v116
    v_lshlrev_b32 v116, 16, v116
    v_mul_f32 v116, 0xbfb8aa3b, v116
    v_exp_f32 v116, v116
    s_nop 0
    v_add_f32 v116, 1.0, v116
    v_rcp_f32 v116, v116
    s_nop 0
    v_cvt_pk_bf16_f32 v116, v116, v116
    v_lshlrev_b32 v116, 16, v116
    v_sub_f32 v117, 1.0, v116
    v_cvt_pk_bf16_f32 v117, v117, v117
    v_lshlrev_b32 v117, 16, v117
    s_mov_b32 s75, 200000
    v_mov_b32 v30, 4160
L_flag_poll:
    ds_read_b32 v26, v30
    s_waitcnt lgkmcnt(0)
    v_readfirstlane_b32 s62, v26
    s_cmp_eq_u32 s62, 1
    s_cbranch_scc1 L_flag_ok
    s_sleep 64
    s_sub_u32 s75, s75, 1
    s_cmp_lg_u32 s75, 0
    s_cbranch_scc1 L_flag_poll
L_flag_ok:
    s_mov_b32 s75, 200000
    s_lshl_b32 s63, s57, 13
    s_add_u32 s63, s63, 1179648
    v_lshlrev_b32 v30, 7, v1
L_rdy_poll:
    buffer_load_dword v26, v30, s[52:55], s63 offen sc1
    s_waitcnt vmcnt(0)
    v_cmp_ne_u32 vcc, v26, v122
    s_nop 4
    s_cbranch_vccz L_rdy_ok
    s_sleep 32
    s_sub_u32 s75, s75, 1
    s_cmp_lg_u32 s75, 0
    s_cbranch_scc1 L_rdy_poll
L_rdy_ok:
    s_lshl_b32 s62, s57, 17
    s_lshl_b32 s63, s78, 4
    s_add_u32 s64, s62, s63
    s_add_u32 s64, s64, 655360
    s_add_u32 s44, s22, s64
    s_addc_u32 s45, s23, 0
    s_and_b32 s45, s45, 0xffff
    s_mov_b32 s46, 114688
    s_mov_b32 s47, 0x00020000
    s_sub_u32 s46, s46, s63
    s_mul_i32 s62, s57, 139264
    s_add_u32 s48, s22, s62
    s_addc_u32 s49, s23, 0
    s_and_b32 s49, s49, 0xffff
    s_mov_b32 s50, 139264
    s_mov_b32 s51, 0x00020000
    v_lshlrev_b32 v119, 11, v1
    s_waitcnt vmcnt(0)
    v_lshlrev_b32 v118, 16, v118
    s_lshl_b32 s62, s57, 10
    s_lshl_b32 s63, s78, 4
    s_add_u32 s62, s62, s63
    s_add_u32 s28, s12, s62
    s_addc_u32 s29, s13, 0
    s_and_b32 s29, s29, 0xffff
    s_mov_b32 s30, 16
    s_mov_b32 s31, 0x00020000
    s_mov_b32 s62, 2176
    v_mul_lo_u32 v32, s62, v1
    s_lshl_b32 s65, s78, 5
    s_barrier
    v_lshlrev_b32 v33, 4, v1
    s_lshl_b32 s63, s61, 11
    s_add_u32 s63, s63, 655360
    buffer_store_dwordx4 v[18:21], v33, s[52:55], s63 offen sc1
    buffer_store_dwordx4 v[22:25], v33, s[52:55], s63 offen offset:1024 sc1
    s_mov_b32 s75, 200000
L_y_poll:
    buffer_load_dwordx4 v[104:107], v119, s[44:47], 0 offen sc1
    buffer_load_dwordx4 v[108:111], v119, s[44:47], 0 offen offset:1024 sc1
    buffer_load_dwordx4 v[40:43], v32, s[48:51], s65 offen sc1
    buffer_load_dwordx4 v[44:47], v32, s[48:51], s65 offen offset:16 sc1
    buffer_load_dwordx2 v[48:49], v32, s[48:51], 0 offen offset:2048 sc1
    s_waitcnt vmcnt(0)
    v_max3_u32 v26, v40, v41, v42
    v_max3_u32 v27, v43, v44, v45
    v_max3_u32 v26, v26, v46, v47
    v_max3_u32 v27, v27, v48, v49
    v_max3_u32 v28, v104, v105, v106
    v_max3_u32 v29, v107, v108, v109
    v_max3_u32 v28, v28, v110, v111
    v_max3_u32 v26, v26, v28, v29
    v_max_u32 v26, v26, v27
    v_cmp_eq_u32 vcc, -1, v26
    s_nop 1
    s_and_b64 exec, exec, vcc
    s_cbranch_execz L_y_poll_ok
    s_sleep 2
    s_sub_u32 s75, s75, 1
    s_cmp_lg_u32 s75, 0
    s_cbranch_scc1 L_y_poll
L_y_poll_ok:
    s_mov_b64 exec, -1
    v_mov_b32_dpp v26, v48 quad_perm:[1,0,3,2] row_mask:0xf bank_mask:0xf
    v_mov_b32_dpp v27, v49 quad_perm:[1,0,3,2] row_mask:0xf bank_mask:0xf
    v_max_f32 v28, v48, v26
    v_sub_f32 v29, v48, v28
    v_sub_f32 v26, v26, v28
    v_exp_f32 v29, v29
    v_exp_f32 v26, v26
    s_nop 0
    v_mul_f32 v28, v29, v49
    v_fma_f32 v28, v26, v27, v28
    v_rcp_f32 v28, v28
    s_nop 0
    v_mul_f32 v28, v28, v29
    v_mul_f32 v40, v28, v40
    v_mul_f32 v41, v28, v41
    v_mul_f32 v42, v28, v42
    v_mul_f32 v43, v28, v43
    v_mul_f32 v44, v28, v44
    v_mul_f32 v45, v28, v45
    v_mul_f32 v46, v28, v46
    v_mul_f32 v47, v28, v47
    s_nop 1
    v_permlane32_swap_b32 v40, v44
    v_permlane32_swap_b32 v104, v108
    v_permlane32_swap_b32 v41, v45
    v_permlane32_swap_b32 v105, v109
    v_permlane32_swap_b32 v42, v46
    v_permlane32_swap_b32 v106, v110
    v_permlane32_swap_b32 v43, v47
    v_permlane32_swap_b32 v107, v111
    v_add_f32 v40, v40, v44
    v_add_f32 v104, v104, v108
    v_add_f32 v41, v41, v45
    v_add_f32 v105, v105, v109
    v_add_f32 v42, v42, v46
    v_add_f32 v106, v106, v110
    v_add_f32 v43, v43, v47
    v_add_f32 v107, v107, v111
    s_nop 0
    v_permlane16_swap_b32 v40, v42
    v_permlane16_swap_b32 v104, v106
    v_permlane16_swap_b32 v41, v43
    v_permlane16_swap_b32 v105, v107
    v_add_f32 v40, v40, v42
    v_add_f32 v104, v104, v106
    v_add_f32 v41, v41, v43
    v_add_f32 v105, v105, v107
    s_nop 1
    v_add_f32_dpp v40, v40, v40 row_ror:8 row_mask:0xf bank_mask:0x3
    v_add_f32_dpp v104, v104, v104 row_ror:8 row_mask:0xf bank_mask:0x3
    v_add_f32_dpp v40, v41, v41 row_ror:8 row_mask:0xf bank_mask:0xc
    v_add_f32_dpp v104, v105, v105 row_ror:8 row_mask:0xf bank_mask:0xc
    s_nop 0
    v_add_f32_dpp v40, v40, v40 row_half_mirror row_mask:0xf bank_mask:0xf
    v_add_f32_dpp v104, v104, v104 row_half_mirror row_mask:0xf bank_mask:0xf
    s_nop 0
    v_add_f32_dpp v40, v40, v40 quad_perm:[1,0,3,2] row_mask:0xf bank_mask:0xf
    v_add_f32_dpp v104, v104, v104 quad_perm:[1,0,3,2] row_mask:0xf bank_mask:0xf
    s_nop 0
    v_add_f32_dpp v40, v40, v40 quad_perm:[2,3,0,1] row_mask:0xf bank_mask:0xf
    v_add_f32_dpp v104, v104, v104 quad_perm:[2,3,0,1] row_mask:0xf bank_mask:0xf
    v_cvt_pk_bf16_f32 v104, v104, v104
    v_lshlrev_b32 v104, 16, v104
    v_add_f32 v104, v104, v118
    v_cvt_pk_bf16_f32 v104, v104, v104
    v_lshlrev_b32 v104, 16, v104
    v_mul_f32 v117, v117, v104
    v_cvt_pk_bf16_f32 v117, v117, v117
    v_lshlrev_b32 v117, 16, v117
    v_cvt_pk_bf16_f32 v40, v40, v40
    v_lshlrev_b32 v40, 16, v40
    v_mul_f32 v40, v116, v40
    v_cvt_pk_bf16_f32 v40, v40, v40
    v_lshlrev_b32 v40, 16, v40
    v_add_f32 v40, v40, v117
    v_cvt_pk_bf16_f32 v40, v40, v40
    v_and_b32 v26, 7, v1
    v_cmp_eq_u32 vcc, 0, v26
    s_and_saveexec_b64 s[66:67], vcc
    buffer_store_short v40, v121, s[28:31], 0 offen
    s_cmp_lg_u32 s60, 0
    s_cbranch_scc1 L_no_epoch
    s_lshl_b32 s62, s57, 7
    s_add_u32 s62, s62, 1277952
    v_mov_b32 v30, 0
    buffer_store_dword v122, v30, s[52:55], s62 offen sc1
L_no_epoch:
L_end:
    s_endpgm
L_code_end:
.section .rodata,"a"
.p2align 6
.amdhsa_kernel gated_mix__mha_block_cached__dense_activation_squared_relu__decode_kernel
  .amdhsa_next_free_vgpr 248
  .amdhsa_next_free_sgpr 102
  .amdhsa_accum_offset 248
  .amdhsa_group_segment_fixed_size 0
  .amdhsa_kernarg_size 112
  .amdhsa_user_sgpr_count 2
  .amdhsa_user_sgpr_kernarg_segment_ptr 1
  .amdhsa_system_sgpr_workgroup_id_x 1
  .amdhsa_float_denorm_mode_32 3
.end_amdhsa_kernel
```
